```python
import torch

def _softmax(x, axis=-1):
    return torch.softmax(x, dim=axis)
def _gelu(x):
    return torch.nn.functional.gelu(x, approximate="tanh")
def _silu(x):
    return torch.nn.functional.silu(x)
def _sigmoid(x):
    return torch.sigmoid(x)
def _layernorm(x, axis=-1, eps=1e-5):
    m = x.mean(dim=axis, keepdim=True)
    v = x.var(dim=axis, keepdim=True, unbiased=False)
    return (x - m) / torch.sqrt(v + eps)
def _scatter_add(tgt, idx, src, axis=0):
    return tgt.clone().index_add_(axis, idx, src)
def _segment_sum(src, seg, n):
    out = torch.zeros((n,) + src.shape[1:], dtype=src.dtype)
    return out.index_add_(0, seg, src)
def _pad(x, pw):
    flat = tuple(v for pair in reversed(pw) for v in pair)
    return torch.nn.functional.pad(x, flat)

kernel_name = 'gated_mix__mha_block__moe_arch_mod__prompt'

def setup_inputs():

    _w = (lambda a: (lambda t: t.to(torch.bfloat16) if t.is_floating_point() else t)(torch.as_tensor(a)))
    def _A_setup():
        B, S, D, H = 1, 2048, 576, 32
        return {
            "x": _w((lambda *s: torch.randn(*s, dtype=torch.bfloat16) * 0.05)(B, S, D)),
            "wqkv": _w((lambda *s: torch.randn(*s, dtype=torch.bfloat16) * 0.8)(D, 3 * D)),
            "wo": _w((lambda *s: torch.randn(*s, dtype=torch.bfloat16) * 0.1)(D, D)),
        }
    _A_in = _A_setup()

    def _B_setup():
        B, S, D, F, C = 1, 2048, 576, 4608, 2
        return {
            "x": _w((lambda *s: torch.randn(*s, dtype=torch.bfloat16) * 0.05)(B, S, D)),
            "w_r": _w((lambda *s: torch.randn(*s, dtype=torch.bfloat16) * 3.2)(D)),
            "w_gate": _w((lambda *s: torch.randn(*s, dtype=torch.bfloat16) * 0.2)(D, F)),
            "w_up": _w((lambda *s: torch.randn(*s, dtype=torch.bfloat16) * 0.2)(D, F)),
            "w_down": _w((lambda *s: torch.randn(*s, dtype=torch.bfloat16) * 0.2)(F, D)),
        }
    _B_in = _B_setup()

    return {
        "A_x": _A_in["x"],
        "A_wqkv": _A_in["wqkv"],
        "A_wo": _A_in["wo"],
        "B_x": _B_in["x"],
        "B_w_r": _B_in["w_r"],
        "B_w_gate": _B_in["w_gate"],
        "B_w_up": _B_in["w_up"],
        "B_w_down": _B_in["w_down"],
        "gate_w": _w((lambda *s: torch.randn(*s, dtype=torch.bfloat16) * 0.05)(576) * 16.0),
    }

def reference(A_x, A_wqkv, A_wo, B_x, B_w_r, B_w_gate, B_w_up, B_w_down, gate_w):
    def _A_ref(x, wqkv, wo):
        B, S, D = x.shape
        H = 32
        Dh = D // H
        qkv = (lambda x, *d: x.permute(*d))((x @ wqkv).reshape(B, S, 3, H, Dh), 2, 0, 3, 1, 4)
        q, k, v = qkv[0], qkv[1], qkv[2]
        scores = torch.einsum("bhqd,bhkd->bhqk", q, k) * (Dh ** -0.5)
        p = _softmax(scores, axis=-1)
        o = torch.einsum("bhqk,bhkd->bhqd", p, v)
        return (lambda x, *d: x.permute(*d))(o, 0, 2, 1, 3).reshape(B, S, D) @ wo

    def _B_ref(x, w_r, w_gate, w_up, w_down):
        B, S, D = x.shape
        C = 2
        r = x @ w_r
        idx = torch.argsort(-r, axis=-1)[:, :C]
        idx_e = (lambda x, n, axis: torch.repeat_interleave(x, n, dim=axis))(idx.reshape(B, C, 1), D, axis=2)
        x_sel = (lambda x, i, axis: torch.take_along_dim(x, i, dim=axis))(x, idx_e, axis=1)
        g = _silu(x_sel @ w_gate)
        u = x_sel @ w_up
        y = (g * u) @ w_down
        r_sel = _sigmoid((lambda x, i, axis: torch.take_along_dim(x, i, dim=axis))(r, idx, axis=1))
        y = y * r_sel.reshape(B, C, 1)
        b_off = (torch.arange(B) * S).reshape(B, 1)
        flat_idx = (idx + b_off).reshape(B * C)
        zero = (x * 0.0).reshape(B * S, D)
        upd = _scatter_add(zero, flat_idx, y.reshape(B * C, D), axis=0)
        return x + upd.reshape(B, S, D)

    x = A_x
    g = _sigmoid((x * gate_w).sum(-1, keepdims=True))
    a = _A_ref(x, A_wqkv, A_wo)
    b = _B_ref(x, B_w_r, B_w_gate, B_w_up, B_w_down)
    return g * a + (1 - g) * b
```

```asm
; @launch grid=(256,1,1) block=(512,1,1) lds=163376
.amdgcn_target "amdgcn-amd-amdhsa--gfx950"
.text
.globl gated_mix__mha_block__moe_arch_mod__prompt_kernel
.p2align 8
.type gated_mix__mha_block__moe_arch_mod__prompt_kernel,@function
gated_mix__mha_block__moe_arch_mod__prompt_kernel:
    s_cmp_ge_u32 s2, 256
    s_cbranch_scc1 K2_end
    s_load_dwordx2 s[16:17], s[0:1], 0
    s_load_dwordx2 s[20:21], s[0:1], 8
    s_load_dwordx2 s[28:29], s[0:1], 8
    s_load_dwordx2 s[24:25], s[0:1], 88
    s_load_dwordx2 s[12:13], s[0:1], 80
    v_readfirstlane_b32 s38, v0
    v_and_b32 v239, 63, v0
    s_and_b32 s4, s2, 3
    s_bfe_u32 s5, s2, 0x20003
    s_bfe_u32 s6, s2, 0x10002
    s_lshr_b32 s7, s2, 5
    s_lshl2_add_u32 s68, s4, s5
    s_mul_i32 s97, s6, 6
    s_add_u32 s97, s97, s7
    s_lshl3_add_u32 s9, s6, s7
    s_cmp_eq_u32 s9, 6
    s_cselect_b32 s97, 13, s97
    s_cmp_ge_u32 s97, 9
    s_cselect_b32 s100, 2, 0
    s_lshr_b32 s9, s5, 1
    s_xor_b32 s9, s9, s6
    s_add_u32 s9, s9, 3
    s_cmp_eq_u32 s7, 7
    s_cselect_b32 s100, s9, s100
    s_mov_b32 s18, 2359296
    s_mov_b32 s19, 0x00020000
    s_bfe_u32 s40, s38, 0x20006
    s_lshr_b32 s39, s38, 8
    s_cbranch_scc0 K2_old
    s_setprio 2
    s_cmp_eq_u32 s100, 4
    s_cbranch_scc1 K2_noload
    v_lshrrev_b32 v2, 3, v239
    v_and_b32 v3, 7, v239
    v_lshrrev_b32 v4, 4, v239
    v_lshl_add_u32 v2, s40, 3, v2
    s_cmp_eq_u32 s100, 2
    s_cselect_b32 s9, 1, 2
    s_cselect_b32 s10, 1, 3
    s_lshl_b32 s9, s40, s9
    s_and_b32 s9, s9, 7
    v_and_b32 v5, s10, v4
    v_xor_b32 v5, v3, v5
    v_xor_b32 v5, s9, v5
    v_lshl_add_u32 v6, s68, 7, v2
    v_mul_u32_u24 v6, 1152, v6
    v_lshl_add_u32 v10, v5, 4, v6
    s_xor_b32 s71, s7, s5
    s_and_b32 s71, s71, 1
    s_lshl2_add_u32 s71, s71, s4
    s_lshl1_add_u32 s71, s6, s71
    s_cmp_eq_u32 s71, 9
    s_cselect_b32 s71, 0, s71
    s_cmp_eq_u32 s100, 3
    s_cselect_b32 s71, 0, s71
    s_cselect_b32 s22, 0, 1990656
    s_lshl_b32 s42, s40, 10
    s_waitcnt lgkmcnt(0)
    s_lshl_b32 s65, s71, 7
    s_mul_i32 s66, s71, 221184
    s_add_u32 m0, s42, 0
    s_add_u32 s67, s65, 0
    buffer_load_dwordx4 v10, s[16:19], s67 offen lds
    s_add_u32 m0, s42, 4096
    s_add_u32 s67, s65, 36864
    buffer_load_dwordx4 v10, s[16:19], s67 offen lds
    s_add_u32 m0, s42, 8192
    s_add_u32 s67, s65, 73728
    buffer_load_dwordx4 v10, s[16:19], s67 offen lds
    s_add_u32 m0, s42, 12288
    s_add_u32 s67, s65, 110592
    buffer_load_dwordx4 v10, s[16:19], s67 offen lds
    s_cmp_eq_u32 s97, 13
    s_cselect_b32 s30, 0, s22
    s_mov_b32 s23, 0x00020000
    s_mov_b32 s31, 0x00020000
    v_and_b32 v4, 1, v4
    s_and_b32 s9, s40, 1
    s_lshl_b32 s9, s9, 2
    v_lshl_add_u32 v4, v4, 1, s9
    v_xor_b32 v3, v3, v4
    v_mul_u32_u24 v6, 3456, v2
    v_lshl_add_u32 v6, v3, 4, v6
    v_lshl_add_u32 v11, s97, 8, v6
    s_add_u32 m0, s42, 16384
    s_add_u32 s67, s66, 0
    buffer_load_dwordx4 v11, s[20:23], s67 offen lds
    s_add_u32 m0, s42, 24576
    s_add_u32 s67, s66, 128
    buffer_load_dwordx4 v11, s[28:31], s67 offen lds
    s_add_u32 m0, s42, 20480
    s_add_u32 s67, s66, 110592
    buffer_load_dwordx4 v11, s[20:23], s67 offen lds
    s_add_u32 m0, s42, 28672
    s_add_u32 s67, s66, 110720
    buffer_load_dwordx4 v11, s[28:31], s67 offen lds
    s_add_u32 s71, s71, 1
    s_cmp_eq_u32 s71, 9
    s_cselect_b32 s71, 0, s71
    s_lshl_b32 s65, s71, 7
    s_mul_i32 s66, s71, 221184
    s_add_u32 m0, s42, 49152
    s_add_u32 s67, s66, 0
    buffer_load_dwordx4 v11, s[20:23], s67 offen lds
    s_add_u32 m0, s42, 32768
    s_add_u32 s67, s65, 0
    buffer_load_dwordx4 v10, s[16:19], s67 offen lds
    s_add_u32 m0, s42, 57344
    s_add_u32 s67, s66, 128
    buffer_load_dwordx4 v11, s[28:31], s67 offen lds
    s_add_u32 m0, s42, 36864
    s_add_u32 s67, s65, 36864
    buffer_load_dwordx4 v10, s[16:19], s67 offen lds
    s_add_u32 m0, s42, 53248
    s_add_u32 s67, s66, 110592
    buffer_load_dwordx4 v11, s[20:23], s67 offen lds
    s_add_u32 m0, s42, 40960
    s_add_u32 s67, s65, 73728
    buffer_load_dwordx4 v10, s[16:19], s67 offen lds
    s_add_u32 m0, s42, 61440
    s_add_u32 s67, s66, 110720
    buffer_load_dwordx4 v11, s[28:31], s67 offen lds
    s_add_u32 m0, s42, 45056
    s_add_u32 s67, s65, 110592
    buffer_load_dwordx4 v10, s[16:19], s67 offen lds
    s_add_u32 s71, s71, 1
    s_cmp_eq_u32 s71, 9
    s_cselect_b32 s71, 0, s71
    s_waitcnt vmcnt(8)
    s_barrier
    s_lshl_b32 s65, s71, 7
    s_mul_i32 s66, s71, 221184
    s_add_u32 m0, s42, 81920
    s_add_u32 s67, s66, 0
    buffer_load_dwordx4 v11, s[20:23], s67 offen lds
    s_add_u32 m0, s42, 65536
    s_add_u32 s67, s65, 0
    buffer_load_dwordx4 v10, s[16:19], s67 offen lds
    s_add_u32 m0, s42, 90112
    s_add_u32 s67, s66, 128
    buffer_load_dwordx4 v11, s[28:31], s67 offen lds
    s_add_u32 m0, s42, 69632
    s_add_u32 s67, s65, 36864
    buffer_load_dwordx4 v10, s[16:19], s67 offen lds
    s_add_u32 m0, s42, 86016
    s_add_u32 s67, s66, 110592
    buffer_load_dwordx4 v11, s[20:23], s67 offen lds
    s_add_u32 m0, s42, 73728
    s_add_u32 s67, s65, 73728
    buffer_load_dwordx4 v10, s[16:19], s67 offen lds
    s_add_u32 m0, s42, 94208
    s_add_u32 s67, s66, 110720
    buffer_load_dwordx4 v11, s[28:31], s67 offen lds
    s_add_u32 m0, s42, 77824
    s_add_u32 s67, s65, 110592
    buffer_load_dwordx4 v10, s[16:19], s67 offen lds
    s_add_u32 s71, s71, 1
    s_cmp_eq_u32 s71, 9
    s_cselect_b32 s71, 0, s71
    s_waitcnt vmcnt(8)
    s_barrier
    s_lshl_b32 s65, s71, 7
    s_mul_i32 s66, s71, 221184
    s_add_u32 m0, s42, 114688
    s_add_u32 s67, s66, 0
    buffer_load_dwordx4 v11, s[20:23], s67 offen lds
    s_add_u32 m0, s42, 98304
    s_add_u32 s67, s65, 0
    buffer_load_dwordx4 v10, s[16:19], s67 offen lds
    s_add_u32 m0, s42, 122880
    s_add_u32 s67, s66, 128
    buffer_load_dwordx4 v11, s[28:31], s67 offen lds
    s_add_u32 m0, s42, 102400
    s_add_u32 s67, s65, 36864
    buffer_load_dwordx4 v10, s[16:19], s67 offen lds
    s_add_u32 m0, s42, 118784
    s_add_u32 s67, s66, 110592
    buffer_load_dwordx4 v11, s[20:23], s67 offen lds
    s_add_u32 m0, s42, 106496
    s_add_u32 s67, s65, 73728
    buffer_load_dwordx4 v10, s[16:19], s67 offen lds
    s_add_u32 m0, s42, 126976
    s_add_u32 s67, s66, 110720
    buffer_load_dwordx4 v11, s[28:31], s67 offen lds
    s_add_u32 m0, s42, 110592
    s_add_u32 s67, s65, 110592
    buffer_load_dwordx4 v10, s[16:19], s67 offen lds
    s_add_u32 s71, s71, 1
    s_cmp_eq_u32 s71, 9
    s_cselect_b32 s71, 0, s71
    s_waitcnt vmcnt(8)
    s_barrier
    s_lshl_b32 s65, s71, 7
    s_mul_i32 s66, s71, 221184
    s_add_u32 m0, s42, 16384
    s_add_u32 s67, s66, 0
    buffer_load_dwordx4 v11, s[20:23], s67 offen lds
    s_add_u32 m0, s42, 0
    s_add_u32 s67, s65, 0
    buffer_load_dwordx4 v10, s[16:19], s67 offen lds
    s_add_u32 m0, s42, 24576
    s_add_u32 s67, s66, 128
    buffer_load_dwordx4 v11, s[28:31], s67 offen lds
    s_add_u32 m0, s42, 4096
    s_add_u32 s67, s65, 36864
    buffer_load_dwordx4 v10, s[16:19], s67 offen lds
    s_add_u32 m0, s42, 20480
    s_add_u32 s67, s66, 110592
    buffer_load_dwordx4 v11, s[20:23], s67 offen lds
    s_add_u32 m0, s42, 8192
    s_add_u32 s67, s65, 73728
    buffer_load_dwordx4 v10, s[16:19], s67 offen lds
    s_add_u32 m0, s42, 28672
    s_add_u32 s67, s66, 110720
    buffer_load_dwordx4 v11, s[28:31], s67 offen lds
    s_add_u32 m0, s42, 12288
    s_add_u32 s67, s65, 110592
    buffer_load_dwordx4 v10, s[16:19], s67 offen lds
    s_add_u32 s71, s71, 1
    s_cmp_eq_u32 s71, 9
    s_cselect_b32 s71, 0, s71
    s_waitcnt vmcnt(8)
    s_barrier
    s_lshl_b32 s65, s71, 7
    s_mul_i32 s66, s71, 221184
    s_add_u32 m0, s42, 49152
    s_add_u32 s67, s66, 0
    buffer_load_dwordx4 v11, s[20:23], s67 offen lds
    s_add_u32 m0, s42, 32768
    s_add_u32 s67, s65, 0
    buffer_load_dwordx4 v10, s[16:19], s67 offen lds
    s_add_u32 m0, s42, 57344
    s_add_u32 s67, s66, 128
    buffer_load_dwordx4 v11, s[28:31], s67 offen lds
    s_add_u32 m0, s42, 36864
    s_add_u32 s67, s65, 36864
    buffer_load_dwordx4 v10, s[16:19], s67 offen lds
    s_add_u32 m0, s42, 53248
    s_add_u32 s67, s66, 110592
    buffer_load_dwordx4 v11, s[20:23], s67 offen lds
    s_add_u32 m0, s42, 40960
    s_add_u32 s67, s65, 73728
    buffer_load_dwordx4 v10, s[16:19], s67 offen lds
    s_add_u32 m0, s42, 61440
    s_add_u32 s67, s66, 110720
    buffer_load_dwordx4 v11, s[28:31], s67 offen lds
    s_add_u32 m0, s42, 45056
    s_add_u32 s67, s65, 110592
    buffer_load_dwordx4 v10, s[16:19], s67 offen lds
    s_add_u32 s71, s71, 1
    s_cmp_eq_u32 s71, 9
    s_cselect_b32 s71, 0, s71
    s_waitcnt vmcnt(8)
    s_barrier
    s_lshl_b32 s65, s71, 7
    s_mul_i32 s66, s71, 221184
    s_add_u32 m0, s42, 81920
    s_add_u32 s67, s66, 0
    buffer_load_dwordx4 v11, s[20:23], s67 offen lds
    s_add_u32 m0, s42, 65536
    s_add_u32 s67, s65, 0
    buffer_load_dwordx4 v10, s[16:19], s67 offen lds
    s_add_u32 m0, s42, 90112
    s_add_u32 s67, s66, 128
    buffer_load_dwordx4 v11, s[28:31], s67 offen lds
    s_add_u32 m0, s42, 69632
    s_add_u32 s67, s65, 36864
    buffer_load_dwordx4 v10, s[16:19], s67 offen lds
    s_add_u32 m0, s42, 86016
    s_add_u32 s67, s66, 110592
    buffer_load_dwordx4 v11, s[20:23], s67 offen lds
    s_add_u32 m0, s42, 73728
    s_add_u32 s67, s65, 73728
    buffer_load_dwordx4 v10, s[16:19], s67 offen lds
    s_add_u32 m0, s42, 94208
    s_add_u32 s67, s66, 110720
    buffer_load_dwordx4 v11, s[28:31], s67 offen lds
    s_add_u32 m0, s42, 77824
    s_add_u32 s67, s65, 110592
    buffer_load_dwordx4 v10, s[16:19], s67 offen lds
    s_add_u32 s71, s71, 1
    s_cmp_eq_u32 s71, 9
    s_cselect_b32 s71, 0, s71
    s_waitcnt vmcnt(8)
    s_barrier
    s_lshl_b32 s65, s71, 7
    s_mul_i32 s66, s71, 221184
    s_add_u32 m0, s42, 114688
    s_add_u32 s67, s66, 0
    buffer_load_dwordx4 v11, s[20:23], s67 offen lds
    s_add_u32 m0, s42, 98304
    s_add_u32 s67, s65, 0
    buffer_load_dwordx4 v10, s[16:19], s67 offen lds
    s_add_u32 m0, s42, 122880
    s_add_u32 s67, s66, 128
    buffer_load_dwordx4 v11, s[28:31], s67 offen lds
    s_add_u32 m0, s42, 102400
    s_add_u32 s67, s65, 36864
    buffer_load_dwordx4 v10, s[16:19], s67 offen lds
    s_add_u32 m0, s42, 118784
    s_add_u32 s67, s66, 110592
    buffer_load_dwordx4 v11, s[20:23], s67 offen lds
    s_add_u32 m0, s42, 106496
    s_add_u32 s67, s65, 73728
    buffer_load_dwordx4 v10, s[16:19], s67 offen lds
    s_add_u32 m0, s42, 126976
    s_add_u32 s67, s66, 110720
    buffer_load_dwordx4 v11, s[28:31], s67 offen lds
    s_add_u32 m0, s42, 110592
    s_add_u32 s67, s65, 110592
    buffer_load_dwordx4 v10, s[16:19], s67 offen lds
    s_add_u32 s71, s71, 1
    s_cmp_eq_u32 s71, 9
    s_cselect_b32 s71, 0, s71
    s_waitcnt vmcnt(8)
    s_barrier
    s_lshl_b32 s65, s71, 7
    s_mul_i32 s66, s71, 221184
    s_add_u32 m0, s42, 16384
    s_add_u32 s67, s66, 0
    buffer_load_dwordx4 v11, s[20:23], s67 offen lds
    s_add_u32 m0, s42, 0
    s_add_u32 s67, s65, 0
    buffer_load_dwordx4 v10, s[16:19], s67 offen lds
    s_add_u32 m0, s42, 24576
    s_add_u32 s67, s66, 128
    buffer_load_dwordx4 v11, s[28:31], s67 offen lds
    s_add_u32 m0, s42, 4096
    s_add_u32 s67, s65, 36864
    buffer_load_dwordx4 v10, s[16:19], s67 offen lds
    s_add_u32 m0, s42, 20480
    s_add_u32 s67, s66, 110592
    buffer_load_dwordx4 v11, s[20:23], s67 offen lds
    s_add_u32 m0, s42, 8192
    s_add_u32 s67, s65, 73728
    buffer_load_dwordx4 v10, s[16:19], s67 offen lds
    s_add_u32 m0, s42, 28672
    s_add_u32 s67, s66, 110720
    buffer_load_dwordx4 v11, s[28:31], s67 offen lds
    s_add_u32 m0, s42, 12288
    s_add_u32 s67, s65, 110592
    buffer_load_dwordx4 v10, s[16:19], s67 offen lds
    s_add_u32 s71, s71, 1
    s_cmp_eq_u32 s71, 9
    s_cselect_b32 s71, 0, s71
    s_waitcnt vmcnt(8)
    s_barrier
    s_waitcnt vmcnt(0)
K2_lastbar:
    s_barrier
K2_loaded:
    s_lshr_b32 s38, s38, 6
    s_and_b32 s3, s2, 7
    s_lshl_b32 s69, s97, 1
    s_mov_b32 s26, 16777216
    s_mov_b32 s27, 0x00020000
    s_mov_b32 s14, 256
    s_mov_b32 s15, 0x00020000
    v_lshlrev_b32 v237, 4, v239
    s_waitcnt lgkmcnt(0)
    buffer_load_dword v246, off, s[12:15], 0 sc1
    s_lshl_b32 s4, s3, 1
    s_bfe_u32 s5, s2, 0x10003
    s_add_u32 s43, s4, s5
    s_lshr_b32 s37, s2, 4
    s_lshl_b32 s36, s43, 1
    s_add_u32 s36, s36, s39
    s_lshr_b32 s4, s36, 1
    s_mul_i32 s4, s4, 2304
    s_and_b32 s5, s36, 1
    s_mul_i32 s5, s5, 1280
    s_add_u32 s5, s5, s4
    s_add_u32 s4, s4, 1024
    v_and_b32 v4, 31, v239
    v_lshrrev_b32 v6, 5, v239
    v_lshrrev_b32 v5, 4, v4
    v_mul_u32_u24 v5, 110336, v5
    v_lshl_add_u32 v5, v4, 4, v5
    v_add_u32 v242, s4, v5
    v_add_u32 v240, s5, v5
    v_lshl_add_u32 v240, v6, 9, v240
    s_mul_i32 s4, s36, 288
    s_add_u32 s4, s4, 36864
    v_min_u32 v5, 17, v4
    v_lshl_add_u32 v238, v5, 4, s4
    v_mul_u32_u24 v5, 9216, v6
    v_add_u32 v238, v238, v5
    v_add_u32 v241, 18432, v238
    s_mul_i32 s10, s37, 442368
    s_xor_b32 s11, s40, 3
    s_mov_b32 s60, s10
    s_lshr_b32 s4, s11, 1
    s_mul_i32 s5, s4, 221184
    s_add_u32 s56, s10, s5
    s_xor_b32 s5, s4, 1
    s_mul_i32 s5, s5, 221184
    s_add_u32 s57, s10, s5
    v_xor_b32 v5, s4, v6
    s_mov_b32 s4, 221184
    v_mad_u32_u24 v251, v5, s4, v242
    v_mad_u32_u24 v242, v6, s4, v242
    s_mul_i32 s10, s40, 1769472
    s_add_u32 s44, s10, 36864
    s_add_u32 s45, s10, 147456
    s_add_u32 s46, s10, 258048
    s_add_u32 s47, s10, 368640
    s_add_u32 s48, s10, 479232
    s_add_u32 s49, s10, 589824
    s_add_u32 s50, s10, 700416
    s_add_u32 s51, s10, 811008
    s_add_u32 s72, s10, 921600
    s_add_u32 s73, s10, 1032192
    s_add_u32 s74, s10, 1142784
    s_add_u32 s75, s10, 1253376
    s_add_u32 s76, s10, 1363968
    s_add_u32 s77, s10, 1474560
    s_add_u32 s78, s10, 1585152
    s_add_u32 s79, s10, 1695744
    s_mov_b32 s62, 0x0011ffff
    s_mov_b32 s63, 0x0011ffff
    v_and_b32 v4, 31, v239
    v_or_b32 v5, 4, v4
    v_cmp_eq_u32 vcc, 21, v5
    v_mov_b32 v6, 0x3afe3f80
    v_mov_b32 v8, 0x3f803f80
    v_cndmask_b32 v6, 0, v6, vcc
    v_mov_b32 v7, 0
    v_mov_b32 v9, 0
    v_mov_b32 v10, 0
    v_mov_b32 v11, 0
    v_mfma_f32_32x32x4_2b_bf16 v[170:201], v[8:9], v[6:7], 0
    v_mfma_f32_32x32x4_2b_bf16 v[202:233], v[8:9], v[6:7], 0
    v_mfma_f32_32x32x4_2b_bf16 v[64:95], v[10:11], v[10:11], 0
    v_mfma_f32_32x32x4_2b_bf16 v[96:127], v[10:11], v[10:11], 0
    s_nop 3
    s_mov_b32 s5, 131072
K2_tag_1:
    s_waitcnt vmcnt(0)
    v_readfirstlane_b32 s53, v246
    s_cmp_lg_u32 s53, 0
    s_cbranch_scc1 K2_tag_1_d
    s_sleep 8
    buffer_load_dword v246, off, s[12:15], 0 sc1
    s_sub_u32 s5, s5, 1
    s_cbranch_scc0 K2_tag_1
K2_tag_1_d:
    s_branch K2_young2
K2_noload:
    s_lshl_b32 s4, s40, 8
    s_or_b32 s4, s4, s2
    s_cmp_lg_u32 s4, 228
    s_cbranch_scc1 K2_lastbar
    s_mov_b32 s26, 16777216
    s_mov_b32 s27, 0x00020000
    s_mov_b32 s14, 256
    s_mov_b32 s15, 0x00020000
    s_waitcnt lgkmcnt(0)
    s_mov_b32 s4, 10813440
    buffer_load_dword v14, off, s[24:27], s4 sc1
    s_mov_b32 s5, 1664525
    s_waitcnt vmcnt(0)
    v_mul_lo_u32 v14, v14, s5
    v_add_u32 v14, 1013904223, v14
    v_max_u32 v14, 1, v14
    s_mov_b64 exec, 1
    buffer_store_dword v14, off, s[12:15], 0 sc1
    buffer_store_dword v14, off, s[24:27], s4 sc1
    s_mov_b64 exec, -1
    s_branch K2_lastbar
K2_old:
    s_lshr_b32 s38, s38, 6
    s_and_b32 s3, s2, 7
    s_lshl_b32 s69, s97, 1
    s_mov_b32 s26, 16777216
    s_mov_b32 s27, 0x00020000
    s_mov_b32 s14, 256
    s_mov_b32 s15, 0x00020000
    v_lshlrev_b32 v237, 4, v239
    v_mov_b32 v255, 163328
    v_mov_b32 v254, 1
    v_mov_b32 v10, 0
    v_mov_b32 v11, 0
    v_mov_b32 v12, 0
    v_mov_b32 v13, 0
    s_getpc_b64 s[8:9]
K2_pc:
    s_sub_u32 s8, s8, K2_pc - gated_mix__mha_block__moe_arch_mod__prompt_kernel
    s_subb_u32 s9, s9, 0
    s_lshr_b32 s10, s2, 3
    s_lshl_b32 s10, s10, 2
    s_add_u32 s10, s10, s40
    v_min_u32 v2, 2, v239
    v_lshl_add_u32 v2, v2, 7, s10
    v_min_u32 v2, (K2_codeend - gated_mix__mha_block__moe_arch_mod__prompt_kernel) / 128, v2
    v_lshlrev_b32 v2, 7, v2
    v_mov_b32 v3, s9
    v_add_co_u32 v2, vcc, s8, v2
    s_nop 1
    v_addc_co_u32 v3, vcc, 0, v3, vcc
    global_load_dword v161, v[2:3], off
    s_waitcnt lgkmcnt(0)
    ds_write_b128 v255, v[10:13]
    ds_write_b128 v255, v[10:13] offset:16
    ds_write_b128 v255, v[10:13] offset:32
    s_load_dwordx2 s[4:5], s[0:1], 32
    s_load_dwordx2 s[6:7], s[0:1], 64
    s_load_dwordx2 s[20:21], s[0:1], 40
    s_mov_b32 s22, 5308416
    s_mov_b32 s23, 0x00020000
    s_load_dwordx2 s[32:33], s[0:1], 48
    s_mov_b32 s34, 5308416
    s_mov_b32 s35, 0x00020000
    s_load_dwordx2 s[28:29], s[0:1], 56
    s_mov_b32 s30, 5308416
    s_mov_b32 s31, 0x00020000
    s_mov_b32 s10, 1152
    s_mov_b32 s11, 0x00020000
    s_waitcnt lgkmcnt(0)
    s_cmp_lt_u32 s40, 2
    s_cselect_b32 s8, s4, s6
    s_cselect_b32 s9, s5, s7
    s_cmp_lg_u32 s100, 3
    s_cbranch_scc1 K2_norgv
    s_lshl_b32 s4, s40, 10
    s_add_u32 m0, s4, 131072
    s_and_b32 s4, s4, 1024
    buffer_load_dwordx4 v237, s[8:11], s4 offen lds
K2_norgv:
    v_lshrrev_b32 v1, 4, v239
    v_and_b32 v2, 15, v239
    v_and_b32 v3, 12, v2
    v_add_u32 v3, v3, v2
    s_cmp_eq_u32 s100, 2
    s_cselect_b64 vcc, -1, 0
    v_cndmask_b32 v3, v2, v3, vcc
    v_mul_u32_u24 v4, 9216, v1
    v_lshl_add_u32 v4, v2, 4, v4
    v_cndmask_b32 v250, v237, v4, vcc
    v_lshrrev_b32 v4, 1, v2
    v_xor_b32 v4, v4, v1
    s_and_b32 s4, s40, 1
    s_lshl_b32 s4, s4, 1
    s_cmp_eq_u32 s100, 3
    s_cselect_b32 s4, s40, s4
    s_lshl_b32 s5, s68, 2
    s_add_u32 s71, s5, s4
    s_lshl_b32 s4, s4, 12
    v_lshl_add_u32 v3, v3, 7, s4
    v_lshl_add_u32 v220, v4, 4, v3
    v_xor_b32 v221, 64, v220
    v_add_u32 v222, 65536, v220
    v_add_u32 v223, 65536, v221
    v_bfe_u32 v3, v239, 2, 2
    v_lshl_add_u32 v4, v1, 3, v3
    v_lshlrev_b32 v4, 7, v4
    v_bfe_u32 v3, v239, 3, 2
    v_lshl_add_u32 v4, v3, 5, v4
    v_and_b32 v3, 3, v239
    v_lshl_add_u32 v4, v3, 3, v4
    s_lshr_b32 s7, s40, 1
    s_lshl_b32 s4, s7, 13
    s_add_u32 s4, s4, 16384
    v_add_u32 v224, s4, v4
    v_xor_b32 v225, 32, v224
    v_xor_b32 v226, 64, v224
    v_xor_b32 v227, 96, v224
    v_add_u32 v228, 65536, v224
    v_add_u32 v229, 65536, v225
    v_add_u32 v230, 65536, v226
    v_add_u32 v231, 65536, v227
    s_add_u32 s69, s69, s7
    s_mul_i32 s4, s71, 110592
    s_lshl_b32 s5, s69, 12
    s_lshl_b32 s6, s69, 10
    s_add_u32 s6, s6, 55296
    s_cmp_eq_u32 s100, 2
    s_cselect_b32 s5, s6, s5
    s_add_u32 s65, s4, s5
    s_add_u32 s66, s65, 110592
    s_lshl_b32 s4, s68, 5
    s_add_u32 s61, s4, 10878976
    s_mul_i32 s4, s97, 116512
    s_add_u32 s5, s4, 109230
    s_lshr_b32 s4, s4, 16
    s_lshr_b32 s5, s5, 16
    s_min_u32 s5, s5, 23
    v_lshrrev_b32 v3, 3, v239
    v_add_u32 v3, s4, v3
    v_min_u32 v3, s5, v3
    v_mul_u32_u24 v4, 9, v3
    v_lshrrev_b32 v4, 4, v4
    v_sub_u32 v4, s97, v4
    v_lshl_add_u32 v3, v3, 1, v4
    v_and_b32 v4, 7, v239
    v_lshlrev_b32 v4, 2, v4
    v_lshl_add_u32 v162, v3, 9, v4
    s_mov_b32 s98, 1051597459
    s_mov_b32 s99, s98
    s_lshl_b32 s4, s3, 1
    s_bfe_u32 s5, s2, 0x10003
    s_add_u32 s43, s4, s5
    s_lshr_b32 s37, s2, 4
    s_lshl_b32 s36, s43, 1
    s_add_u32 s36, s36, s39
    s_lshr_b32 s4, s36, 1
    s_mul_i32 s4, s4, 2304
    s_and_b32 s5, s36, 1
    s_mul_i32 s5, s5, 1280
    s_add_u32 s5, s5, s4
    s_add_u32 s4, s4, 1024
    v_and_b32 v4, 31, v239
    v_lshrrev_b32 v6, 5, v239
    v_lshrrev_b32 v5, 4, v4
    v_mul_u32_u24 v5, 110336, v5
    v_lshl_add_u32 v5, v4, 4, v5
    v_add_u32 v242, s4, v5
    v_add_u32 v240, s5, v5
    v_lshl_add_u32 v240, v6, 9, v240
    s_mul_i32 s4, s36, 288
    s_add_u32 s4, s4, 36864
    v_min_u32 v5, 17, v4
    v_lshl_add_u32 v238, v5, 4, s4
    v_mul_u32_u24 v5, 9216, v6
    v_add_u32 v238, v238, v5
    v_add_u32 v241, 18432, v238
    s_mul_i32 s10, s37, 442368
    s_xor_b32 s11, s40, 3
    s_mov_b32 s60, s10
    s_lshr_b32 s4, s11, 1
    s_mul_i32 s5, s4, 221184
    s_add_u32 s56, s10, s5
    s_xor_b32 s5, s4, 1
    s_mul_i32 s5, s5, 221184
    s_add_u32 s57, s10, s5
    v_xor_b32 v5, s4, v6
    s_mov_b32 s4, 221184
    v_mad_u32_u24 v251, v5, s4, v242
    v_mad_u32_u24 v242, v6, s4, v242
    s_mul_i32 s10, s40, 1769472
    s_add_u32 s44, s10, 36864
    s_add_u32 s45, s10, 147456
    s_add_u32 s46, s10, 258048
    s_add_u32 s47, s10, 368640
    s_add_u32 s48, s10, 479232
    s_add_u32 s49, s10, 589824
    s_add_u32 s50, s10, 700416
    s_add_u32 s51, s10, 811008
    s_add_u32 s72, s10, 921600
    s_add_u32 s73, s10, 1032192
    s_add_u32 s74, s10, 1142784
    s_add_u32 s75, s10, 1253376
    s_add_u32 s76, s10, 1363968
    s_add_u32 s77, s10, 1474560
    s_add_u32 s78, s10, 1585152
    s_add_u32 s79, s10, 1695744
    s_mov_b32 s62, 0x0011ffff
    s_mov_b32 s63, 0x0011ffff
    s_mul_i32 s4, s43, 36
    v_bfe_u32 v5, v239, 4, 1
    v_mad_u32_u24 v5, v5, 35, s4
    v_lshrrev_b32 v7, 7, v5
    s_lshr_b32 s7, s43, 1
    s_mul_i32 s4, s7, 9
    s_lshr_b32 s4, s4, 4
    s_lshl_b32 s5, s7, 1
    s_sub_u32 s4, s5, s4
    v_add_u32 v7, s4, v7
    v_lshl_add_u32 v7, v7, 4, s37
    s_and_b32 s4, s37, 14
    s_add_u32 s4, s4, 766
    v_lshrrev_b32 v8, 4, v239
    v_cmp_lt_u32 vcc, 1, v8
    v_add_u32 v8, s4, v8
    s_mov_b32 s4, 10878976
    v_cndmask_b32 v7, v7, v8, vcc
    v_lshl_add_u32 v253, v7, 5, s4
    v_mul_u32_u24 v7, 576, v6
    v_add_u32 v5, 576, v5
    v_add_u32 v5, v5, v7
    v_lshrrev_b32 v5, 7, v5
    s_add_u32 s5, s7, 8
    v_lshl_add_u32 v7, v6, 3, s5
    v_mul_u32_u24 v8, 9, v7
    v_lshrrev_b32 v8, 4, v8
    v_sub_u32 v5, v5, v8
    v_lshl_add_u32 v5, v7, 1, v5
    v_and_b32 v7, 15, v239
    v_lshl_add_u32 v5, v5, 4, v7
    v_lshl_add_u32 v252, v5, 5, s4
    s_lshr_b32 s4, s2, 3
    s_mul_i32 s41, s3, 18
    s_add_u32 s41, s41, s4
    s_mul_i32 s42, s40, 14336
    s_mul_i32 s9, s40, 9216
    s_cmp_lt_u32 s4, 18
    s_cselect_b32 s30, s30, 0
    s_cselect_b32 s64, 1, 0
    s_mul_i32 s8, s41, 36864
    s_add_u32 s8, s8, s9
    s_add_u32 s9, s9, 57344
    s_mul_i32 s5, s3, 27
    s_add_u32 s5, s5, s4
    s_sub_u32 s5, s5, 5
    s_max_i32 s5, s5, 0
    s_mul_i32 s58, s5, 3641
    s_lshr_b32 s58, s58, 16
    s_mul_i32 s10, s58, 18
    s_sub_u32 s5, s5, s10
    s_lshl_b32 s5, s5, 2
    s_add_u32 s5, s5, s40
    s_mul_i32 s59, s5, 24
    s_add_u32 s59, s59, s58
    s_lshl_b32 s59, s59, 9
    s_add_u32 s59, s59, 11534336
    s_sub_u32 s10, s58, 6
    s_cselect_b32 s58, s58, s10
    s_cselect_b64 s[20:21], s[20:21], s[32:33]
    s_mul_i32 s54, s58, 884736
    s_lshl_b32 s5, s5, 7
    s_add_u32 s54, s54, s5
    s_mul_i32 s58, s58, 192
    v_lshrrev_b32 v8, 3, v239
    v_mul_u32_u24 v8, 9088, v8
    v_add_u32 v234, v8, v237
    s_cmp_lt_u32 s4, 5
    s_cselect_b32 s22, 0, s22
    s_cselect_b32 s59, 2147483392, s59
    s_setprio 3
    s_cmp_eq_u32 s100, 3
    s_cbranch_scc1 K2_rg
    s_cmp_eq_u32 s100, 4
    s_cbranch_scc1 K2_idle2
    s_cmp_ge_u32 s69, 27
    s_cbranch_scc1 K2_idle
    s_cmp_eq_u32 s100, 2
    s_cbranch_scc1 K2_pv
    s_barrier
    ds_read_b64_tr_b16 v[16:17], v224
    ds_read_b64_tr_b16 v[18:19], v224 offset:512
    ds_read_b128 v[0:3], v220
    ds_read_b64_tr_b16 v[20:21], v225
    ds_read_b64_tr_b16 v[22:23], v225 offset:512
    ds_read_b64_tr_b16 v[24:25], v226
    ds_read_b64_tr_b16 v[26:27], v226 offset:512
    ds_read_b64_tr_b16 v[28:29], v227
    ds_read_b64_tr_b16 v[30:31], v227 offset:512
    ds_read_b128 v[4:7], v220 offset:2048
    ds_read_b128 v[8:11], v220 offset:4096
    ds_read_b128 v[12:15], v220 offset:6144
    s_waitcnt lgkmcnt(9)
    v_mfma_f32_16x16x32_bf16 v[64:67], v[16:19], v[0:3], 0
    ds_read_b64_tr_b16 v[48:49], v224 offset:4096
    s_waitcnt lgkmcnt(8)
    v_mfma_f32_16x16x32_bf16 v[68:71], v[20:23], v[0:3], 0
    ds_read_b64_tr_b16 v[50:51], v224 offset:4608
    s_waitcnt lgkmcnt(7)
    v_mfma_f32_16x16x32_bf16 v[72:75], v[24:27], v[0:3], 0
    ds_read_b128 v[32:35], v221
    s_waitcnt lgkmcnt(6)
    v_mfma_f32_16x16x32_bf16 v[76:79], v[28:31], v[0:3], 0
    ds_read_b64_tr_b16 v[52:53], v225 offset:4096
    s_waitcnt lgkmcnt(6)
    v_mfma_f32_16x16x32_bf16 v[80:83], v[16:19], v[4:7], 0
    ds_read_b64_tr_b16 v[54:55], v225 offset:4608
    v_mfma_f32_16x16x32_bf16 v[84:87], v[20:23], v[4:7], 0
    ds_read_b64_tr_b16 v[56:57], v226 offset:4096
    v_mfma_f32_16x16x32_bf16 v[88:91], v[24:27], v[4:7], 0
    ds_read_b64_tr_b16 v[58:59], v226 offset:4608
    v_mfma_f32_16x16x32_bf16 v[92:95], v[28:31], v[4:7], 0
    ds_read_b64_tr_b16 v[60:61], v227 offset:4096
    s_waitcnt lgkmcnt(9)
    v_mfma_f32_16x16x32_bf16 v[96:99], v[16:19], v[8:11], 0
    ds_read_b64_tr_b16 v[62:63], v227 offset:4608
    v_mfma_f32_16x16x32_bf16 v[100:103], v[20:23], v[8:11], 0
    ds_read_b128 v[36:39], v221 offset:2048
    v_mfma_f32_16x16x32_bf16 v[104:107], v[24:27], v[8:11], 0
    ds_read_b128 v[40:43], v221 offset:4096
    v_mfma_f32_16x16x32_bf16 v[108:111], v[28:31], v[8:11], 0
    ds_read_b128 v[44:47], v221 offset:6144
    s_waitcnt lgkmcnt(12)
    v_mfma_f32_16x16x32_bf16 v[112:115], v[16:19], v[12:15], 0
    v_mfma_f32_16x16x32_bf16 v[116:119], v[20:23], v[12:15], 0
    v_mfma_f32_16x16x32_bf16 v[120:123], v[24:27], v[12:15], 0
    v_mfma_f32_16x16x32_bf16 v[124:127], v[28:31], v[12:15], 0
    s_waitcnt lgkmcnt(3)
    v_mfma_f32_16x16x32_bf16 v[64:67], v[48:51], v[32:35], v[64:67]
    s_waitcnt lgkmcnt(0)
    s_barrier
    ds_read_b64_tr_b16 v[16:17], v224 offset:32768
    v_mfma_f32_16x16x32_bf16 v[68:71], v[52:55], v[32:35], v[68:71]
    ds_read_b64_tr_b16 v[18:19], v224 offset:33280
    v_mfma_f32_16x16x32_bf16 v[72:75], v[56:59], v[32:35], v[72:75]
    ds_read_b128 v[0:3], v220 offset:32768
    v_mfma_f32_16x16x32_bf16 v[76:79], v[60:63], v[32:35], v[76:79]
    ds_read_b64_tr_b16 v[20:21], v225 offset:32768
    v_mfma_f32_16x16x32_bf16 v[80:83], v[48:51], v[36:39], v[80:83]
    ds_read_b64_tr_b16 v[22:23], v225 offset:33280
    v_mfma_f32_16x16x32_bf16 v[84:87], v[52:55], v[36:39], v[84:87]
    ds_read_b64_tr_b16 v[24:25], v226 offset:32768
    v_mfma_f32_16x16x32_bf16 v[88:91], v[56:59], v[36:39], v[88:91]
    ds_read_b64_tr_b16 v[26:27], v226 offset:33280
    v_mfma_f32_16x16x32_bf16 v[92:95], v[60:63], v[36:39], v[92:95]
    ds_read_b64_tr_b16 v[28:29], v227 offset:32768
    v_mfma_f32_16x16x32_bf16 v[96:99], v[48:51], v[40:43], v[96:99]
    ds_read_b64_tr_b16 v[30:31], v227 offset:33280
    v_mfma_f32_16x16x32_bf16 v[100:103], v[52:55], v[40:43], v[100:103]
    ds_read_b128 v[4:7], v220 offset:34816
    v_mfma_f32_16x16x32_bf16 v[104:107], v[56:59], v[40:43], v[104:107]
    ds_read_b128 v[8:11], v220 offset:36864
    v_mfma_f32_16x16x32_bf16 v[108:111], v[60:63], v[40:43], v[108:111]
    ds_read_b128 v[12:15], v220 offset:38912
    v_mfma_f32_16x16x32_bf16 v[112:115], v[48:51], v[44:47], v[112:115]
    v_mfma_f32_16x16x32_bf16 v[116:119], v[52:55], v[44:47], v[116:119]
    v_mfma_f32_16x16x32_bf16 v[120:123], v[56:59], v[44:47], v[120:123]
    v_mfma_f32_16x16x32_bf16 v[124:127], v[60:63], v[44:47], v[124:127]
    s_waitcnt lgkmcnt(3)
    v_mfma_f32_16x16x32_bf16 v[64:67], v[16:19], v[0:3], v[64:67]
    ds_read_b64_tr_b16 v[48:49], v224 offset:36864
    v_mfma_f32_16x16x32_bf16 v[68:71], v[20:23], v[0:3], v[68:71]
    ds_read_b64_tr_b16 v[50:51], v224 offset:37376
    v_mfma_f32_16x16x32_bf16 v[72:75], v[24:27], v[0:3], v[72:75]
    ds_read_b128 v[32:35], v221 offset:32768
    v_mfma_f32_16x16x32_bf16 v[76:79], v[28:31], v[0:3], v[76:79]
    ds_read_b64_tr_b16 v[52:53], v225 offset:36864
    s_waitcnt lgkmcnt(6)
    v_mfma_f32_16x16x32_bf16 v[80:83], v[16:19], v[4:7], v[80:83]
    ds_read_b64_tr_b16 v[54:55], v225 offset:37376
    v_mfma_f32_16x16x32_bf16 v[84:87], v[20:23], v[4:7], v[84:87]
    ds_read_b64_tr_b16 v[56:57], v226 offset:36864
    v_mfma_f32_16x16x32_bf16 v[88:91], v[24:27], v[4:7], v[88:91]
    ds_read_b64_tr_b16 v[58:59], v226 offset:37376
    v_mfma_f32_16x16x32_bf16 v[92:95], v[28:31], v[4:7], v[92:95]
    ds_read_b64_tr_b16 v[60:61], v227 offset:36864
    s_waitcnt lgkmcnt(9)
    v_mfma_f32_16x16x32_bf16 v[96:99], v[16:19], v[8:11], v[96:99]
    ds_read_b64_tr_b16 v[62:63], v227 offset:37376
    v_mfma_f32_16x16x32_bf16 v[100:103], v[20:23], v[8:11], v[100:103]
    ds_read_b128 v[36:39], v221 offset:34816
    v_mfma_f32_16x16x32_bf16 v[104:107], v[24:27], v[8:11], v[104:107]
    ds_read_b128 v[40:43], v221 offset:36864
    v_mfma_f32_16x16x32_bf16 v[108:111], v[28:31], v[8:11], v[108:111]
    ds_read_b128 v[44:47], v221 offset:38912
    s_waitcnt lgkmcnt(12)
    v_mfma_f32_16x16x32_bf16 v[112:115], v[16:19], v[12:15], v[112:115]
    v_mfma_f32_16x16x32_bf16 v[116:119], v[20:23], v[12:15], v[116:119]
    v_mfma_f32_16x16x32_bf16 v[120:123], v[24:27], v[12:15], v[120:123]
    v_mfma_f32_16x16x32_bf16 v[124:127], v[28:31], v[12:15], v[124:127]
    s_waitcnt lgkmcnt(3)
    v_mfma_f32_16x16x32_bf16 v[64:67], v[48:51], v[32:35], v[64:67]
    s_waitcnt lgkmcnt(0)
    s_barrier
    ds_read_b64_tr_b16 v[16:17], v228
    v_mfma_f32_16x16x32_bf16 v[68:71], v[52:55], v[32:35], v[68:71]
    ds_read_b64_tr_b16 v[18:19], v228 offset:512
    v_mfma_f32_16x16x32_bf16 v[72:75], v[56:59], v[32:35], v[72:75]
    ds_read_b128 v[0:3], v222
    v_mfma_f32_16x16x32_bf16 v[76:79], v[60:63], v[32:35], v[76:79]
    ds_read_b64_tr_b16 v[20:21], v229
    v_mfma_f32_16x16x32_bf16 v[80:83], v[48:51], v[36:39], v[80:83]
    ds_read_b64_tr_b16 v[22:23], v229 offset:512
    v_mfma_f32_16x16x32_bf16 v[84:87], v[52:55], v[36:39], v[84:87]
    ds_read_b64_tr_b16 v[24:25], v230
    v_mfma_f32_16x16x32_bf16 v[88:91], v[56:59], v[36:39], v[88:91]
    ds_read_b64_tr_b16 v[26:27], v230 offset:512
    v_mfma_f32_16x16x32_bf16 v[92:95], v[60:63], v[36:39], v[92:95]
    ds_read_b64_tr_b16 v[28:29], v231
    v_mfma_f32_16x16x32_bf16 v[96:99], v[48:51], v[40:43], v[96:99]
    ds_read_b64_tr_b16 v[30:31], v231 offset:512
    v_mfma_f32_16x16x32_bf16 v[100:103], v[52:55], v[40:43], v[100:103]
    ds_read_b128 v[4:7], v222 offset:2048
    v_mfma_f32_16x16x32_bf16 v[104:107], v[56:59], v[40:43], v[104:107]
    ds_read_b128 v[8:11], v222 offset:4096
    v_mfma_f32_16x16x32_bf16 v[108:111], v[60:63], v[40:43], v[108:111]
    ds_read_b128 v[12:15], v222 offset:6144
    v_mfma_f32_16x16x32_bf16 v[112:115], v[48:51], v[44:47], v[112:115]
    v_mfma_f32_16x16x32_bf16 v[116:119], v[52:55], v[44:47], v[116:119]
    v_mfma_f32_16x16x32_bf16 v[120:123], v[56:59], v[44:47], v[120:123]
    v_mfma_f32_16x16x32_bf16 v[124:127], v[60:63], v[44:47], v[124:127]
    s_waitcnt lgkmcnt(3)
    v_mfma_f32_16x16x32_bf16 v[64:67], v[16:19], v[0:3], v[64:67]
    ds_read_b64_tr_b16 v[48:49], v228 offset:4096
    v_mfma_f32_16x16x32_bf16 v[68:71], v[20:23], v[0:3], v[68:71]
    ds_read_b64_tr_b16 v[50:51], v228 offset:4608
    v_mfma_f32_16x16x32_bf16 v[72:75], v[24:27], v[0:3], v[72:75]
    ds_read_b128 v[32:35], v223
    v_mfma_f32_16x16x32_bf16 v[76:79], v[28:31], v[0:3], v[76:79]
    ds_read_b64_tr_b16 v[52:53], v229 offset:4096
    s_waitcnt lgkmcnt(6)
    v_mfma_f32_16x16x32_bf16 v[80:83], v[16:19], v[4:7], v[80:83]
    ds_read_b64_tr_b16 v[54:55], v229 offset:4608
    v_mfma_f32_16x16x32_bf16 v[84:87], v[20:23], v[4:7], v[84:87]
    ds_read_b64_tr_b16 v[56:57], v230 offset:4096
    v_mfma_f32_16x16x32_bf16 v[88:91], v[24:27], v[4:7], v[88:91]
    ds_read_b64_tr_b16 v[58:59], v230 offset:4608
    v_mfma_f32_16x16x32_bf16 v[92:95], v[28:31], v[4:7], v[92:95]
    ds_read_b64_tr_b16 v[60:61], v231 offset:4096
    s_waitcnt lgkmcnt(9)
    v_mfma_f32_16x16x32_bf16 v[96:99], v[16:19], v[8:11], v[96:99]
    ds_read_b64_tr_b16 v[62:63], v231 offset:4608
    v_mfma_f32_16x16x32_bf16 v[100:103], v[20:23], v[8:11], v[100:103]
    ds_read_b128 v[36:39], v223 offset:2048
    v_mfma_f32_16x16x32_bf16 v[104:107], v[24:27], v[8:11], v[104:107]
    ds_read_b128 v[40:43], v223 offset:4096
    v_mfma_f32_16x16x32_bf16 v[108:111], v[28:31], v[8:11], v[108:111]
    ds_read_b128 v[44:47], v223 offset:6144
    s_waitcnt lgkmcnt(12)
    v_mfma_f32_16x16x32_bf16 v[112:115], v[16:19], v[12:15], v[112:115]
    v_mfma_f32_16x16x32_bf16 v[116:119], v[20:23], v[12:15], v[116:119]
    v_mfma_f32_16x16x32_bf16 v[120:123], v[24:27], v[12:15], v[120:123]
    v_mfma_f32_16x16x32_bf16 v[124:127], v[28:31], v[12:15], v[124:127]
    s_waitcnt lgkmcnt(3)
    v_mfma_f32_16x16x32_bf16 v[64:67], v[48:51], v[32:35], v[64:67]
    s_waitcnt lgkmcnt(0)
    s_barrier
    ds_read_b64_tr_b16 v[16:17], v228 offset:32768
    v_mfma_f32_16x16x32_bf16 v[68:71], v[52:55], v[32:35], v[68:71]
    ds_read_b64_tr_b16 v[18:19], v228 offset:33280
    v_mfma_f32_16x16x32_bf16 v[72:75], v[56:59], v[32:35], v[72:75]
    ds_read_b128 v[0:3], v222 offset:32768
    v_mfma_f32_16x16x32_bf16 v[76:79], v[60:63], v[32:35], v[76:79]
    ds_read_b64_tr_b16 v[20:21], v229 offset:32768
    v_mfma_f32_16x16x32_bf16 v[80:83], v[48:51], v[36:39], v[80:83]
    ds_read_b64_tr_b16 v[22:23], v229 offset:33280
    v_mfma_f32_16x16x32_bf16 v[84:87], v[52:55], v[36:39], v[84:87]
    ds_read_b64_tr_b16 v[24:25], v230 offset:32768
    v_mfma_f32_16x16x32_bf16 v[88:91], v[56:59], v[36:39], v[88:91]
    ds_read_b64_tr_b16 v[26:27], v230 offset:33280
    v_mfma_f32_16x16x32_bf16 v[92:95], v[60:63], v[36:39], v[92:95]
    ds_read_b64_tr_b16 v[28:29], v231 offset:32768
    v_mfma_f32_16x16x32_bf16 v[96:99], v[48:51], v[40:43], v[96:99]
    ds_read_b64_tr_b16 v[30:31], v231 offset:33280
    v_mfma_f32_16x16x32_bf16 v[100:103], v[52:55], v[40:43], v[100:103]
    ds_read_b128 v[4:7], v222 offset:34816
    v_mfma_f32_16x16x32_bf16 v[104:107], v[56:59], v[40:43], v[104:107]
    ds_read_b128 v[8:11], v222 offset:36864
    v_mfma_f32_16x16x32_bf16 v[108:111], v[60:63], v[40:43], v[108:111]
    ds_read_b128 v[12:15], v222 offset:38912
    v_mfma_f32_16x16x32_bf16 v[112:115], v[48:51], v[44:47], v[112:115]
    v_mfma_f32_16x16x32_bf16 v[116:119], v[52:55], v[44:47], v[116:119]
    v_mfma_f32_16x16x32_bf16 v[120:123], v[56:59], v[44:47], v[120:123]
    v_mfma_f32_16x16x32_bf16 v[124:127], v[60:63], v[44:47], v[124:127]
    s_waitcnt lgkmcnt(3)
    v_mfma_f32_16x16x32_bf16 v[64:67], v[16:19], v[0:3], v[64:67]
    ds_read_b64_tr_b16 v[48:49], v228 offset:36864
    v_mfma_f32_16x16x32_bf16 v[68:71], v[20:23], v[0:3], v[68:71]
    ds_read_b64_tr_b16 v[50:51], v228 offset:37376
    v_mfma_f32_16x16x32_bf16 v[72:75], v[24:27], v[0:3], v[72:75]
    ds_read_b128 v[32:35], v223 offset:32768
    v_mfma_f32_16x16x32_bf16 v[76:79], v[28:31], v[0:3], v[76:79]
    ds_read_b64_tr_b16 v[52:53], v229 offset:36864
    s_waitcnt lgkmcnt(6)
    v_mfma_f32_16x16x32_bf16 v[80:83], v[16:19], v[4:7], v[80:83]
    ds_read_b64_tr_b16 v[54:55], v229 offset:37376
    v_mfma_f32_16x16x32_bf16 v[84:87], v[20:23], v[4:7], v[84:87]
    ds_read_b64_tr_b16 v[56:57], v230 offset:36864
    v_mfma_f32_16x16x32_bf16 v[88:91], v[24:27], v[4:7], v[88:91]
    ds_read_b64_tr_b16 v[58:59], v230 offset:37376
    v_mfma_f32_16x16x32_bf16 v[92:95], v[28:31], v[4:7], v[92:95]
    ds_read_b64_tr_b16 v[60:61], v231 offset:36864
    s_waitcnt lgkmcnt(9)
    v_mfma_f32_16x16x32_bf16 v[96:99], v[16:19], v[8:11], v[96:99]
    ds_read_b64_tr_b16 v[62:63], v231 offset:37376
    v_mfma_f32_16x16x32_bf16 v[100:103], v[20:23], v[8:11], v[100:103]
    ds_read_b128 v[36:39], v223 offset:34816
    v_mfma_f32_16x16x32_bf16 v[104:107], v[24:27], v[8:11], v[104:107]
    ds_read_b128 v[40:43], v223 offset:36864
    v_mfma_f32_16x16x32_bf16 v[108:111], v[28:31], v[8:11], v[108:111]
    ds_read_b128 v[44:47], v223 offset:38912
    s_waitcnt lgkmcnt(12)
    v_mfma_f32_16x16x32_bf16 v[112:115], v[16:19], v[12:15], v[112:115]
    v_mfma_f32_16x16x32_bf16 v[116:119], v[20:23], v[12:15], v[116:119]
    v_mfma_f32_16x16x32_bf16 v[120:123], v[24:27], v[12:15], v[120:123]
    v_mfma_f32_16x16x32_bf16 v[124:127], v[28:31], v[12:15], v[124:127]
    s_waitcnt lgkmcnt(3)
    v_mfma_f32_16x16x32_bf16 v[64:67], v[48:51], v[32:35], v[64:67]
    s_waitcnt lgkmcnt(0)
    s_barrier
    ds_read_b64_tr_b16 v[16:17], v224
    v_mfma_f32_16x16x32_bf16 v[68:71], v[52:55], v[32:35], v[68:71]
    ds_read_b64_tr_b16 v[18:19], v224 offset:512
    v_mfma_f32_16x16x32_bf16 v[72:75], v[56:59], v[32:35], v[72:75]
    ds_read_b128 v[0:3], v220
    v_mfma_f32_16x16x32_bf16 v[76:79], v[60:63], v[32:35], v[76:79]
    ds_read_b64_tr_b16 v[20:21], v225
    v_mfma_f32_16x16x32_bf16 v[80:83], v[48:51], v[36:39], v[80:83]
    ds_read_b64_tr_b16 v[22:23], v225 offset:512
    v_mfma_f32_16x16x32_bf16 v[84:87], v[52:55], v[36:39], v[84:87]
    ds_read_b64_tr_b16 v[24:25], v226
    v_mfma_f32_16x16x32_bf16 v[88:91], v[56:59], v[36:39], v[88:91]
    ds_read_b64_tr_b16 v[26:27], v226 offset:512
    v_mfma_f32_16x16x32_bf16 v[92:95], v[60:63], v[36:39], v[92:95]
    ds_read_b64_tr_b16 v[28:29], v227
    v_mfma_f32_16x16x32_bf16 v[96:99], v[48:51], v[40:43], v[96:99]
    ds_read_b64_tr_b16 v[30:31], v227 offset:512
    v_mfma_f32_16x16x32_bf16 v[100:103], v[52:55], v[40:43], v[100:103]
    ds_read_b128 v[4:7], v220 offset:2048
    v_mfma_f32_16x16x32_bf16 v[104:107], v[56:59], v[40:43], v[104:107]
    ds_read_b128 v[8:11], v220 offset:4096
    v_mfma_f32_16x16x32_bf16 v[108:111], v[60:63], v[40:43], v[108:111]
    ds_read_b128 v[12:15], v220 offset:6144
    v_mfma_f32_16x16x32_bf16 v[112:115], v[48:51], v[44:47], v[112:115]
    v_mfma_f32_16x16x32_bf16 v[116:119], v[52:55], v[44:47], v[116:119]
    v_mfma_f32_16x16x32_bf16 v[120:123], v[56:59], v[44:47], v[120:123]
    v_mfma_f32_16x16x32_bf16 v[124:127], v[60:63], v[44:47], v[124:127]
    s_waitcnt lgkmcnt(3)
    v_mfma_f32_16x16x32_bf16 v[64:67], v[16:19], v[0:3], v[64:67]
    buffer_load_dword v246, off, s[12:15], 0 sc1
    ds_read_b64_tr_b16 v[48:49], v224 offset:4096
    v_mfma_f32_16x16x32_bf16 v[68:71], v[20:23], v[0:3], v[68:71]
    ds_read_b64_tr_b16 v[50:51], v224 offset:4608
    v_mfma_f32_16x16x32_bf16 v[72:75], v[24:27], v[0:3], v[72:75]
    ds_read_b128 v[32:35], v221
    v_mfma_f32_16x16x32_bf16 v[76:79], v[28:31], v[0:3], v[76:79]
    ds_read_b64_tr_b16 v[52:53], v225 offset:4096
    s_waitcnt lgkmcnt(6)
    v_mfma_f32_16x16x32_bf16 v[80:83], v[16:19], v[4:7], v[80:83]
    ds_read_b64_tr_b16 v[54:55], v225 offset:4608
    v_mfma_f32_16x16x32_bf16 v[84:87], v[20:23], v[4:7], v[84:87]
    ds_read_b64_tr_b16 v[56:57], v226 offset:4096
    v_mfma_f32_16x16x32_bf16 v[88:91], v[24:27], v[4:7], v[88:91]
    ds_read_b64_tr_b16 v[58:59], v226 offset:4608
    v_mfma_f32_16x16x32_bf16 v[92:95], v[28:31], v[4:7], v[92:95]
    ds_read_b64_tr_b16 v[60:61], v227 offset:4096
    s_waitcnt lgkmcnt(9)
    v_mfma_f32_16x16x32_bf16 v[96:99], v[16:19], v[8:11], v[96:99]
    ds_read_b64_tr_b16 v[62:63], v227 offset:4608
    v_mfma_f32_16x16x32_bf16 v[100:103], v[20:23], v[8:11], v[100:103]
    ds_read_b128 v[36:39], v221 offset:2048
    v_mfma_f32_16x16x32_bf16 v[104:107], v[24:27], v[8:11], v[104:107]
    ds_read_b128 v[40:43], v221 offset:4096
    v_mfma_f32_16x16x32_bf16 v[108:111], v[28:31], v[8:11], v[108:111]
    ds_read_b128 v[44:47], v221 offset:6144
    s_waitcnt lgkmcnt(12)
    v_mfma_f32_16x16x32_bf16 v[112:115], v[16:19], v[12:15], v[112:115]
    v_mfma_f32_16x16x32_bf16 v[116:119], v[20:23], v[12:15], v[116:119]
    v_mfma_f32_16x16x32_bf16 v[120:123], v[24:27], v[12:15], v[120:123]
    v_mfma_f32_16x16x32_bf16 v[124:127], v[28:31], v[12:15], v[124:127]
    s_waitcnt lgkmcnt(3)
    v_mfma_f32_16x16x32_bf16 v[64:67], v[48:51], v[32:35], v[64:67]
    s_waitcnt lgkmcnt(0)
    s_barrier
    ds_read_b64_tr_b16 v[16:17], v224 offset:32768
    v_mfma_f32_16x16x32_bf16 v[68:71], v[52:55], v[32:35], v[68:71]
    ds_read_b64_tr_b16 v[18:19], v224 offset:33280
    v_mfma_f32_16x16x32_bf16 v[72:75], v[56:59], v[32:35], v[72:75]
    ds_read_b128 v[0:3], v220 offset:32768
    v_mfma_f32_16x16x32_bf16 v[76:79], v[60:63], v[32:35], v[76:79]
    ds_read_b64_tr_b16 v[20:21], v225 offset:32768
    v_mfma_f32_16x16x32_bf16 v[80:83], v[48:51], v[36:39], v[80:83]
    ds_read_b64_tr_b16 v[22:23], v225 offset:33280
    v_mfma_f32_16x16x32_bf16 v[84:87], v[52:55], v[36:39], v[84:87]
    ds_read_b64_tr_b16 v[24:25], v226 offset:32768
    v_mfma_f32_16x16x32_bf16 v[88:91], v[56:59], v[36:39], v[88:91]
    ds_read_b64_tr_b16 v[26:27], v226 offset:33280
    v_mfma_f32_16x16x32_bf16 v[92:95], v[60:63], v[36:39], v[92:95]
    ds_read_b64_tr_b16 v[28:29], v227 offset:32768
    v_mfma_f32_16x16x32_bf16 v[96:99], v[48:51], v[40:43], v[96:99]
    ds_read_b64_tr_b16 v[30:31], v227 offset:33280
    v_mfma_f32_16x16x32_bf16 v[100:103], v[52:55], v[40:43], v[100:103]
    ds_read_b128 v[4:7], v220 offset:34816
    v_mfma_f32_16x16x32_bf16 v[104:107], v[56:59], v[40:43], v[104:107]
    ds_read_b128 v[8:11], v220 offset:36864
    v_mfma_f32_16x16x32_bf16 v[108:111], v[60:63], v[40:43], v[108:111]
    ds_read_b128 v[12:15], v220 offset:38912
    v_mfma_f32_16x16x32_bf16 v[112:115], v[48:51], v[44:47], v[112:115]
    v_mfma_f32_16x16x32_bf16 v[116:119], v[52:55], v[44:47], v[116:119]
    v_mfma_f32_16x16x32_bf16 v[120:123], v[56:59], v[44:47], v[120:123]
    v_mfma_f32_16x16x32_bf16 v[124:127], v[60:63], v[44:47], v[124:127]
    s_waitcnt lgkmcnt(3)
    v_mfma_f32_16x16x32_bf16 v[64:67], v[16:19], v[0:3], v[64:67]
    ds_read_b64_tr_b16 v[48:49], v224 offset:36864
    v_mfma_f32_16x16x32_bf16 v[68:71], v[20:23], v[0:3], v[68:71]
    ds_read_b64_tr_b16 v[50:51], v224 offset:37376
    v_mfma_f32_16x16x32_bf16 v[72:75], v[24:27], v[0:3], v[72:75]
    ds_read_b128 v[32:35], v221 offset:32768
    v_mfma_f32_16x16x32_bf16 v[76:79], v[28:31], v[0:3], v[76:79]
    ds_read_b64_tr_b16 v[52:53], v225 offset:36864
    s_waitcnt lgkmcnt(6)
    v_mfma_f32_16x16x32_bf16 v[80:83], v[16:19], v[4:7], v[80:83]
    ds_read_b64_tr_b16 v[54:55], v225 offset:37376
    v_mfma_f32_16x16x32_bf16 v[84:87], v[20:23], v[4:7], v[84:87]
    ds_read_b64_tr_b16 v[56:57], v226 offset:36864
    v_mfma_f32_16x16x32_bf16 v[88:91], v[24:27], v[4:7], v[88:91]
    ds_read_b64_tr_b16 v[58:59], v226 offset:37376
    v_mfma_f32_16x16x32_bf16 v[92:95], v[28:31], v[4:7], v[92:95]
    ds_read_b64_tr_b16 v[60:61], v227 offset:36864
    s_waitcnt lgkmcnt(9)
    v_mfma_f32_16x16x32_bf16 v[96:99], v[16:19], v[8:11], v[96:99]
    ds_read_b64_tr_b16 v[62:63], v227 offset:37376
    v_mfma_f32_16x16x32_bf16 v[100:103], v[20:23], v[8:11], v[100:103]
    ds_read_b128 v[36:39], v221 offset:34816
    v_mfma_f32_16x16x32_bf16 v[104:107], v[24:27], v[8:11], v[104:107]
    ds_read_b128 v[40:43], v221 offset:36864
    v_mfma_f32_16x16x32_bf16 v[108:111], v[28:31], v[8:11], v[108:111]
    ds_read_b128 v[44:47], v221 offset:38912
    s_waitcnt lgkmcnt(12)
    v_mfma_f32_16x16x32_bf16 v[112:115], v[16:19], v[12:15], v[112:115]
    v_mfma_f32_16x16x32_bf16 v[116:119], v[20:23], v[12:15], v[116:119]
    v_mfma_f32_16x16x32_bf16 v[120:123], v[24:27], v[12:15], v[120:123]
    v_mfma_f32_16x16x32_bf16 v[124:127], v[28:31], v[12:15], v[124:127]
    s_waitcnt lgkmcnt(3)
    v_mfma_f32_16x16x32_bf16 v[64:67], v[48:51], v[32:35], v[64:67]
    s_waitcnt lgkmcnt(0)
    s_barrier
    ds_read_b64_tr_b16 v[16:17], v228
    v_mfma_f32_16x16x32_bf16 v[68:71], v[52:55], v[32:35], v[68:71]
    ds_read_b64_tr_b16 v[18:19], v228 offset:512
    v_mfma_f32_16x16x32_bf16 v[72:75], v[56:59], v[32:35], v[72:75]
    ds_read_b128 v[0:3], v222
    v_mfma_f32_16x16x32_bf16 v[76:79], v[60:63], v[32:35], v[76:79]
    ds_read_b64_tr_b16 v[20:21], v229
    v_mfma_f32_16x16x32_bf16 v[80:83], v[48:51], v[36:39], v[80:83]
    ds_read_b64_tr_b16 v[22:23], v229 offset:512
    v_mfma_f32_16x16x32_bf16 v[84:87], v[52:55], v[36:39], v[84:87]
    ds_read_b64_tr_b16 v[24:25], v230
    v_mfma_f32_16x16x32_bf16 v[88:91], v[56:59], v[36:39], v[88:91]
    ds_read_b64_tr_b16 v[26:27], v230 offset:512
    v_mfma_f32_16x16x32_bf16 v[92:95], v[60:63], v[36:39], v[92:95]
    ds_read_b64_tr_b16 v[28:29], v231
    v_mfma_f32_16x16x32_bf16 v[96:99], v[48:51], v[40:43], v[96:99]
    ds_read_b64_tr_b16 v[30:31], v231 offset:512
    v_mfma_f32_16x16x32_bf16 v[100:103], v[52:55], v[40:43], v[100:103]
    ds_read_b128 v[4:7], v222 offset:2048
    v_mfma_f32_16x16x32_bf16 v[104:107], v[56:59], v[40:43], v[104:107]
    ds_read_b128 v[8:11], v222 offset:4096
    v_mfma_f32_16x16x32_bf16 v[108:111], v[60:63], v[40:43], v[108:111]
    ds_read_b128 v[12:15], v222 offset:6144
    v_mfma_f32_16x16x32_bf16 v[112:115], v[48:51], v[44:47], v[112:115]
    v_mfma_f32_16x16x32_bf16 v[116:119], v[52:55], v[44:47], v[116:119]
    v_mfma_f32_16x16x32_bf16 v[120:123], v[56:59], v[44:47], v[120:123]
    v_mfma_f32_16x16x32_bf16 v[124:127], v[60:63], v[44:47], v[124:127]
    s_waitcnt lgkmcnt(3)
    v_mfma_f32_16x16x32_bf16 v[64:67], v[16:19], v[0:3], v[64:67]
    ds_read_b64_tr_b16 v[48:49], v228 offset:4096
    v_mfma_f32_16x16x32_bf16 v[68:71], v[20:23], v[0:3], v[68:71]
    ds_read_b64_tr_b16 v[50:51], v228 offset:4608
    v_mfma_f32_16x16x32_bf16 v[72:75], v[24:27], v[0:3], v[72:75]
    ds_read_b128 v[32:35], v223
    v_mfma_f32_16x16x32_bf16 v[76:79], v[28:31], v[0:3], v[76:79]
    ds_read_b64_tr_b16 v[52:53], v229 offset:4096
    s_waitcnt lgkmcnt(6)
    v_mfma_f32_16x16x32_bf16 v[80:83], v[16:19], v[4:7], v[80:83]
    ds_read_b64_tr_b16 v[54:55], v229 offset:4608
    v_mfma_f32_16x16x32_bf16 v[84:87], v[20:23], v[4:7], v[84:87]
    ds_read_b64_tr_b16 v[56:57], v230 offset:4096
    v_mfma_f32_16x16x32_bf16 v[88:91], v[24:27], v[4:7], v[88:91]
    ds_read_b64_tr_b16 v[58:59], v230 offset:4608
    v_mfma_f32_16x16x32_bf16 v[92:95], v[28:31], v[4:7], v[92:95]
    ds_read_b64_tr_b16 v[60:61], v231 offset:4096
    s_waitcnt lgkmcnt(9)
    v_mfma_f32_16x16x32_bf16 v[96:99], v[16:19], v[8:11], v[96:99]
    ds_read_b64_tr_b16 v[62:63], v231 offset:4608
    v_mfma_f32_16x16x32_bf16 v[100:103], v[20:23], v[8:11], v[100:103]
    ds_read_b128 v[36:39], v223 offset:2048
    v_mfma_f32_16x16x32_bf16 v[104:107], v[24:27], v[8:11], v[104:107]
    ds_read_b128 v[40:43], v223 offset:4096
    v_mfma_f32_16x16x32_bf16 v[108:111], v[28:31], v[8:11], v[108:111]
    ds_read_b128 v[44:47], v223 offset:6144
    s_waitcnt lgkmcnt(12)
    v_mfma_f32_16x16x32_bf16 v[112:115], v[16:19], v[12:15], v[112:115]
    v_mfma_f32_16x16x32_bf16 v[116:119], v[20:23], v[12:15], v[116:119]
    v_mfma_f32_16x16x32_bf16 v[120:123], v[24:27], v[12:15], v[120:123]
    v_mfma_f32_16x16x32_bf16 v[124:127], v[28:31], v[12:15], v[124:127]
    s_waitcnt lgkmcnt(3)
    v_mfma_f32_16x16x32_bf16 v[64:67], v[48:51], v[32:35], v[64:67]
    s_waitcnt lgkmcnt(0)
    s_barrier
    s_mov_b32 s5, 131072
K2_tag_2:
    s_waitcnt vmcnt(0)
    v_readfirstlane_b32 s53, v246
    s_cmp_lg_u32 s53, 0
    s_cbranch_scc1 K2_tag_2_d
    s_sleep 8
    buffer_load_dword v246, off, s[12:15], 0 sc1
    s_sub_u32 s5, s5, 1
    s_cbranch_scc0 K2_tag_2
K2_tag_2_d:
    ds_read_b64_tr_b16 v[16:17], v228 offset:32768
    v_mfma_f32_16x16x32_bf16 v[68:71], v[52:55], v[32:35], v[68:71]
    ds_read_b64_tr_b16 v[18:19], v228 offset:33280
    v_mfma_f32_16x16x32_bf16 v[72:75], v[56:59], v[32:35], v[72:75]
    ds_read_b128 v[0:3], v222 offset:32768
    v_mfma_f32_16x16x32_bf16 v[76:79], v[60:63], v[32:35], v[76:79]
    ds_read_b64_tr_b16 v[20:21], v229 offset:32768
    v_mfma_f32_16x16x32_bf16 v[80:83], v[48:51], v[36:39], v[80:83]
    ds_read_b64_tr_b16 v[22:23], v229 offset:33280
    v_mfma_f32_16x16x32_bf16 v[84:87], v[52:55], v[36:39], v[84:87]
    ds_read_b64_tr_b16 v[24:25], v230 offset:32768
    v_mfma_f32_16x16x32_bf16 v[88:91], v[56:59], v[36:39], v[88:91]
    ds_read_b64_tr_b16 v[26:27], v230 offset:33280
    v_mfma_f32_16x16x32_bf16 v[92:95], v[60:63], v[36:39], v[92:95]
    ds_read_b64_tr_b16 v[28:29], v231 offset:32768
    v_mfma_f32_16x16x32_bf16 v[96:99], v[48:51], v[40:43], v[96:99]
    ds_read_b64_tr_b16 v[30:31], v231 offset:33280
    v_mfma_f32_16x16x32_bf16 v[100:103], v[52:55], v[40:43], v[100:103]
    ds_read_b128 v[4:7], v222 offset:34816
    v_mfma_f32_16x16x32_bf16 v[104:107], v[56:59], v[40:43], v[104:107]
    ds_read_b128 v[8:11], v222 offset:36864
    v_mfma_f32_16x16x32_bf16 v[108:111], v[60:63], v[40:43], v[108:111]
    ds_read_b128 v[12:15], v222 offset:38912
    v_mfma_f32_16x16x32_bf16 v[112:115], v[48:51], v[44:47], v[112:115]
    v_mfma_f32_16x16x32_bf16 v[116:119], v[52:55], v[44:47], v[116:119]
    v_mfma_f32_16x16x32_bf16 v[120:123], v[56:59], v[44:47], v[120:123]
    v_mfma_f32_16x16x32_bf16 v[124:127], v[60:63], v[44:47], v[124:127]
    s_waitcnt lgkmcnt(3)
    v_mfma_f32_16x16x32_bf16 v[64:67], v[16:19], v[0:3], v[64:67]
    ds_read_b64_tr_b16 v[48:49], v228 offset:36864
    v_mfma_f32_16x16x32_bf16 v[68:71], v[20:23], v[0:3], v[68:71]
    ds_read_b64_tr_b16 v[50:51], v228 offset:37376
    v_mfma_f32_16x16x32_bf16 v[72:75], v[24:27], v[0:3], v[72:75]
    ds_read_b128 v[32:35], v223 offset:32768
    v_mfma_f32_16x16x32_bf16 v[76:79], v[28:31], v[0:3], v[76:79]
    ds_read_b64_tr_b16 v[52:53], v229 offset:36864
    s_waitcnt lgkmcnt(6)
    v_mfma_f32_16x16x32_bf16 v[80:83], v[16:19], v[4:7], v[80:83]
    ds_read_b64_tr_b16 v[54:55], v229 offset:37376
    v_mfma_f32_16x16x32_bf16 v[84:87], v[20:23], v[4:7], v[84:87]
    ds_read_b64_tr_b16 v[56:57], v230 offset:36864
    v_mfma_f32_16x16x32_bf16 v[88:91], v[24:27], v[4:7], v[88:91]
    ds_read_b64_tr_b16 v[58:59], v230 offset:37376
    v_mfma_f32_16x16x32_bf16 v[92:95], v[28:31], v[4:7], v[92:95]
    ds_read_b64_tr_b16 v[60:61], v231 offset:36864
    s_waitcnt lgkmcnt(9)
    v_mfma_f32_16x16x32_bf16 v[96:99], v[16:19], v[8:11], v[96:99]
    ds_read_b64_tr_b16 v[62:63], v231 offset:37376
    v_mfma_f32_16x16x32_bf16 v[100:103], v[20:23], v[8:11], v[100:103]
    ds_read_b128 v[36:39], v223 offset:34816
    v_mfma_f32_16x16x32_bf16 v[104:107], v[24:27], v[8:11], v[104:107]
    ds_read_b128 v[40:43], v223 offset:36864
    v_mfma_f32_16x16x32_bf16 v[108:111], v[28:31], v[8:11], v[108:111]
    ds_read_b128 v[44:47], v223 offset:38912
    s_waitcnt lgkmcnt(12)
    v_mfma_f32_16x16x32_bf16 v[112:115], v[16:19], v[12:15], v[112:115]
    v_mfma_f32_16x16x32_bf16 v[116:119], v[20:23], v[12:15], v[116:119]
    v_mfma_f32_16x16x32_bf16 v[120:123], v[24:27], v[12:15], v[120:123]
    v_mfma_f32_16x16x32_bf16 v[124:127], v[28:31], v[12:15], v[124:127]
    s_waitcnt lgkmcnt(3)
    v_mfma_f32_16x16x32_bf16 v[64:67], v[48:51], v[32:35], v[64:67]
    v_mfma_f32_16x16x32_bf16 v[68:71], v[52:55], v[32:35], v[68:71]
    v_mfma_f32_16x16x32_bf16 v[72:75], v[56:59], v[32:35], v[72:75]
    v_mfma_f32_16x16x32_bf16 v[76:79], v[60:63], v[32:35], v[76:79]
    s_waitcnt lgkmcnt(2)
    v_mfma_f32_16x16x32_bf16 v[80:83], v[48:51], v[36:39], v[80:83]
    v_mfma_f32_16x16x32_bf16 v[84:87], v[52:55], v[36:39], v[84:87]
    v_mfma_f32_16x16x32_bf16 v[88:91], v[56:59], v[36:39], v[88:91]
    s_waitcnt lgkmcnt(0)
    s_barrier
    ds_read_b64_tr_b16 v[16:17], v224
    ds_read_b64_tr_b16 v[18:19], v224 offset:512
    v_mfma_f32_16x16x32_bf16 v[92:95], v[60:63], v[36:39], v[92:95]
    ds_read_b128 v[0:3], v220
    ds_read_b64_tr_b16 v[20:21], v225
    v_mfma_f32_16x16x32_bf16 v[96:99], v[48:51], v[40:43], v[96:99]
    ds_read_b64_tr_b16 v[22:23], v225 offset:512
    ds_read_b64_tr_b16 v[24:25], v226
    v_mfma_f32_16x16x32_bf16 v[100:103], v[52:55], v[40:43], v[100:103]
    ds_read_b64_tr_b16 v[26:27], v226 offset:512
    ds_read_b64_tr_b16 v[28:29], v227
    v_mfma_f32_16x16x32_bf16 v[104:107], v[56:59], v[40:43], v[104:107]
    ds_read_b64_tr_b16 v[30:31], v227 offset:512
    ds_read_b128 v[4:7], v220 offset:2048
    v_mfma_f32_16x16x32_bf16 v[108:111], v[60:63], v[40:43], v[108:111]
    ds_read_b128 v[8:11], v220 offset:4096
    ds_read_b128 v[12:15], v220 offset:6144
    v_mfma_f32_16x16x32_bf16 v[112:115], v[48:51], v[44:47], v[112:115]
    v_mfma_f32_16x16x32_bf16 v[116:119], v[52:55], v[44:47], v[116:119]
    v_mfma_f32_16x16x32_bf16 v[120:123], v[56:59], v[44:47], v[120:123]
    v_mfma_f32_16x16x32_bf16 v[124:127], v[60:63], v[44:47], v[124:127]
    s_waitcnt lgkmcnt(9)
    v_mfma_f32_16x16x32_bf16 v[64:67], v[16:19], v[0:3], v[64:67]
    ds_read_b64_tr_b16 v[48:49], v224 offset:4096
    ds_read_b64_tr_b16 v[50:51], v224 offset:4608
    s_waitcnt lgkmcnt(9)
    v_mfma_f32_16x16x32_bf16 v[68:71], v[20:23], v[0:3], v[68:71]
    ds_read_b128 v[32:35], v221
    ds_read_b64_tr_b16 v[52:53], v225 offset:4096
    s_waitcnt lgkmcnt(9)
    v_mfma_f32_16x16x32_bf16 v[72:75], v[24:27], v[0:3], v[72:75]
    ds_read_b64_tr_b16 v[54:55], v225 offset:4608
    ds_read_b64_tr_b16 v[56:57], v226 offset:4096
    s_waitcnt lgkmcnt(9)
    v_mfma_f32_16x16x32_bf16 v[76:79], v[28:31], v[0:3], v[76:79]
    ds_read_b64_tr_b16 v[58:59], v226 offset:4608
    ds_read_b64_tr_b16 v[60:61], v227 offset:4096
    s_waitcnt lgkmcnt(10)
    v_mfma_f32_16x16x32_bf16 v[80:83], v[16:19], v[4:7], v[80:83]
    ds_read_b64_tr_b16 v[62:63], v227 offset:4608
    ds_read_b128 v[36:39], v221 offset:2048
    v_mfma_f32_16x16x32_bf16 v[84:87], v[20:23], v[4:7], v[84:87]
    ds_read_b128 v[40:43], v221 offset:4096
    ds_read_b128 v[44:47], v221 offset:6144
    v_mfma_f32_16x16x32_bf16 v[88:91], v[24:27], v[4:7], v[88:91]
    v_mfma_f32_16x16x32_bf16 v[92:95], v[28:31], v[4:7], v[92:95]
    s_waitcnt lgkmcnt(9)
    v_mfma_f32_16x16x32_bf16 v[64:67], v[48:51], v[32:35], v[64:67]
    s_waitcnt lgkmcnt(2)
    v_mfma_f32_16x16x32_bf16 v[80:83], v[48:51], v[36:39], v[80:83]
    v_mfma_f32_16x16x32_bf16 v[68:71], v[52:55], v[32:35], v[68:71]
    v_mfma_f32_16x16x32_bf16 v[84:87], v[52:55], v[36:39], v[84:87]
    v_mfma_f32_16x16x32_bf16 v[72:75], v[56:59], v[32:35], v[72:75]
    v_mfma_f32_16x16x32_bf16 v[88:91], v[56:59], v[36:39], v[88:91]
    v_mfma_f32_16x16x32_bf16 v[76:79], v[60:63], v[32:35], v[76:79]
    v_mfma_f32_16x16x32_bf16 v[92:95], v[60:63], v[36:39], v[92:95]
    s_cmp_lt_u32 s69, 9
    s_cbranch_scc1 K2_qtail
    v_mfma_f32_16x16x32_bf16 v[96:99], v[16:19], v[8:11], v[96:99]
    v_mfma_f32_16x16x32_bf16 v[100:103], v[20:23], v[8:11], v[100:103]
    v_mfma_f32_16x16x32_bf16 v[104:107], v[24:27], v[8:11], v[104:107]
    v_cvt_pk_bf16_f32 v128, v64, v65
    v_mfma_f32_16x16x32_bf16 v[108:111], v[28:31], v[8:11], v[108:111]
    v_cvt_pk_bf16_f32 v129, v66, v67
    v_mfma_f32_16x16x32_bf16 v[112:115], v[16:19], v[12:15], v[112:115]
    v_cvt_pk_bf16_f32 v130, v80, v81
    v_cvt_pk_bf16_f32 v131, v82, v83
    v_mfma_f32_16x16x32_bf16 v[116:119], v[20:23], v[12:15], v[116:119]
    buffer_store_dwordx4 v[128:131], v250, s[24:27], s65 offen sc1
    v_mfma_f32_16x16x32_bf16 v[120:123], v[24:27], v[12:15], v[120:123]
    v_cvt_pk_bf16_f32 v132, v68, v69
    v_cvt_pk_bf16_f32 v133, v70, v71
    v_mfma_f32_16x16x32_bf16 v[124:127], v[28:31], v[12:15], v[124:127]
    v_cvt_pk_bf16_f32 v134, v84, v85
    s_waitcnt lgkmcnt(1)
    v_mfma_f32_16x16x32_bf16 v[96:99], v[48:51], v[40:43], v[96:99]
    v_cvt_pk_bf16_f32 v135, v86, v87
    buffer_store_dwordx4 v[132:135], v250, s[24:27], s65 offen offset:1024 sc1
    s_waitcnt lgkmcnt(0)
    v_mfma_f32_16x16x32_bf16 v[112:115], v[48:51], v[44:47], v[112:115]
    v_cvt_pk_bf16_f32 v136, v72, v73
    v_mfma_f32_16x16x32_bf16 v[100:103], v[52:55], v[40:43], v[100:103]
    v_cvt_pk_bf16_f32 v137, v74, v75
    v_mfma_f32_16x16x32_bf16 v[116:119], v[52:55], v[44:47], v[116:119]
    v_cvt_pk_bf16_f32 v138, v88, v89
    v_cvt_pk_bf16_f32 v139, v90, v91
    v_mfma_f32_16x16x32_bf16 v[104:107], v[56:59], v[40:43], v[104:107]
    buffer_store_dwordx4 v[136:139], v250, s[24:27], s65 offen offset:2048 sc1
    v_mfma_f32_16x16x32_bf16 v[120:123], v[56:59], v[44:47], v[120:123]
    v_cvt_pk_bf16_f32 v140, v76, v77
    v_cvt_pk_bf16_f32 v141, v78, v79
    v_mfma_f32_16x16x32_bf16 v[108:111], v[60:63], v[40:43], v[108:111]
    v_cvt_pk_bf16_f32 v142, v92, v93
    v_mfma_f32_16x16x32_bf16 v[124:127], v[60:63], v[44:47], v[124:127]
    v_cvt_pk_bf16_f32 v143, v94, v95
    buffer_store_dwordx4 v[140:143], v250, s[24:27], s65 offen offset:3072 sc1
    s_nop 1
    v_cvt_pk_bf16_f32 v144, v96, v97
    v_cvt_pk_bf16_f32 v145, v98, v99
    v_cvt_pk_bf16_f32 v146, v112, v113
    v_cvt_pk_bf16_f32 v147, v114, v115
    buffer_store_dwordx4 v[144:147], v250, s[24:27], s66 offen sc1
    v_cvt_pk_bf16_f32 v148, v100, v101
    v_cvt_pk_bf16_f32 v149, v102, v103
    v_cvt_pk_bf16_f32 v150, v116, v117
    v_cvt_pk_bf16_f32 v151, v118, v119
    buffer_store_dwordx4 v[148:151], v250, s[24:27], s66 offen offset:1024 sc1
    v_cvt_pk_bf16_f32 v152, v104, v105
    v_cvt_pk_bf16_f32 v153, v106, v107
    v_cvt_pk_bf16_f32 v154, v120, v121
    v_cvt_pk_bf16_f32 v155, v122, v123
    buffer_store_dwordx4 v[152:155], v250, s[24:27], s66 offen offset:2048 sc1
    v_cvt_pk_bf16_f32 v156, v108, v109
    v_cvt_pk_bf16_f32 v157, v110, v111
    v_cvt_pk_bf16_f32 v158, v124, v125
    v_cvt_pk_bf16_f32 v159, v126, v127
    buffer_store_dwordx4 v[156:159], v250, s[24:27], s66 offen offset:3072 sc1
    s_branch K2_p1done
K2_qtail:
    v_mfma_f32_16x16x32_bf16 v[96:99], v[16:19], v[8:11], v[96:99]
    v_mfma_f32_16x16x32_bf16 v[100:103], v[20:23], v[8:11], v[100:103]
    v_mfma_f32_16x16x32_bf16 v[104:107], v[24:27], v[8:11], v[104:107]
    v_pk_mul_f32 v[64:65], v[64:65], s[98:99]
    v_pk_mul_f32 v[66:67], v[66:67], s[98:99]
    v_mfma_f32_16x16x32_bf16 v[108:111], v[28:31], v[8:11], v[108:111]
    v_cvt_pk_bf16_f32 v128, v64, v65
    v_cvt_pk_bf16_f32 v129, v66, v67
    v_pk_mul_f32 v[80:81], v[80:81], s[98:99]
    v_mfma_f32_16x16x32_bf16 v[112:115], v[16:19], v[12:15], v[112:115]
    v_pk_mul_f32 v[82:83], v[82:83], s[98:99]
    v_cvt_pk_bf16_f32 v130, v80, v81
    v_mfma_f32_16x16x32_bf16 v[116:119], v[20:23], v[12:15], v[116:119]
    v_cvt_pk_bf16_f32 v131, v82, v83
    buffer_store_dwordx4 v[128:131], v250, s[24:27], s65 offen sc1
    v_pk_mul_f32 v[68:69], v[68:69], s[98:99]
    v_mfma_f32_16x16x32_bf16 v[120:123], v[24:27], v[12:15], v[120:123]
    v_pk_mul_f32 v[70:71], v[70:71], s[98:99]
    v_cvt_pk_bf16_f32 v132, v68, v69
    v_mfma_f32_16x16x32_bf16 v[124:127], v[28:31], v[12:15], v[124:127]
    v_cvt_pk_bf16_f32 v133, v70, v71
    v_pk_mul_f32 v[84:85], v[84:85], s[98:99]
    v_pk_mul_f32 v[86:87], v[86:87], s[98:99]
    s_waitcnt lgkmcnt(1)
    v_mfma_f32_16x16x32_bf16 v[96:99], v[48:51], v[40:43], v[96:99]
    v_cvt_pk_bf16_f32 v134, v84, v85
    v_cvt_pk_bf16_f32 v135, v86, v87
    buffer_store_dwordx4 v[132:135], v250, s[24:27], s65 offen offset:1024 sc1
    s_waitcnt lgkmcnt(0)
    v_mfma_f32_16x16x32_bf16 v[112:115], v[48:51], v[44:47], v[112:115]
    v_pk_mul_f32 v[72:73], v[72:73], s[98:99]
    v_pk_mul_f32 v[74:75], v[74:75], s[98:99]
    v_mfma_f32_16x16x32_bf16 v[100:103], v[52:55], v[40:43], v[100:103]
    v_cvt_pk_bf16_f32 v136, v72, v73
    v_cvt_pk_bf16_f32 v137, v74, v75
    v_pk_mul_f32 v[88:89], v[88:89], s[98:99]
    v_mfma_f32_16x16x32_bf16 v[116:119], v[52:55], v[44:47], v[116:119]
    v_pk_mul_f32 v[90:91], v[90:91], s[98:99]
    v_cvt_pk_bf16_f32 v138, v88, v89
    v_mfma_f32_16x16x32_bf16 v[104:107], v[56:59], v[40:43], v[104:107]
    v_cvt_pk_bf16_f32 v139, v90, v91
    buffer_store_dwordx4 v[136:139], v250, s[24:27], s65 offen offset:2048 sc1
    v_pk_mul_f32 v[76:77], v[76:77], s[98:99]
    v_mfma_f32_16x16x32_bf16 v[120:123], v[56:59], v[44:47], v[120:123]
    v_pk_mul_f32 v[78:79], v[78:79], s[98:99]
    v_cvt_pk_bf16_f32 v140, v76, v77
    v_mfma_f32_16x16x32_bf16 v[108:111], v[60:63], v[40:43], v[108:111]
    v_cvt_pk_bf16_f32 v141, v78, v79
    v_pk_mul_f32 v[92:93], v[92:93], s[98:99]
    v_pk_mul_f32 v[94:95], v[94:95], s[98:99]
    v_mfma_f32_16x16x32_bf16 v[124:127], v[60:63], v[44:47], v[124:127]
    v_cvt_pk_bf16_f32 v142, v92, v93
    v_cvt_pk_bf16_f32 v143, v94, v95
    buffer_store_dwordx4 v[140:143], v250, s[24:27], s65 offen offset:3072 sc1
    s_nop 1
    v_pk_mul_f32 v[96:97], v[96:97], s[98:99]
    v_pk_mul_f32 v[98:99], v[98:99], s[98:99]
    v_cvt_pk_bf16_f32 v144, v96, v97
    v_cvt_pk_bf16_f32 v145, v98, v99
    v_pk_mul_f32 v[112:113], v[112:113], s[98:99]
    v_pk_mul_f32 v[114:115], v[114:115], s[98:99]
    v_cvt_pk_bf16_f32 v146, v112, v113
    v_cvt_pk_bf16_f32 v147, v114, v115
    buffer_store_dwordx4 v[144:147], v250, s[24:27], s66 offen sc1
    v_pk_mul_f32 v[100:101], v[100:101], s[98:99]
    v_pk_mul_f32 v[102:103], v[102:103], s[98:99]
    v_cvt_pk_bf16_f32 v148, v100, v101
    v_cvt_pk_bf16_f32 v149, v102, v103
    v_pk_mul_f32 v[116:117], v[116:117], s[98:99]
    v_pk_mul_f32 v[118:119], v[118:119], s[98:99]
    v_cvt_pk_bf16_f32 v150, v116, v117
    v_cvt_pk_bf16_f32 v151, v118, v119
    buffer_store_dwordx4 v[148:151], v250, s[24:27], s66 offen offset:1024 sc1
    v_pk_mul_f32 v[104:105], v[104:105], s[98:99]
    v_pk_mul_f32 v[106:107], v[106:107], s[98:99]
    v_cvt_pk_bf16_f32 v152, v104, v105
    v_cvt_pk_bf16_f32 v153, v106, v107
    v_pk_mul_f32 v[120:121], v[120:121], s[98:99]
    v_pk_mul_f32 v[122:123], v[122:123], s[98:99]
    v_cvt_pk_bf16_f32 v154, v120, v121
    v_cvt_pk_bf16_f32 v155, v122, v123
    buffer_store_dwordx4 v[152:155], v250, s[24:27], s66 offen offset:2048 sc1
    v_pk_mul_f32 v[108:109], v[108:109], s[98:99]
    v_pk_mul_f32 v[110:111], v[110:111], s[98:99]
    v_cvt_pk_bf16_f32 v156, v108, v109
    v_cvt_pk_bf16_f32 v157, v110, v111
    v_pk_mul_f32 v[124:125], v[124:125], s[98:99]
    v_pk_mul_f32 v[126:127], v[126:127], s[98:99]
    v_cvt_pk_bf16_f32 v158, v124, v125
    v_cvt_pk_bf16_f32 v159, v126, v127
    buffer_store_dwordx4 v[156:159], v250, s[24:27], s66 offen offset:3072 sc1
    s_branch K2_p1done
K2_pv:
    s_barrier
    ds_read_b64_tr_b16 v[16:17], v224
    ds_read_b64_tr_b16 v[18:19], v224 offset:512
    ds_read_b128 v[0:3], v220
    ds_read_b64_tr_b16 v[20:21], v225
    ds_read_b64_tr_b16 v[22:23], v225 offset:512
    ds_read_b64_tr_b16 v[24:25], v226
    ds_read_b64_tr_b16 v[26:27], v226 offset:512
    ds_read_b64_tr_b16 v[28:29], v227
    ds_read_b64_tr_b16 v[30:31], v227 offset:512
    ds_read_b128 v[4:7], v220 offset:512
    ds_read_b128 v[8:11], v220 offset:4096
    ds_read_b128 v[12:15], v220 offset:4608
    s_waitcnt lgkmcnt(9)
    v_mfma_f32_16x16x32_bf16 v[64:67], v[0:3], v[16:19], 0
    ds_read_b64_tr_b16 v[48:49], v224 offset:4096
    s_waitcnt lgkmcnt(8)
    v_mfma_f32_16x16x32_bf16 v[68:71], v[0:3], v[20:23], 0
    ds_read_b64_tr_b16 v[50:51], v224 offset:4608
    s_waitcnt lgkmcnt(7)
    v_mfma_f32_16x16x32_bf16 v[72:75], v[0:3], v[24:27], 0
    ds_read_b128 v[32:35], v221
    s_waitcnt lgkmcnt(6)
    v_mfma_f32_16x16x32_bf16 v[76:79], v[0:3], v[28:31], 0
    ds_read_b64_tr_b16 v[52:53], v225 offset:4096
    s_waitcnt lgkmcnt(6)
    v_mfma_f32_16x16x32_bf16 v[80:83], v[4:7], v[16:19], 0
    ds_read_b64_tr_b16 v[54:55], v225 offset:4608
    v_mfma_f32_16x16x32_bf16 v[84:87], v[4:7], v[20:23], 0
    ds_read_b64_tr_b16 v[56:57], v226 offset:4096
    v_mfma_f32_16x16x32_bf16 v[88:91], v[4:7], v[24:27], 0
    ds_read_b64_tr_b16 v[58:59], v226 offset:4608
    v_mfma_f32_16x16x32_bf16 v[92:95], v[4:7], v[28:31], 0
    ds_read_b64_tr_b16 v[60:61], v227 offset:4096
    s_waitcnt lgkmcnt(9)
    v_mfma_f32_16x16x32_bf16 v[96:99], v[8:11], v[16:19], 0
    ds_read_b64_tr_b16 v[62:63], v227 offset:4608
    v_mfma_f32_16x16x32_bf16 v[100:103], v[8:11], v[20:23], 0
    ds_read_b128 v[36:39], v221 offset:512
    v_mfma_f32_16x16x32_bf16 v[104:107], v[8:11], v[24:27], 0
    ds_read_b128 v[40:43], v221 offset:4096
    v_mfma_f32_16x16x32_bf16 v[108:111], v[8:11], v[28:31], 0
    ds_read_b128 v[44:47], v221 offset:4608
    s_waitcnt lgkmcnt(12)
    v_mfma_f32_16x16x32_bf16 v[112:115], v[12:15], v[16:19], 0
    v_mfma_f32_16x16x32_bf16 v[116:119], v[12:15], v[20:23], 0
    v_mfma_f32_16x16x32_bf16 v[120:123], v[12:15], v[24:27], 0
    v_mfma_f32_16x16x32_bf16 v[124:127], v[12:15], v[28:31], 0
    s_waitcnt lgkmcnt(3)
    v_mfma_f32_16x16x32_bf16 v[64:67], v[32:35], v[48:51], v[64:67]
    s_waitcnt lgkmcnt(0)
    s_barrier
    ds_read_b64_tr_b16 v[16:17], v224 offset:32768
    v_mfma_f32_16x16x32_bf16 v[68:71], v[32:35], v[52:55], v[68:71]
    ds_read_b64_tr_b16 v[18:19], v224 offset:33280
    v_mfma_f32_16x16x32_bf16 v[72:75], v[32:35], v[56:59], v[72:75]
    ds_read_b128 v[0:3], v220 offset:32768
    v_mfma_f32_16x16x32_bf16 v[76:79], v[32:35], v[60:63], v[76:79]
    ds_read_b64_tr_b16 v[20:21], v225 offset:32768
    v_mfma_f32_16x16x32_bf16 v[80:83], v[36:39], v[48:51], v[80:83]
    ds_read_b64_tr_b16 v[22:23], v225 offset:33280
    v_mfma_f32_16x16x32_bf16 v[84:87], v[36:39], v[52:55], v[84:87]
    ds_read_b64_tr_b16 v[24:25], v226 offset:32768
    v_mfma_f32_16x16x32_bf16 v[88:91], v[36:39], v[56:59], v[88:91]
    ds_read_b64_tr_b16 v[26:27], v226 offset:33280
    v_mfma_f32_16x16x32_bf16 v[92:95], v[36:39], v[60:63], v[92:95]
    ds_read_b64_tr_b16 v[28:29], v227 offset:32768
    v_mfma_f32_16x16x32_bf16 v[96:99], v[40:43], v[48:51], v[96:99]
    ds_read_b64_tr_b16 v[30:31], v227 offset:33280
    v_mfma_f32_16x16x32_bf16 v[100:103], v[40:43], v[52:55], v[100:103]
    ds_read_b128 v[4:7], v220 offset:33280
    v_mfma_f32_16x16x32_bf16 v[104:107], v[40:43], v[56:59], v[104:107]
    ds_read_b128 v[8:11], v220 offset:36864
    v_mfma_f32_16x16x32_bf16 v[108:111], v[40:43], v[60:63], v[108:111]
    ds_read_b128 v[12:15], v220 offset:37376
    v_mfma_f32_16x16x32_bf16 v[112:115], v[44:47], v[48:51], v[112:115]
    v_mfma_f32_16x16x32_bf16 v[116:119], v[44:47], v[52:55], v[116:119]
    v_mfma_f32_16x16x32_bf16 v[120:123], v[44:47], v[56:59], v[120:123]
    v_mfma_f32_16x16x32_bf16 v[124:127], v[44:47], v[60:63], v[124:127]
    s_waitcnt lgkmcnt(3)
    v_mfma_f32_16x16x32_bf16 v[64:67], v[0:3], v[16:19], v[64:67]
    ds_read_b64_tr_b16 v[48:49], v224 offset:36864
    v_mfma_f32_16x16x32_bf16 v[68:71], v[0:3], v[20:23], v[68:71]
    ds_read_b64_tr_b16 v[50:51], v224 offset:37376
    v_mfma_f32_16x16x32_bf16 v[72:75], v[0:3], v[24:27], v[72:75]
    ds_read_b128 v[32:35], v221 offset:32768
    v_mfma_f32_16x16x32_bf16 v[76:79], v[0:3], v[28:31], v[76:79]
    ds_read_b64_tr_b16 v[52:53], v225 offset:36864
    s_waitcnt lgkmcnt(6)
    v_mfma_f32_16x16x32_bf16 v[80:83], v[4:7], v[16:19], v[80:83]
    ds_read_b64_tr_b16 v[54:55], v225 offset:37376
    v_mfma_f32_16x16x32_bf16 v[84:87], v[4:7], v[20:23], v[84:87]
    ds_read_b64_tr_b16 v[56:57], v226 offset:36864
    v_mfma_f32_16x16x32_bf16 v[88:91], v[4:7], v[24:27], v[88:91]
    ds_read_b64_tr_b16 v[58:59], v226 offset:37376
    v_mfma_f32_16x16x32_bf16 v[92:95], v[4:7], v[28:31], v[92:95]
    ds_read_b64_tr_b16 v[60:61], v227 offset:36864
    s_waitcnt lgkmcnt(9)
    v_mfma_f32_16x16x32_bf16 v[96:99], v[8:11], v[16:19], v[96:99]
    ds_read_b64_tr_b16 v[62:63], v227 offset:37376
    v_mfma_f32_16x16x32_bf16 v[100:103], v[8:11], v[20:23], v[100:103]
    ds_read_b128 v[36:39], v221 offset:33280
    v_mfma_f32_16x16x32_bf16 v[104:107], v[8:11], v[24:27], v[104:107]
    ds_read_b128 v[40:43], v221 offset:36864
    v_mfma_f32_16x16x32_bf16 v[108:111], v[8:11], v[28:31], v[108:111]
    ds_read_b128 v[44:47], v221 offset:37376
    s_waitcnt lgkmcnt(12)
    v_mfma_f32_16x16x32_bf16 v[112:115], v[12:15], v[16:19], v[112:115]
    v_mfma_f32_16x16x32_bf16 v[116:119], v[12:15], v[20:23], v[116:119]
    v_mfma_f32_16x16x32_bf16 v[120:123], v[12:15], v[24:27], v[120:123]
    v_mfma_f32_16x16x32_bf16 v[124:127], v[12:15], v[28:31], v[124:127]
    s_waitcnt lgkmcnt(3)
    v_mfma_f32_16x16x32_bf16 v[64:67], v[32:35], v[48:51], v[64:67]
    s_waitcnt lgkmcnt(0)
    s_barrier
    ds_read_b64_tr_b16 v[16:17], v228
    v_mfma_f32_16x16x32_bf16 v[68:71], v[32:35], v[52:55], v[68:71]
    ds_read_b64_tr_b16 v[18:19], v228 offset:512
    v_mfma_f32_16x16x32_bf16 v[72:75], v[32:35], v[56:59], v[72:75]
    ds_read_b128 v[0:3], v222
    v_mfma_f32_16x16x32_bf16 v[76:79], v[32:35], v[60:63], v[76:79]
    ds_read_b64_tr_b16 v[20:21], v229
    v_mfma_f32_16x16x32_bf16 v[80:83], v[36:39], v[48:51], v[80:83]
    ds_read_b64_tr_b16 v[22:23], v229 offset:512
    v_mfma_f32_16x16x32_bf16 v[84:87], v[36:39], v[52:55], v[84:87]
    ds_read_b64_tr_b16 v[24:25], v230
    v_mfma_f32_16x16x32_bf16 v[88:91], v[36:39], v[56:59], v[88:91]
    ds_read_b64_tr_b16 v[26:27], v230 offset:512
    v_mfma_f32_16x16x32_bf16 v[92:95], v[36:39], v[60:63], v[92:95]
    ds_read_b64_tr_b16 v[28:29], v231
    v_mfma_f32_16x16x32_bf16 v[96:99], v[40:43], v[48:51], v[96:99]
    ds_read_b64_tr_b16 v[30:31], v231 offset:512
    v_mfma_f32_16x16x32_bf16 v[100:103], v[40:43], v[52:55], v[100:103]
    ds_read_b128 v[4:7], v222 offset:512
    v_mfma_f32_16x16x32_bf16 v[104:107], v[40:43], v[56:59], v[104:107]
    ds_read_b128 v[8:11], v222 offset:4096
    v_mfma_f32_16x16x32_bf16 v[108:111], v[40:43], v[60:63], v[108:111]
    ds_read_b128 v[12:15], v222 offset:4608
    v_mfma_f32_16x16x32_bf16 v[112:115], v[44:47], v[48:51], v[112:115]
    v_mfma_f32_16x16x32_bf16 v[116:119], v[44:47], v[52:55], v[116:119]
    v_mfma_f32_16x16x32_bf16 v[120:123], v[44:47], v[56:59], v[120:123]
    v_mfma_f32_16x16x32_bf16 v[124:127], v[44:47], v[60:63], v[124:127]
    s_waitcnt lgkmcnt(3)
    v_mfma_f32_16x16x32_bf16 v[64:67], v[0:3], v[16:19], v[64:67]
    ds_read_b64_tr_b16 v[48:49], v228 offset:4096
    v_mfma_f32_16x16x32_bf16 v[68:71], v[0:3], v[20:23], v[68:71]
    ds_read_b64_tr_b16 v[50:51], v228 offset:4608
    v_mfma_f32_16x16x32_bf16 v[72:75], v[0:3], v[24:27], v[72:75]
    ds_read_b128 v[32:35], v223
    v_mfma_f32_16x16x32_bf16 v[76:79], v[0:3], v[28:31], v[76:79]
    ds_read_b64_tr_b16 v[52:53], v229 offset:4096
    s_waitcnt lgkmcnt(6)
    v_mfma_f32_16x16x32_bf16 v[80:83], v[4:7], v[16:19], v[80:83]
    ds_read_b64_tr_b16 v[54:55], v229 offset:4608
    v_mfma_f32_16x16x32_bf16 v[84:87], v[4:7], v[20:23], v[84:87]
    ds_read_b64_tr_b16 v[56:57], v230 offset:4096
    v_mfma_f32_16x16x32_bf16 v[88:91], v[4:7], v[24:27], v[88:91]
    ds_read_b64_tr_b16 v[58:59], v230 offset:4608
    v_mfma_f32_16x16x32_bf16 v[92:95], v[4:7], v[28:31], v[92:95]
    ds_read_b64_tr_b16 v[60:61], v231 offset:4096
    s_waitcnt lgkmcnt(9)
    v_mfma_f32_16x16x32_bf16 v[96:99], v[8:11], v[16:19], v[96:99]
    ds_read_b64_tr_b16 v[62:63], v231 offset:4608
    v_mfma_f32_16x16x32_bf16 v[100:103], v[8:11], v[20:23], v[100:103]
    ds_read_b128 v[36:39], v223 offset:512
    v_mfma_f32_16x16x32_bf16 v[104:107], v[8:11], v[24:27], v[104:107]
    ds_read_b128 v[40:43], v223 offset:4096
    v_mfma_f32_16x16x32_bf16 v[108:111], v[8:11], v[28:31], v[108:111]
    ds_read_b128 v[44:47], v223 offset:4608
    s_waitcnt lgkmcnt(12)
    v_mfma_f32_16x16x32_bf16 v[112:115], v[12:15], v[16:19], v[112:115]
    v_mfma_f32_16x16x32_bf16 v[116:119], v[12:15], v[20:23], v[116:119]
    v_mfma_f32_16x16x32_bf16 v[120:123], v[12:15], v[24:27], v[120:123]
    v_mfma_f32_16x16x32_bf16 v[124:127], v[12:15], v[28:31], v[124:127]
    s_waitcnt lgkmcnt(3)
    v_mfma_f32_16x16x32_bf16 v[64:67], v[32:35], v[48:51], v[64:67]
    s_waitcnt lgkmcnt(0)
    s_barrier
    ds_read_b64_tr_b16 v[16:17], v228 offset:32768
    v_mfma_f32_16x16x32_bf16 v[68:71], v[32:35], v[52:55], v[68:71]
    ds_read_b64_tr_b16 v[18:19], v228 offset:33280
    v_mfma_f32_16x16x32_bf16 v[72:75], v[32:35], v[56:59], v[72:75]
    ds_read_b128 v[0:3], v222 offset:32768
    v_mfma_f32_16x16x32_bf16 v[76:79], v[32:35], v[60:63], v[76:79]
    ds_read_b64_tr_b16 v[20:21], v229 offset:32768
    v_mfma_f32_16x16x32_bf16 v[80:83], v[36:39], v[48:51], v[80:83]
    ds_read_b64_tr_b16 v[22:23], v229 offset:33280
    v_mfma_f32_16x16x32_bf16 v[84:87], v[36:39], v[52:55], v[84:87]
    ds_read_b64_tr_b16 v[24:25], v230 offset:32768
    v_mfma_f32_16x16x32_bf16 v[88:91], v[36:39], v[56:59], v[88:91]
    ds_read_b64_tr_b16 v[26:27], v230 offset:33280
    v_mfma_f32_16x16x32_bf16 v[92:95], v[36:39], v[60:63], v[92:95]
    ds_read_b64_tr_b16 v[28:29], v231 offset:32768
    v_mfma_f32_16x16x32_bf16 v[96:99], v[40:43], v[48:51], v[96:99]
    ds_read_b64_tr_b16 v[30:31], v231 offset:33280
    v_mfma_f32_16x16x32_bf16 v[100:103], v[40:43], v[52:55], v[100:103]
    ds_read_b128 v[4:7], v222 offset:33280
    v_mfma_f32_16x16x32_bf16 v[104:107], v[40:43], v[56:59], v[104:107]
    ds_read_b128 v[8:11], v222 offset:36864
    v_mfma_f32_16x16x32_bf16 v[108:111], v[40:43], v[60:63], v[108:111]
    ds_read_b128 v[12:15], v222 offset:37376
    v_mfma_f32_16x16x32_bf16 v[112:115], v[44:47], v[48:51], v[112:115]
    v_mfma_f32_16x16x32_bf16 v[116:119], v[44:47], v[52:55], v[116:119]
    v_mfma_f32_16x16x32_bf16 v[120:123], v[44:47], v[56:59], v[120:123]
    v_mfma_f32_16x16x32_bf16 v[124:127], v[44:47], v[60:63], v[124:127]
    s_waitcnt lgkmcnt(3)
    v_mfma_f32_16x16x32_bf16 v[64:67], v[0:3], v[16:19], v[64:67]
    ds_read_b64_tr_b16 v[48:49], v228 offset:36864
    v_mfma_f32_16x16x32_bf16 v[68:71], v[0:3], v[20:23], v[68:71]
    ds_read_b64_tr_b16 v[50:51], v228 offset:37376
    v_mfma_f32_16x16x32_bf16 v[72:75], v[0:3], v[24:27], v[72:75]
    ds_read_b128 v[32:35], v223 offset:32768
    v_mfma_f32_16x16x32_bf16 v[76:79], v[0:3], v[28:31], v[76:79]
    ds_read_b64_tr_b16 v[52:53], v229 offset:36864
    s_waitcnt lgkmcnt(6)
    v_mfma_f32_16x16x32_bf16 v[80:83], v[4:7], v[16:19], v[80:83]
    ds_read_b64_tr_b16 v[54:55], v229 offset:37376
    v_mfma_f32_16x16x32_bf16 v[84:87], v[4:7], v[20:23], v[84:87]
    ds_read_b64_tr_b16 v[56:57], v230 offset:36864
    v_mfma_f32_16x16x32_bf16 v[88:91], v[4:7], v[24:27], v[88:91]
    ds_read_b64_tr_b16 v[58:59], v230 offset:37376
    v_mfma_f32_16x16x32_bf16 v[92:95], v[4:7], v[28:31], v[92:95]
    ds_read_b64_tr_b16 v[60:61], v231 offset:36864
    s_waitcnt lgkmcnt(9)
    v_mfma_f32_16x16x32_bf16 v[96:99], v[8:11], v[16:19], v[96:99]
    ds_read_b64_tr_b16 v[62:63], v231 offset:37376
    v_mfma_f32_16x16x32_bf16 v[100:103], v[8:11], v[20:23], v[100:103]
    ds_read_b128 v[36:39], v223 offset:33280
    v_mfma_f32_16x16x32_bf16 v[104:107], v[8:11], v[24:27], v[104:107]
    ds_read_b128 v[40:43], v223 offset:36864
    v_mfma_f32_16x16x32_bf16 v[108:111], v[8:11], v[28:31], v[108:111]
    ds_read_b128 v[44:47], v223 offset:37376
    s_waitcnt lgkmcnt(12)
    v_mfma_f32_16x16x32_bf16 v[112:115], v[12:15], v[16:19], v[112:115]
    v_mfma_f32_16x16x32_bf16 v[116:119], v[12:15], v[20:23], v[116:119]
    v_mfma_f32_16x16x32_bf16 v[120:123], v[12:15], v[24:27], v[120:123]
    v_mfma_f32_16x16x32_bf16 v[124:127], v[12:15], v[28:31], v[124:127]
    s_waitcnt lgkmcnt(3)
    v_mfma_f32_16x16x32_bf16 v[64:67], v[32:35], v[48:51], v[64:67]
    s_waitcnt lgkmcnt(0)
    s_barrier
    ds_read_b64_tr_b16 v[16:17], v224
    v_mfma_f32_16x16x32_bf16 v[68:71], v[32:35], v[52:55], v[68:71]
    ds_read_b64_tr_b16 v[18:19], v224 offset:512
    v_mfma_f32_16x16x32_bf16 v[72:75], v[32:35], v[56:59], v[72:75]
    ds_read_b128 v[0:3], v220
    v_mfma_f32_16x16x32_bf16 v[76:79], v[32:35], v[60:63], v[76:79]
    ds_read_b64_tr_b16 v[20:21], v225
    v_mfma_f32_16x16x32_bf16 v[80:83], v[36:39], v[48:51], v[80:83]
    ds_read_b64_tr_b16 v[22:23], v225 offset:512
    v_mfma_f32_16x16x32_bf16 v[84:87], v[36:39], v[52:55], v[84:87]
    ds_read_b64_tr_b16 v[24:25], v226
    v_mfma_f32_16x16x32_bf16 v[88:91], v[36:39], v[56:59], v[88:91]
    ds_read_b64_tr_b16 v[26:27], v226 offset:512
    v_mfma_f32_16x16x32_bf16 v[92:95], v[36:39], v[60:63], v[92:95]
    ds_read_b64_tr_b16 v[28:29], v227
    v_mfma_f32_16x16x32_bf16 v[96:99], v[40:43], v[48:51], v[96:99]
    ds_read_b64_tr_b16 v[30:31], v227 offset:512
    v_mfma_f32_16x16x32_bf16 v[100:103], v[40:43], v[52:55], v[100:103]
    ds_read_b128 v[4:7], v220 offset:512
    v_mfma_f32_16x16x32_bf16 v[104:107], v[40:43], v[56:59], v[104:107]
    ds_read_b128 v[8:11], v220 offset:4096
    v_mfma_f32_16x16x32_bf16 v[108:111], v[40:43], v[60:63], v[108:111]
    ds_read_b128 v[12:15], v220 offset:4608
    v_mfma_f32_16x16x32_bf16 v[112:115], v[44:47], v[48:51], v[112:115]
    v_mfma_f32_16x16x32_bf16 v[116:119], v[44:47], v[52:55], v[116:119]
    v_mfma_f32_16x16x32_bf16 v[120:123], v[44:47], v[56:59], v[120:123]
    v_mfma_f32_16x16x32_bf16 v[124:127], v[44:47], v[60:63], v[124:127]
    s_waitcnt lgkmcnt(3)
    v_mfma_f32_16x16x32_bf16 v[64:67], v[0:3], v[16:19], v[64:67]
    buffer_load_dword v246, off, s[12:15], 0 sc1
    ds_read_b64_tr_b16 v[48:49], v224 offset:4096
    v_mfma_f32_16x16x32_bf16 v[68:71], v[0:3], v[20:23], v[68:71]
    ds_read_b64_tr_b16 v[50:51], v224 offset:4608
    v_mfma_f32_16x16x32_bf16 v[72:75], v[0:3], v[24:27], v[72:75]
    ds_read_b128 v[32:35], v221
    v_mfma_f32_16x16x32_bf16 v[76:79], v[0:3], v[28:31], v[76:79]
    ds_read_b64_tr_b16 v[52:53], v225 offset:4096
    s_waitcnt lgkmcnt(6)
    v_mfma_f32_16x16x32_bf16 v[80:83], v[4:7], v[16:19], v[80:83]
    ds_read_b64_tr_b16 v[54:55], v225 offset:4608
    v_mfma_f32_16x16x32_bf16 v[84:87], v[4:7], v[20:23], v[84:87]
    ds_read_b64_tr_b16 v[56:57], v226 offset:4096
    v_mfma_f32_16x16x32_bf16 v[88:91], v[4:7], v[24:27], v[88:91]
    ds_read_b64_tr_b16 v[58:59], v226 offset:4608
    v_mfma_f32_16x16x32_bf16 v[92:95], v[4:7], v[28:31], v[92:95]
    ds_read_b64_tr_b16 v[60:61], v227 offset:4096
    s_waitcnt lgkmcnt(9)
    v_mfma_f32_16x16x32_bf16 v[96:99], v[8:11], v[16:19], v[96:99]
    ds_read_b64_tr_b16 v[62:63], v227 offset:4608
    v_mfma_f32_16x16x32_bf16 v[100:103], v[8:11], v[20:23], v[100:103]
    ds_read_b128 v[36:39], v221 offset:512
    v_mfma_f32_16x16x32_bf16 v[104:107], v[8:11], v[24:27], v[104:107]
    ds_read_b128 v[40:43], v221 offset:4096
    v_mfma_f32_16x16x32_bf16 v[108:111], v[8:11], v[28:31], v[108:111]
    ds_read_b128 v[44:47], v221 offset:4608
    s_waitcnt lgkmcnt(12)
    v_mfma_f32_16x16x32_bf16 v[112:115], v[12:15], v[16:19], v[112:115]
    v_mfma_f32_16x16x32_bf16 v[116:119], v[12:15], v[20:23], v[116:119]
    v_mfma_f32_16x16x32_bf16 v[120:123], v[12:15], v[24:27], v[120:123]
    v_mfma_f32_16x16x32_bf16 v[124:127], v[12:15], v[28:31], v[124:127]
    s_waitcnt lgkmcnt(3)
    v_mfma_f32_16x16x32_bf16 v[64:67], v[32:35], v[48:51], v[64:67]
    s_waitcnt lgkmcnt(0)
    s_barrier
    ds_read_b64_tr_b16 v[16:17], v224 offset:32768
    v_mfma_f32_16x16x32_bf16 v[68:71], v[32:35], v[52:55], v[68:71]
    ds_read_b64_tr_b16 v[18:19], v224 offset:33280
    v_mfma_f32_16x16x32_bf16 v[72:75], v[32:35], v[56:59], v[72:75]
    ds_read_b128 v[0:3], v220 offset:32768
    v_mfma_f32_16x16x32_bf16 v[76:79], v[32:35], v[60:63], v[76:79]
    ds_read_b64_tr_b16 v[20:21], v225 offset:32768
    v_mfma_f32_16x16x32_bf16 v[80:83], v[36:39], v[48:51], v[80:83]
    ds_read_b64_tr_b16 v[22:23], v225 offset:33280
    v_mfma_f32_16x16x32_bf16 v[84:87], v[36:39], v[52:55], v[84:87]
    ds_read_b64_tr_b16 v[24:25], v226 offset:32768
    v_mfma_f32_16x16x32_bf16 v[88:91], v[36:39], v[56:59], v[88:91]
    ds_read_b64_tr_b16 v[26:27], v226 offset:33280
    v_mfma_f32_16x16x32_bf16 v[92:95], v[36:39], v[60:63], v[92:95]
    ds_read_b64_tr_b16 v[28:29], v227 offset:32768
    v_mfma_f32_16x16x32_bf16 v[96:99], v[40:43], v[48:51], v[96:99]
    ds_read_b64_tr_b16 v[30:31], v227 offset:33280
    v_mfma_f32_16x16x32_bf16 v[100:103], v[40:43], v[52:55], v[100:103]
    ds_read_b128 v[4:7], v220 offset:33280
    v_mfma_f32_16x16x32_bf16 v[104:107], v[40:43], v[56:59], v[104:107]
    ds_read_b128 v[8:11], v220 offset:36864
    v_mfma_f32_16x16x32_bf16 v[108:111], v[40:43], v[60:63], v[108:111]
    ds_read_b128 v[12:15], v220 offset:37376
    v_mfma_f32_16x16x32_bf16 v[112:115], v[44:47], v[48:51], v[112:115]
    v_mfma_f32_16x16x32_bf16 v[116:119], v[44:47], v[52:55], v[116:119]
    v_mfma_f32_16x16x32_bf16 v[120:123], v[44:47], v[56:59], v[120:123]
    v_mfma_f32_16x16x32_bf16 v[124:127], v[44:47], v[60:63], v[124:127]
    s_waitcnt lgkmcnt(3)
    v_mfma_f32_16x16x32_bf16 v[64:67], v[0:3], v[16:19], v[64:67]
    ds_read_b64_tr_b16 v[48:49], v224 offset:36864
    v_mfma_f32_16x16x32_bf16 v[68:71], v[0:3], v[20:23], v[68:71]
    ds_read_b64_tr_b16 v[50:51], v224 offset:37376
    v_mfma_f32_16x16x32_bf16 v[72:75], v[0:3], v[24:27], v[72:75]
    ds_read_b128 v[32:35], v221 offset:32768
    v_mfma_f32_16x16x32_bf16 v[76:79], v[0:3], v[28:31], v[76:79]
    ds_read_b64_tr_b16 v[52:53], v225 offset:36864
    s_waitcnt lgkmcnt(6)
    v_mfma_f32_16x16x32_bf16 v[80:83], v[4:7], v[16:19], v[80:83]
    ds_read_b64_tr_b16 v[54:55], v225 offset:37376
    v_mfma_f32_16x16x32_bf16 v[84:87], v[4:7], v[20:23], v[84:87]
    ds_read_b64_tr_b16 v[56:57], v226 offset:36864
    v_mfma_f32_16x16x32_bf16 v[88:91], v[4:7], v[24:27], v[88:91]
    ds_read_b64_tr_b16 v[58:59], v226 offset:37376
    v_mfma_f32_16x16x32_bf16 v[92:95], v[4:7], v[28:31], v[92:95]
    ds_read_b64_tr_b16 v[60:61], v227 offset:36864
    s_waitcnt lgkmcnt(9)
    v_mfma_f32_16x16x32_bf16 v[96:99], v[8:11], v[16:19], v[96:99]
    ds_read_b64_tr_b16 v[62:63], v227 offset:37376
    v_mfma_f32_16x16x32_bf16 v[100:103], v[8:11], v[20:23], v[100:103]
    ds_read_b128 v[36:39], v221 offset:33280
    v_mfma_f32_16x16x32_bf16 v[104:107], v[8:11], v[24:27], v[104:107]
    ds_read_b128 v[40:43], v221 offset:36864
    v_mfma_f32_16x16x32_bf16 v[108:111], v[8:11], v[28:31], v[108:111]
    ds_read_b128 v[44:47], v221 offset:37376
    s_waitcnt lgkmcnt(12)
    v_mfma_f32_16x16x32_bf16 v[112:115], v[12:15], v[16:19], v[112:115]
    v_mfma_f32_16x16x32_bf16 v[116:119], v[12:15], v[20:23], v[116:119]
    v_mfma_f32_16x16x32_bf16 v[120:123], v[12:15], v[24:27], v[120:123]
    v_mfma_f32_16x16x32_bf16 v[124:127], v[12:15], v[28:31], v[124:127]
    s_waitcnt lgkmcnt(3)
    v_mfma_f32_16x16x32_bf16 v[64:67], v[32:35], v[48:51], v[64:67]
    s_waitcnt lgkmcnt(0)
    s_barrier
    ds_read_b64_tr_b16 v[16:17], v228
    v_mfma_f32_16x16x32_bf16 v[68:71], v[32:35], v[52:55], v[68:71]
    ds_read_b64_tr_b16 v[18:19], v228 offset:512
    v_mfma_f32_16x16x32_bf16 v[72:75], v[32:35], v[56:59], v[72:75]
    ds_read_b128 v[0:3], v222
    v_mfma_f32_16x16x32_bf16 v[76:79], v[32:35], v[60:63], v[76:79]
    ds_read_b64_tr_b16 v[20:21], v229
    v_mfma_f32_16x16x32_bf16 v[80:83], v[36:39], v[48:51], v[80:83]
    ds_read_b64_tr_b16 v[22:23], v229 offset:512
    v_mfma_f32_16x16x32_bf16 v[84:87], v[36:39], v[52:55], v[84:87]
    ds_read_b64_tr_b16 v[24:25], v230
    v_mfma_f32_16x16x32_bf16 v[88:91], v[36:39], v[56:59], v[88:91]
    ds_read_b64_tr_b16 v[26:27], v230 offset:512
    v_mfma_f32_16x16x32_bf16 v[92:95], v[36:39], v[60:63], v[92:95]
    ds_read_b64_tr_b16 v[28:29], v231
    v_mfma_f32_16x16x32_bf16 v[96:99], v[40:43], v[48:51], v[96:99]
    ds_read_b64_tr_b16 v[30:31], v231 offset:512
    v_mfma_f32_16x16x32_bf16 v[100:103], v[40:43], v[52:55], v[100:103]
    ds_read_b128 v[4:7], v222 offset:512
    v_mfma_f32_16x16x32_bf16 v[104:107], v[40:43], v[56:59], v[104:107]
    ds_read_b128 v[8:11], v222 offset:4096
    v_mfma_f32_16x16x32_bf16 v[108:111], v[40:43], v[60:63], v[108:111]
    ds_read_b128 v[12:15], v222 offset:4608
    v_mfma_f32_16x16x32_bf16 v[112:115], v[44:47], v[48:51], v[112:115]
    v_mfma_f32_16x16x32_bf16 v[116:119], v[44:47], v[52:55], v[116:119]
    v_mfma_f32_16x16x32_bf16 v[120:123], v[44:47], v[56:59], v[120:123]
    v_mfma_f32_16x16x32_bf16 v[124:127], v[44:47], v[60:63], v[124:127]
    s_waitcnt lgkmcnt(3)
    v_mfma_f32_16x16x32_bf16 v[64:67], v[0:3], v[16:19], v[64:67]
    ds_read_b64_tr_b16 v[48:49], v228 offset:4096
    v_mfma_f32_16x16x32_bf16 v[68:71], v[0:3], v[20:23], v[68:71]
    ds_read_b64_tr_b16 v[50:51], v228 offset:4608
    v_mfma_f32_16x16x32_bf16 v[72:75], v[0:3], v[24:27], v[72:75]
    ds_read_b128 v[32:35], v223
    v_mfma_f32_16x16x32_bf16 v[76:79], v[0:3], v[28:31], v[76:79]
    ds_read_b64_tr_b16 v[52:53], v229 offset:4096
    s_waitcnt lgkmcnt(6)
    v_mfma_f32_16x16x32_bf16 v[80:83], v[4:7], v[16:19], v[80:83]
    ds_read_b64_tr_b16 v[54:55], v229 offset:4608
    v_mfma_f32_16x16x32_bf16 v[84:87], v[4:7], v[20:23], v[84:87]
    ds_read_b64_tr_b16 v[56:57], v230 offset:4096
    v_mfma_f32_16x16x32_bf16 v[88:91], v[4:7], v[24:27], v[88:91]
    ds_read_b64_tr_b16 v[58:59], v230 offset:4608
    v_mfma_f32_16x16x32_bf16 v[92:95], v[4:7], v[28:31], v[92:95]
    ds_read_b64_tr_b16 v[60:61], v231 offset:4096
    s_waitcnt lgkmcnt(9)
    v_mfma_f32_16x16x32_bf16 v[96:99], v[8:11], v[16:19], v[96:99]
    ds_read_b64_tr_b16 v[62:63], v231 offset:4608
    v_mfma_f32_16x16x32_bf16 v[100:103], v[8:11], v[20:23], v[100:103]
    ds_read_b128 v[36:39], v223 offset:512
    v_mfma_f32_16x16x32_bf16 v[104:107], v[8:11], v[24:27], v[104:107]
    ds_read_b128 v[40:43], v223 offset:4096
    v_mfma_f32_16x16x32_bf16 v[108:111], v[8:11], v[28:31], v[108:111]
    ds_read_b128 v[44:47], v223 offset:4608
    s_waitcnt lgkmcnt(12)
    v_mfma_f32_16x16x32_bf16 v[112:115], v[12:15], v[16:19], v[112:115]
    v_mfma_f32_16x16x32_bf16 v[116:119], v[12:15], v[20:23], v[116:119]
    v_mfma_f32_16x16x32_bf16 v[120:123], v[12:15], v[24:27], v[120:123]
    v_mfma_f32_16x16x32_bf16 v[124:127], v[12:15], v[28:31], v[124:127]
    s_waitcnt lgkmcnt(3)
    v_mfma_f32_16x16x32_bf16 v[64:67], v[32:35], v[48:51], v[64:67]
    s_waitcnt lgkmcnt(0)
    s_barrier
    s_mov_b32 s5, 131072
K2_tag_3:
    s_waitcnt vmcnt(0)
    v_readfirstlane_b32 s53, v246
    s_cmp_lg_u32 s53, 0
    s_cbranch_scc1 K2_tag_3_d
    s_sleep 8
    buffer_load_dword v246, off, s[12:15], 0 sc1
    s_sub_u32 s5, s5, 1
    s_cbranch_scc0 K2_tag_3
K2_tag_3_d:
    ds_read_b64_tr_b16 v[16:17], v228 offset:32768
    v_mfma_f32_16x16x32_bf16 v[68:71], v[32:35], v[52:55], v[68:71]
    ds_read_b64_tr_b16 v[18:19], v228 offset:33280
    v_mfma_f32_16x16x32_bf16 v[72:75], v[32:35], v[56:59], v[72:75]
    ds_read_b128 v[0:3], v222 offset:32768
    v_mfma_f32_16x16x32_bf16 v[76:79], v[32:35], v[60:63], v[76:79]
    ds_read_b64_tr_b16 v[20:21], v229 offset:32768
    v_mfma_f32_16x16x32_bf16 v[80:83], v[36:39], v[48:51], v[80:83]
    ds_read_b64_tr_b16 v[22:23], v229 offset:33280
    v_mfma_f32_16x16x32_bf16 v[84:87], v[36:39], v[52:55], v[84:87]
    ds_read_b64_tr_b16 v[24:25], v230 offset:32768
    v_mfma_f32_16x16x32_bf16 v[88:91], v[36:39], v[56:59], v[88:91]
    ds_read_b64_tr_b16 v[26:27], v230 offset:33280
    v_mfma_f32_16x16x32_bf16 v[92:95], v[36:39], v[60:63], v[92:95]
    ds_read_b64_tr_b16 v[28:29], v231 offset:32768
    v_mfma_f32_16x16x32_bf16 v[96:99], v[40:43], v[48:51], v[96:99]
    ds_read_b64_tr_b16 v[30:31], v231 offset:33280
    v_mfma_f32_16x16x32_bf16 v[100:103], v[40:43], v[52:55], v[100:103]
    ds_read_b128 v[4:7], v222 offset:33280
    v_mfma_f32_16x16x32_bf16 v[104:107], v[40:43], v[56:59], v[104:107]
    ds_read_b128 v[8:11], v222 offset:36864
    v_mfma_f32_16x16x32_bf16 v[108:111], v[40:43], v[60:63], v[108:111]
    ds_read_b128 v[12:15], v222 offset:37376
    v_mfma_f32_16x16x32_bf16 v[112:115], v[44:47], v[48:51], v[112:115]
    v_mfma_f32_16x16x32_bf16 v[116:119], v[44:47], v[52:55], v[116:119]
    v_mfma_f32_16x16x32_bf16 v[120:123], v[44:47], v[56:59], v[120:123]
    v_mfma_f32_16x16x32_bf16 v[124:127], v[44:47], v[60:63], v[124:127]
    s_waitcnt lgkmcnt(3)
    v_mfma_f32_16x16x32_bf16 v[64:67], v[0:3], v[16:19], v[64:67]
    ds_read_b64_tr_b16 v[48:49], v228 offset:36864
    v_mfma_f32_16x16x32_bf16 v[68:71], v[0:3], v[20:23], v[68:71]
    ds_read_b64_tr_b16 v[50:51], v228 offset:37376
    v_mfma_f32_16x16x32_bf16 v[72:75], v[0:3], v[24:27], v[72:75]
    ds_read_b128 v[32:35], v223 offset:32768
    v_mfma_f32_16x16x32_bf16 v[76:79], v[0:3], v[28:31], v[76:79]
    ds_read_b64_tr_b16 v[52:53], v229 offset:36864
    s_waitcnt lgkmcnt(6)
    v_mfma_f32_16x16x32_bf16 v[80:83], v[4:7], v[16:19], v[80:83]
    ds_read_b64_tr_b16 v[54:55], v229 offset:37376
    v_mfma_f32_16x16x32_bf16 v[84:87], v[4:7], v[20:23], v[84:87]
    ds_read_b64_tr_b16 v[56:57], v230 offset:36864
    v_mfma_f32_16x16x32_bf16 v[88:91], v[4:7], v[24:27], v[88:91]
    ds_read_b64_tr_b16 v[58:59], v230 offset:37376
    v_mfma_f32_16x16x32_bf16 v[92:95], v[4:7], v[28:31], v[92:95]
    ds_read_b64_tr_b16 v[60:61], v231 offset:36864
    s_waitcnt lgkmcnt(9)
    v_mfma_f32_16x16x32_bf16 v[96:99], v[8:11], v[16:19], v[96:99]
    ds_read_b64_tr_b16 v[62:63], v231 offset:37376
    v_mfma_f32_16x16x32_bf16 v[100:103], v[8:11], v[20:23], v[100:103]
    ds_read_b128 v[36:39], v223 offset:33280
    v_mfma_f32_16x16x32_bf16 v[104:107], v[8:11], v[24:27], v[104:107]
    ds_read_b128 v[40:43], v223 offset:36864
    v_mfma_f32_16x16x32_bf16 v[108:111], v[8:11], v[28:31], v[108:111]
    ds_read_b128 v[44:47], v223 offset:37376
    s_waitcnt lgkmcnt(12)
    v_mfma_f32_16x16x32_bf16 v[112:115], v[12:15], v[16:19], v[112:115]
    v_mfma_f32_16x16x32_bf16 v[116:119], v[12:15], v[20:23], v[116:119]
    v_mfma_f32_16x16x32_bf16 v[120:123], v[12:15], v[24:27], v[120:123]
    v_mfma_f32_16x16x32_bf16 v[124:127], v[12:15], v[28:31], v[124:127]
    s_waitcnt lgkmcnt(3)
    v_mfma_f32_16x16x32_bf16 v[64:67], v[32:35], v[48:51], v[64:67]
    v_mfma_f32_16x16x32_bf16 v[68:71], v[32:35], v[52:55], v[68:71]
    v_mfma_f32_16x16x32_bf16 v[72:75], v[32:35], v[56:59], v[72:75]
    v_mfma_f32_16x16x32_bf16 v[76:79], v[32:35], v[60:63], v[76:79]
    s_waitcnt lgkmcnt(2)
    v_mfma_f32_16x16x32_bf16 v[80:83], v[36:39], v[48:51], v[80:83]
    v_mfma_f32_16x16x32_bf16 v[84:87], v[36:39], v[52:55], v[84:87]
    v_mfma_f32_16x16x32_bf16 v[88:91], v[36:39], v[56:59], v[88:91]
    s_waitcnt lgkmcnt(0)
    s_barrier
    ds_read_b64_tr_b16 v[16:17], v224
    ds_read_b64_tr_b16 v[18:19], v224 offset:512
    v_mfma_f32_16x16x32_bf16 v[92:95], v[36:39], v[60:63], v[92:95]
    ds_read_b128 v[0:3], v220
    ds_read_b64_tr_b16 v[20:21], v225
    v_mfma_f32_16x16x32_bf16 v[96:99], v[40:43], v[48:51], v[96:99]
    ds_read_b64_tr_b16 v[22:23], v225 offset:512
    ds_read_b64_tr_b16 v[24:25], v226
    v_mfma_f32_16x16x32_bf16 v[100:103], v[40:43], v[52:55], v[100:103]
    ds_read_b64_tr_b16 v[26:27], v226 offset:512
    ds_read_b64_tr_b16 v[28:29], v227
    v_mfma_f32_16x16x32_bf16 v[104:107], v[40:43], v[56:59], v[104:107]
    ds_read_b64_tr_b16 v[30:31], v227 offset:512
    ds_read_b128 v[4:7], v220 offset:512
    v_mfma_f32_16x16x32_bf16 v[108:111], v[40:43], v[60:63], v[108:111]
    ds_read_b128 v[8:11], v220 offset:4096
    ds_read_b128 v[12:15], v220 offset:4608
    v_mfma_f32_16x16x32_bf16 v[112:115], v[44:47], v[48:51], v[112:115]
    v_mfma_f32_16x16x32_bf16 v[116:119], v[44:47], v[52:55], v[116:119]
    v_mfma_f32_16x16x32_bf16 v[120:123], v[44:47], v[56:59], v[120:123]
    v_mfma_f32_16x16x32_bf16 v[124:127], v[44:47], v[60:63], v[124:127]
    s_waitcnt lgkmcnt(9)
    v_mfma_f32_16x16x32_bf16 v[64:67], v[0:3], v[16:19], v[64:67]
    ds_read_b64_tr_b16 v[48:49], v224 offset:4096
    ds_read_b64_tr_b16 v[50:51], v224 offset:4608
    s_waitcnt lgkmcnt(9)
    v_mfma_f32_16x16x32_bf16 v[68:71], v[0:3], v[20:23], v[68:71]
    ds_read_b128 v[32:35], v221
    ds_read_b64_tr_b16 v[52:53], v225 offset:4096
    s_waitcnt lgkmcnt(9)
    v_mfma_f32_16x16x32_bf16 v[72:75], v[0:3], v[24:27], v[72:75]
    ds_read_b64_tr_b16 v[54:55], v225 offset:4608
    ds_read_b64_tr_b16 v[56:57], v226 offset:4096
    s_waitcnt lgkmcnt(9)
    v_mfma_f32_16x16x32_bf16 v[76:79], v[0:3], v[28:31], v[76:79]
    ds_read_b64_tr_b16 v[58:59], v226 offset:4608
    ds_read_b64_tr_b16 v[60:61], v227 offset:4096
    s_waitcnt lgkmcnt(10)
    v_mfma_f32_16x16x32_bf16 v[80:83], v[4:7], v[16:19], v[80:83]
    ds_read_b64_tr_b16 v[62:63], v227 offset:4608
    ds_read_b128 v[36:39], v221 offset:512
    v_mfma_f32_16x16x32_bf16 v[84:87], v[4:7], v[20:23], v[84:87]
    ds_read_b128 v[40:43], v221 offset:4096
    ds_read_b128 v[44:47], v221 offset:4608
    v_mfma_f32_16x16x32_bf16 v[88:91], v[4:7], v[24:27], v[88:91]
    v_mfma_f32_16x16x32_bf16 v[92:95], v[4:7], v[28:31], v[92:95]
    s_waitcnt lgkmcnt(9)
    v_mfma_f32_16x16x32_bf16 v[64:67], v[32:35], v[48:51], v[64:67]
    s_waitcnt lgkmcnt(2)
    v_mfma_f32_16x16x32_bf16 v[80:83], v[36:39], v[48:51], v[80:83]
    v_mfma_f32_16x16x32_bf16 v[68:71], v[32:35], v[52:55], v[68:71]
    v_mfma_f32_16x16x32_bf16 v[84:87], v[36:39], v[52:55], v[84:87]
    v_mfma_f32_16x16x32_bf16 v[72:75], v[32:35], v[56:59], v[72:75]
    v_mfma_f32_16x16x32_bf16 v[88:91], v[36:39], v[56:59], v[88:91]
    v_mfma_f32_16x16x32_bf16 v[76:79], v[32:35], v[60:63], v[76:79]
    v_mfma_f32_16x16x32_bf16 v[92:95], v[36:39], v[60:63], v[92:95]
    v_mfma_f32_16x16x32_bf16 v[96:99], v[8:11], v[16:19], v[96:99]
    v_mfma_f32_16x16x32_bf16 v[100:103], v[8:11], v[20:23], v[100:103]
    v_mfma_f32_16x16x32_bf16 v[104:107], v[8:11], v[24:27], v[104:107]
    v_cvt_pk_bf16_f32 v128, v64, v65
    v_mfma_f32_16x16x32_bf16 v[108:111], v[8:11], v[28:31], v[108:111]
    v_cvt_pk_bf16_f32 v129, v66, v67
    v_mfma_f32_16x16x32_bf16 v[112:115], v[12:15], v[16:19], v[112:115]
    v_cvt_pk_bf16_f32 v130, v80, v81
    v_cvt_pk_bf16_f32 v131, v82, v83
    v_mfma_f32_16x16x32_bf16 v[116:119], v[12:15], v[20:23], v[116:119]
    buffer_store_dwordx4 v[128:131], v250, s[24:27], s65 offen sc1
    v_mfma_f32_16x16x32_bf16 v[120:123], v[12:15], v[24:27], v[120:123]
    v_cvt_pk_bf16_f32 v132, v68, v69
    v_cvt_pk_bf16_f32 v133, v70, v71
    v_mfma_f32_16x16x32_bf16 v[124:127], v[12:15], v[28:31], v[124:127]
    v_cvt_pk_bf16_f32 v134, v84, v85
    s_waitcnt lgkmcnt(1)
    v_mfma_f32_16x16x32_bf16 v[96:99], v[40:43], v[48:51], v[96:99]
    v_cvt_pk_bf16_f32 v135, v86, v87
    buffer_store_dwordx4 v[132:135], v250, s[24:27], s65 offen offset:256 sc1
    s_waitcnt lgkmcnt(0)
    v_mfma_f32_16x16x32_bf16 v[112:115], v[44:47], v[48:51], v[112:115]
    v_cvt_pk_bf16_f32 v136, v72, v73
    v_mfma_f32_16x16x32_bf16 v[100:103], v[40:43], v[52:55], v[100:103]
    v_cvt_pk_bf16_f32 v137, v74, v75
    v_mfma_f32_16x16x32_bf16 v[116:119], v[44:47], v[52:55], v[116:119]
    v_cvt_pk_bf16_f32 v138, v88, v89
    v_cvt_pk_bf16_f32 v139, v90, v91
    v_mfma_f32_16x16x32_bf16 v[104:107], v[40:43], v[56:59], v[104:107]
    buffer_store_dwordx4 v[136:139], v250, s[24:27], s65 offen offset:512 sc1
    v_mfma_f32_16x16x32_bf16 v[120:123], v[44:47], v[56:59], v[120:123]
    v_cvt_pk_bf16_f32 v140, v76, v77
    v_cvt_pk_bf16_f32 v141, v78, v79
    v_mfma_f32_16x16x32_bf16 v[108:111], v[40:43], v[60:63], v[108:111]
    v_cvt_pk_bf16_f32 v142, v92, v93
    v_mfma_f32_16x16x32_bf16 v[124:127], v[44:47], v[60:63], v[124:127]
    v_cvt_pk_bf16_f32 v143, v94, v95
    buffer_store_dwordx4 v[140:143], v250, s[24:27], s65 offen offset:768 sc1
    s_nop 1
    v_cvt_pk_bf16_f32 v144, v96, v97
    v_cvt_pk_bf16_f32 v145, v98, v99
    v_cvt_pk_bf16_f32 v146, v112, v113
    v_cvt_pk_bf16_f32 v147, v114, v115
    buffer_store_dwordx4 v[144:147], v250, s[24:27], s66 offen sc1
    v_cvt_pk_bf16_f32 v148, v100, v101
    v_cvt_pk_bf16_f32 v149, v102, v103
    v_cvt_pk_bf16_f32 v150, v116, v117
    v_cvt_pk_bf16_f32 v151, v118, v119
    buffer_store_dwordx4 v[148:151], v250, s[24:27], s66 offen offset:256 sc1
    v_cvt_pk_bf16_f32 v152, v104, v105
    v_cvt_pk_bf16_f32 v153, v106, v107
    v_cvt_pk_bf16_f32 v154, v120, v121
    v_cvt_pk_bf16_f32 v155, v122, v123
    buffer_store_dwordx4 v[152:155], v250, s[24:27], s66 offen offset:512 sc1
    v_cvt_pk_bf16_f32 v156, v108, v109
    v_cvt_pk_bf16_f32 v157, v110, v111
    v_cvt_pk_bf16_f32 v158, v124, v125
    v_cvt_pk_bf16_f32 v159, v126, v127
    buffer_store_dwordx4 v[156:159], v250, s[24:27], s66 offen offset:768 sc1
    s_branch K2_p1done
K2_idle:
    s_barrier
    s_barrier
    s_barrier
    s_barrier
    s_barrier
    s_barrier
    s_barrier
    s_barrier
    s_barrier
    buffer_load_dword v246, off, s[12:15], 0 sc1
    s_mov_b32 s5, 131072
K2_tag_4:
    s_waitcnt vmcnt(0)
    v_readfirstlane_b32 s53, v246
    s_cmp_lg_u32 s53, 0
    s_cbranch_scc1 K2_tag_4_d
    s_sleep 8
    buffer_load_dword v246, off, s[12:15], 0 sc1
    s_sub_u32 s5, s5, 1
    s_cbranch_scc0 K2_tag_4
K2_tag_4_d:
    s_mov_b32 s61, 2147483392
    s_branch K2_p1done
K2_idle2:
    s_load_dwordx2 s[68:69], s[0:1], 16
    s_mov_b32 s70, 663552
    s_mov_b32 s71, 0x00020000
    s_bfe_u32 s5, s2, 0x10003
    v_mul_u32_u24 v0, 6554, v239
    v_lshrrev_b32 v0, 16, v0
    v_mul_u32_u24 v1, 992, v0
    s_mul_i32 s6, s40, 144
    s_mul_i32 s7, s5, 18
    s_add_u32 s6, s6, s7
    s_mul_i32 s4, s6, 1152
    s_mul_i32 s10, s3, 144
    s_add_u32 s4, s4, s10
    v_add3_u32 v2, v1, v237, s4
    s_mul_i32 s6, s6, 160
    s_mul_i32 s7, s7, 160
    s_mov_b32 s10, 0xdff7fdff
    s_mov_b32 s11, 0x7fdff7f
    s_waitcnt lgkmcnt(0)
    s_mov_b64 exec, s[10:11]
    s_add_u32 m0, s6, 0
    s_mov_b32 s67, 0
    buffer_load_dwordx4 v2, s[68:71], s67 offen lds
    s_add_u32 m0, s6, 960
    s_mov_b32 s67, 6912
    buffer_load_dwordx4 v2, s[68:71], s67 offen lds
    s_add_u32 m0, s6, 1920
    s_mov_b32 s67, 13824
    buffer_load_dwordx4 v2, s[68:71], s67 offen lds
    s_add_u32 m0, s6, 5760
    s_mov_b32 s67, 41472
    buffer_load_dwordx4 v2, s[68:71], s67 offen lds
    s_add_u32 m0, s6, 6720
    s_mov_b32 s67, 48384
    buffer_load_dwordx4 v2, s[68:71], s67 offen lds
    s_add_u32 m0, s6, 7680
    s_mov_b32 s67, 55296
    buffer_load_dwordx4 v2, s[68:71], s67 offen lds
    s_add_u32 m0, s6, 11520
    s_mov_b32 s67, 82944
    buffer_load_dwordx4 v2, s[68:71], s67 offen lds
    s_add_u32 m0, s6, 12480
    s_mov_b32 s67, 89856
    buffer_load_dwordx4 v2, s[68:71], s67 offen lds
    s_add_u32 m0, s6, 13440
    s_mov_b32 s67, 96768
    buffer_load_dwordx4 v2, s[68:71], s67 offen lds
    s_add_u32 m0, s6, 17280
    s_mov_b32 s67, 124416
    buffer_load_dwordx4 v2, s[68:71], s67 offen lds
    s_add_u32 m0, s6, 18240
    s_mov_b32 s67, 131328
    buffer_load_dwordx4 v2, s[68:71], s67 offen lds
    s_add_u32 m0, s6, 19200
    s_mov_b32 s67, 138240
    buffer_load_dwordx4 v2, s[68:71], s67 offen lds
    s_mov_b64 exec, -1
    v_lshrrev_b32 v4, 4, v239
    v_and_b32 v6, 1, v4
    v_bfe_u32 v7, v239, 2, 2
    v_lshrrev_b32 v5, 1, v4
    v_mul_u32_u24 v5, 36, v5
    v_lshl_add_u32 v5, v6, 2, v5
    v_add_u32 v5, v5, v7
    v_mul_u32_u24 v5, 160, v5
    v_add_u32 v5, s6, v5
    v_and_b32 v8, 3, v239
    v_and_b32 v9, 1, v239
    v_lshl_add_u32 v10, v8, 3, v5
    v_lshl_add_u32 v11, v9, 3, v5
    v_lshrrev_b32 v5, 1, v7
    v_lshl_add_u32 v5, v4, 2, v5
    v_mul_u32_u24 v5, 36, v5
    v_and_b32 v7, 1, v7
    v_add3_u32 v5, v5, v7, 16
    v_mul_u32_u24 v5, 160, v5
    v_add_u32 v5, s7, v5
    v_lshl_add_u32 v12, v8, 3, v5
    s_lshl_b32 s4, s40, 5
    v_add_u32 v12, s4, v12
    v_lshl_add_u32 v13, v9, 3, v5
    s_lshl_b32 s4, s3, 1
    s_add_u32 s4, s4, s5
    s_lshl_b32 s61, s4, 5
    s_add_u32 s61, s61, 10903552
    v_and_b32 v162, 7, v239
    v_lshlrev_b32 v162, 2, v162
    s_mul_i32 s4, s4, 46080
    s_add_u32 s7, s4, 14721024
    s_mul_i32 s6, s40, 10240
    s_add_u32 s6, s6, s4
    s_add_u32 s6, s6, 14680064
    s_lshl_b32 s10, s40, 10
    s_add_u32 s10, s10, s7
    s_add_u32 s7, s7, 4096
    s_waitcnt vmcnt(0)
    s_barrier
    buffer_load_dword v246, off, s[12:15], 0 sc1
    ds_read_b64_tr_b16 v[16:17], v10
    ds_read_b64_tr_b16 v[18:19], v10 offset:1280
    ds_read_b64_tr_b16 v[20:21], v10 offset:32
    ds_read_b64_tr_b16 v[22:23], v10 offset:1312
    ds_read_b64_tr_b16 v[24:25], v10 offset:64
    ds_read_b64_tr_b16 v[26:27], v10 offset:1344
    ds_read_b64_tr_b16 v[28:29], v10 offset:96
    ds_read_b64_tr_b16 v[30:31], v10 offset:1376
    ds_read_b64_tr_b16 v[32:33], v11 offset:128
    ds_read_b64_tr_b16 v[34:35], v11 offset:1408
    ds_read_b64_tr_b16 v[36:37], v10 offset:11520
    ds_read_b64_tr_b16 v[38:39], v10 offset:12800
    ds_read_b64_tr_b16 v[40:41], v10 offset:11552
    ds_read_b64_tr_b16 v[42:43], v10 offset:12832
    ds_read_b64_tr_b16 v[44:45], v10 offset:11584
    ds_read_b64_tr_b16 v[46:47], v10 offset:12864
    ds_read_b64_tr_b16 v[48:49], v10 offset:11616
    ds_read_b64_tr_b16 v[50:51], v10 offset:12896
    ds_read_b64_tr_b16 v[52:53], v11 offset:11648
    ds_read_b64_tr_b16 v[54:55], v11 offset:12928
    ds_read_b64_tr_b16 v[56:57], v12
    ds_read_b64_tr_b16 v[58:59], v12 offset:11520
    ds_read_b64_tr_b16 v[60:61], v13 offset:128
    ds_read_b64_tr_b16 v[62:63], v13 offset:11648
    s_mov_b32 s5, 131072
K2_tag_5:
    s_waitcnt vmcnt(0)
    v_readfirstlane_b32 s53, v246
    s_cmp_lg_u32 s53, 0
    s_cbranch_scc1 K2_tag_5_d
    s_sleep 8
    buffer_load_dword v246, off, s[12:15], 0 sc1
    s_sub_u32 s5, s5, 1
    s_cbranch_scc0 K2_tag_5
K2_tag_5_d:
    s_waitcnt lgkmcnt(0)
    buffer_store_dwordx4 v[16:19], v237, s[24:27], s6 offen sc1
    buffer_store_dwordx4 v[20:23], v237, s[24:27], s6 offen offset:1024 sc1
    buffer_store_dwordx4 v[24:27], v237, s[24:27], s6 offen offset:2048 sc1
    buffer_store_dwordx4 v[28:31], v237, s[24:27], s6 offen offset:3072 sc1
    s_add_u32 s6, s6, 4096
    buffer_store_dwordx4 v[32:35], v237, s[24:27], s6 offen sc1
    buffer_store_dwordx4 v[36:39], v237, s[24:27], s6 offen offset:1024 sc1
    buffer_store_dwordx4 v[40:43], v237, s[24:27], s6 offen offset:2048 sc1
    buffer_store_dwordx4 v[44:47], v237, s[24:27], s6 offen offset:3072 sc1
    s_add_u32 s6, s6, 4096
    buffer_store_dwordx4 v[48:51], v237, s[24:27], s6 offen sc1
    buffer_store_dwordx4 v[52:55], v237, s[24:27], s6 offen offset:1024 sc1
    buffer_store_dwordx4 v[56:59], v237, s[24:27], s10 offen sc1
    buffer_store_dwordx4 v[60:63], v237, s[24:27], s7 offen sc1
    s_branch K2_p1done
K2_rg:
    v_lshrrev_b32 v1, 4, v239
    v_and_b32 v2, 31, v239
    v_and_b32 v3, 1, v239
    v_lshlrev_b32 v3, 11, v3
    v_lshl_add_u32 v3, v1, 4, v3
    v_add_u32 v224, 131072, v3
    s_lshl_b32 s4, s71, 5
    v_add_u32 v225, s4, v2
    v_cmp_lt_u32 vcc, 15, v2
    s_waitcnt vmcnt(0)
    s_barrier
    ds_read_b128 v[16:19], v224
    ds_read_b128 v[0:3], v220
    ds_read_b128 v[4:7], v220 offset:2048
    ds_read_b128 v[48:51], v224 offset:64
    ds_read_b128 v[32:35], v221
    ds_read_b128 v[36:39], v221 offset:2048
    s_waitcnt lgkmcnt(3)
    v_mfma_f32_16x16x32_bf16 v[64:67], v[16:19], v[0:3], 0
    v_mfma_f32_16x16x32_bf16 v[68:71], v[16:19], v[4:7], 0
    s_waitcnt lgkmcnt(0)
    v_mfma_f32_16x16x32_bf16 v[64:67], v[48:51], v[32:35], v[64:67]
    v_mfma_f32_16x16x32_bf16 v[68:71], v[48:51], v[36:39], v[68:71]
    s_barrier
    ds_read_b128 v[16:19], v224 offset:128
    ds_read_b128 v[0:3], v220 offset:32768
    ds_read_b128 v[4:7], v220 offset:34816
    ds_read_b128 v[48:51], v224 offset:192
    ds_read_b128 v[32:35], v221 offset:32768
    ds_read_b128 v[36:39], v221 offset:34816
    s_waitcnt lgkmcnt(3)
    v_mfma_f32_16x16x32_bf16 v[64:67], v[16:19], v[0:3], v[64:67]
    v_mfma_f32_16x16x32_bf16 v[68:71], v[16:19], v[4:7], v[68:71]
    s_waitcnt lgkmcnt(0)
    v_mfma_f32_16x16x32_bf16 v[64:67], v[48:51], v[32:35], v[64:67]
    v_mfma_f32_16x16x32_bf16 v[68:71], v[48:51], v[36:39], v[68:71]
    s_barrier
    ds_read_b128 v[16:19], v224 offset:256
    ds_read_b128 v[0:3], v222
    ds_read_b128 v[4:7], v222 offset:2048
    ds_read_b128 v[48:51], v224 offset:320
    ds_read_b128 v[32:35], v223
    ds_read_b128 v[36:39], v223 offset:2048
    s_waitcnt lgkmcnt(3)
    v_mfma_f32_16x16x32_bf16 v[64:67], v[16:19], v[0:3], v[64:67]
    v_mfma_f32_16x16x32_bf16 v[68:71], v[16:19], v[4:7], v[68:71]
    s_waitcnt lgkmcnt(0)
    v_mfma_f32_16x16x32_bf16 v[64:67], v[48:51], v[32:35], v[64:67]
    v_mfma_f32_16x16x32_bf16 v[68:71], v[48:51], v[36:39], v[68:71]
    s_barrier
    ds_read_b128 v[16:19], v224 offset:384
    ds_read_b128 v[0:3], v222 offset:32768
    ds_read_b128 v[4:7], v222 offset:34816
    ds_read_b128 v[48:51], v224 offset:448
    ds_read_b128 v[32:35], v223 offset:32768
    ds_read_b128 v[36:39], v223 offset:34816
    s_waitcnt lgkmcnt(3)
    v_mfma_f32_16x16x32_bf16 v[64:67], v[16:19], v[0:3], v[64:67]
    v_mfma_f32_16x16x32_bf16 v[68:71], v[16:19], v[4:7], v[68:71]
    s_waitcnt lgkmcnt(0)
    v_mfma_f32_16x16x32_bf16 v[64:67], v[48:51], v[32:35], v[64:67]
    v_mfma_f32_16x16x32_bf16 v[68:71], v[48:51], v[36:39], v[68:71]
    s_barrier
    ds_read_b128 v[16:19], v224 offset:512
    ds_read_b128 v[0:3], v220
    ds_read_b128 v[4:7], v220 offset:2048
    ds_read_b128 v[48:51], v224 offset:576
    ds_read_b128 v[32:35], v221
    ds_read_b128 v[36:39], v221 offset:2048
    s_waitcnt lgkmcnt(3)
    v_mfma_f32_16x16x32_bf16 v[64:67], v[16:19], v[0:3], v[64:67]
    v_mfma_f32_16x16x32_bf16 v[68:71], v[16:19], v[4:7], v[68:71]
    s_waitcnt lgkmcnt(0)
    v_mfma_f32_16x16x32_bf16 v[64:67], v[48:51], v[32:35], v[64:67]
    v_mfma_f32_16x16x32_bf16 v[68:71], v[48:51], v[36:39], v[68:71]
    s_barrier
    buffer_load_dword v246, off, s[12:15], 0 sc1
    ds_read_b128 v[16:19], v224 offset:640
    ds_read_b128 v[0:3], v220 offset:32768
    ds_read_b128 v[4:7], v220 offset:34816
    ds_read_b128 v[48:51], v224 offset:704
    ds_read_b128 v[32:35], v221 offset:32768
    ds_read_b128 v[36:39], v221 offset:34816
    s_waitcnt lgkmcnt(3)
    v_mfma_f32_16x16x32_bf16 v[64:67], v[16:19], v[0:3], v[64:67]
    v_mfma_f32_16x16x32_bf16 v[68:71], v[16:19], v[4:7], v[68:71]
    s_waitcnt lgkmcnt(0)
    v_mfma_f32_16x16x32_bf16 v[64:67], v[48:51], v[32:35], v[64:67]
    v_mfma_f32_16x16x32_bf16 v[68:71], v[48:51], v[36:39], v[68:71]
    s_barrier
    ds_read_b128 v[16:19], v224 offset:768
    ds_read_b128 v[0:3], v222
    ds_read_b128 v[4:7], v222 offset:2048
    ds_read_b128 v[48:51], v224 offset:832
    ds_read_b128 v[32:35], v223
    ds_read_b128 v[36:39], v223 offset:2048
    s_waitcnt lgkmcnt(3)
    v_mfma_f32_16x16x32_bf16 v[64:67], v[16:19], v[0:3], v[64:67]
    v_mfma_f32_16x16x32_bf16 v[68:71], v[16:19], v[4:7], v[68:71]
    s_waitcnt lgkmcnt(0)
    v_mfma_f32_16x16x32_bf16 v[64:67], v[48:51], v[32:35], v[64:67]
    v_mfma_f32_16x16x32_bf16 v[68:71], v[48:51], v[36:39], v[68:71]
    s_barrier
    ds_read_b128 v[16:19], v224 offset:896
    ds_read_b128 v[0:3], v222 offset:32768
    ds_read_b128 v[4:7], v222 offset:34816
    ds_read_b128 v[48:51], v224 offset:960
    ds_read_b128 v[32:35], v223 offset:32768
    ds_read_b128 v[36:39], v223 offset:34816
    s_waitcnt lgkmcnt(3)
    v_mfma_f32_16x16x32_bf16 v[64:67], v[16:19], v[0:3], v[64:67]
    v_mfma_f32_16x16x32_bf16 v[68:71], v[16:19], v[4:7], v[68:71]
    s_waitcnt lgkmcnt(0)
    v_mfma_f32_16x16x32_bf16 v[64:67], v[48:51], v[32:35], v[64:67]
    v_mfma_f32_16x16x32_bf16 v[68:71], v[48:51], v[36:39], v[68:71]
    s_barrier
    ds_read_b128 v[16:19], v224 offset:1024
    ds_read_b128 v[0:3], v220
    ds_read_b128 v[4:7], v220 offset:2048
    ds_read_b128 v[48:51], v224 offset:1088
    ds_read_b128 v[32:35], v221
    ds_read_b128 v[36:39], v221 offset:2048
    s_waitcnt lgkmcnt(3)
    v_mfma_f32_16x16x32_bf16 v[64:67], v[16:19], v[0:3], v[64:67]
    v_mfma_f32_16x16x32_bf16 v[68:71], v[16:19], v[4:7], v[68:71]
    s_waitcnt lgkmcnt(0)
    v_mfma_f32_16x16x32_bf16 v[64:67], v[48:51], v[32:35], v[64:67]
    v_mfma_f32_16x16x32_bf16 v[68:71], v[48:51], v[36:39], v[68:71]
    s_mov_b32 s5, 131072
K2_tag_6:
    s_waitcnt vmcnt(0)
    v_readfirstlane_b32 s53, v246
    s_cmp_lg_u32 s53, 0
    s_cbranch_scc1 K2_tag_6_d
    s_sleep 8
    buffer_load_dword v246, off, s[12:15], 0 sc1
    s_sub_u32 s5, s5, 1
    s_cbranch_scc0 K2_tag_6
K2_tag_6_d:
    s_nop 3
    v_cndmask_b32 v64, v64, v68, vcc
    v_cndmask_b32 v65, v65, v69, vcc
    s_mov_b32 s5, 0xffff0000
    v_cvt_pk_bf16_f32 v6, v65, v64
    v_lshlrev_b32 v4, 16, v6
    v_mul_f32 v4, 3216550459, v4
    v_exp_f32 v4, v4
    v_ashrrev_i32 v7, 31, v6
    v_add_f32 v4, 1.0, v4
    v_rcp_f32 v4, v4
    v_or_b32 v7, 0x80000000, v7
    v_xor_b32 v6, v6, v7
    v_and_b32 v6, s5, v6
    v_sub_u32 v7, 0xffff, v225
    v_or_b32 v6, v6, v7
    v_cvt_pk_bf16_f32 v4, v4, v4
    v_and_b32 v4, s5, v4
    v_mov_b32 v5, s53
    v_lshlrev_b32 v7, 3, v225
    s_mov_b32 s4, 7307264
    buffer_store_dwordx2 v[4:5], v7, s[24:27], s4 offen sc1
    s_nop 1
    v_max_u32_dpp v7, v6, v6 quad_perm:[1,0,3,2] row_mask:0xf bank_mask:0xf
    s_nop 1
    v_max_u32_dpp v7, v7, v7 quad_perm:[2,3,0,1] row_mask:0xf bank_mask:0xf
    s_nop 1
    v_max_u32_dpp v7, v7, v7 row_half_mirror row_mask:0xf bank_mask:0xf
    s_nop 1
    v_max_u32_dpp v7, v7, v7 row_mirror row_mask:0xf bank_mask:0xf
    s_nop 1
    v_max_u32_dpp v7, v7, v7 row_bcast:15 row_mask:0xa bank_mask:0xf
    s_nop 1
    v_max_u32_dpp v7, v7, v7 row_bcast:31 row_mask:0xc bank_mask:0xf
    s_nop 1
    v_readlane_b32 s6, v7, 63
    s_nop 1
    v_cmp_ne_u32 vcc, s6, v6
    s_nop 1
    v_cndmask_b32 v6, 0, v6, vcc
    s_nop 1
    v_max_u32_dpp v7, v6, v6 quad_perm:[1,0,3,2] row_mask:0xf bank_mask:0xf
    s_nop 1
    v_max_u32_dpp v7, v7, v7 quad_perm:[2,3,0,1] row_mask:0xf bank_mask:0xf
    s_nop 1
    v_max_u32_dpp v7, v7, v7 row_half_mirror row_mask:0xf bank_mask:0xf
    s_nop 1
    v_max_u32_dpp v7, v7, v7 row_mirror row_mask:0xf bank_mask:0xf
    s_nop 1
    v_max_u32_dpp v7, v7, v7 row_bcast:15 row_mask:0xa bank_mask:0xf
    s_nop 1
    v_max_u32_dpp v7, v7, v7 row_bcast:31 row_mask:0xc bank_mask:0xf
    s_nop 1
    v_readlane_b32 s7, v7, 63
    s_lshl_b32 s4, s71, 4
    s_add_u32 s4, s4, 7323648
    v_mov_b32 v8, s6
    v_mov_b32 v9, s53
    v_mov_b32 v10, s7
    v_mov_b32 v11, s53
    s_mov_b64 exec, 1
    buffer_store_dwordx4 v[8:11], off, s[24:27], s4 sc1
    s_mov_b64 exec, -1
    s_mov_b32 s61, 2147483392
K2_p1done:
    s_mov_b32 s55, s61
    v_and_b32 v4, 31, v239
    v_or_b32 v5, 4, v4
    v_cmp_eq_u32 vcc, 21, v5
    v_mov_b32 v6, 0x3afe3f80
    v_mov_b32 v8, 0x3f803f80
    v_cndmask_b32 v6, 0, v6, vcc
    v_mov_b32 v7, 0
    v_mov_b32 v9, 0
    v_mov_b32 v10, 0
    v_mov_b32 v11, 0
    v_mfma_f32_32x32x4_2b_bf16 v[170:201], v[8:9], v[6:7], 0
    v_mfma_f32_32x32x4_2b_bf16 v[202:233], v[8:9], v[6:7], 0
    v_mfma_f32_32x32x4_2b_bf16 v[64:95], v[10:11], v[10:11], 0
    v_mfma_f32_32x32x4_2b_bf16 v[96:127], v[10:11], v[10:11], 0
    s_nop 3
    s_mul_i32 s4, s40, 14336
    s_add_u32 s4, s4, 0
    v_add_u32 v243, s4, v237
    s_xor_b32 s4, s40, 3
    s_mul_i32 s4, s4, 14336
    s_add_u32 s4, s4, 0
    v_add_u32 v247, s4, v237
    s_xor_b32 s4, s40, 2
    s_mul_i32 s4, s4, 14336
    s_add_u32 s4, s4, 0
    v_add_u32 v248, s4, v237
    s_xor_b32 s4, s40, 1
    s_mul_i32 s4, s4, 14336
    s_add_u32 s4, s4, 0
    v_add_u32 v249, s4, v237
    v_bfe_u32 v244, v239, 4, 1
    v_lshlrev_b32 v244, 14, v244
    v_lshrrev_b32 v245, 5, v239
    v_lshl_add_u32 v244, v245, 8, v244
    v_and_b32 v245, 0xff, v237
    v_add_u32 v244, v244, v245
    v_and_b32 v245, 31, v239
    v_lshlrev_b32 v245, 2, v245
    s_lshl_b32 s4, s39, 6
    s_lshl_b32 s5, s37, 2
    s_add_u32 s4, s4, s5
    s_add_u32 s4, s4, s40
    s_lshl_b32 s5, s4, 1
    s_and_b32 s6, s40, 1
    s_sub_u32 s5, s5, s6
    s_lshl_b32 s5, s5, 13
    s_lshl_b32 s6, s43, 9
    s_add_u32 s5, s5, s6
    s_add_u32 s65, s5, 7340032
    s_lshl_b32 s4, s4, 4
    s_add_u32 s4, s4, s43
    s_lshl_b32 s4, s4, 7
    s_add_u32 s66, s4, 9437184
    s_lshl_b32 s4, s37, 10
    s_lshr_b32 s5, s40, 1
    s_lshl_b32 s5, s5, 9
    s_add_u32 s4, s4, s5
    s_and_b32 s5, s40, 1
    s_lshl_b32 s5, s5, 7
    s_add_u32 s4, s4, s5
    s_add_u32 s52, s4, 7307264
    s_lshl2_add_u32 s4, s37, s40
    s_lshl_b32 s4, s4, 7
    s_lshl2_add_u32 s4, s43, s4
    s_add_u32 s61, s4, 10485760
    v_mov_b32 v255, 163328
    v_mov_b32 v254, 1
    s_lshl_b32 s32, s43, 3
    s_and_b32 s4, s37, 1
    s_lshl_b32 s4, s4, 2
    s_add_u32 s32, s32, s4
    s_add_u32 s32, s32, s40
    s_lshr_b32 s33, s37, 1
    s_mul_i32 s33, s33, 144
    s_mul_i32 s34, s32, 18432
    s_add_u32 s34, s34, s33
    s_mul_i32 s35, s33, 640
    s_add_u32 s35, s35, 14680064
    s_mul_i32 s4, s40, 3072
    s_add_u32 s97, s4, 94208
    s_lshl_b32 s4, s32, 13
    s_add_u32 s98, s4, 7340032
    s_add_u32 s101, s98, 4096
    s_lshr_b32 s4, s32, 2
    s_lshl_b32 s4, s4, 1
    s_and_b32 s5, s40, 1
    s_add_u32 s4, s4, s5
    s_lshl_b32 s5, s4, 7
    s_add_u32 s100, s5, 10485760
    s_lshl_b32 s4, s4, 11
    s_lshr_b32 s5, s40, 1
    s_lshl_b32 s5, s5, 6
    s_add_u32 s4, s4, s5
    s_add_u32 s99, s4, 9437184
    s_mul_i32 s4, s40, 5120
    s_add_u32 s4, s4, 106496
    v_add_u32 v235, s4, v237
    s_cmp_lg_u32 s40, 0
    s_waitcnt vmcnt(0)
    s_barrier
    s_cbranch_scc1 K2_noflag
    s_mov_b64 exec, 0xffffff
    buffer_store_dword v246, v162, s[24:27], s55 offen sc1
    s_mov_b64 exec, -1
K2_noflag:
    s_cmp_lg_u32 s40, 1
    s_cbranch_scc1 K2_p1seen
    s_mov_b32 s5, 131072
    s_cmp_lt_u32 s2, 224
    s_cbranch_scc0 K2_p1gate0
    s_sleep 20
    s_branch K2_p1poll
K2_p1gate0:
    s_mov_b64 exec, 15
K2_p1gate:
    s_sleep 3
    buffer_load_dword v12, v252, s[24:27], 0 offen sc1
    s_sub_u32 s5, s5, 1
    s_cbranch_scc1 K2_p1open
    s_waitcnt vmcnt(0)
    v_cmp_ne_u32 vcc, s53, v12
    s_cbranch_vccnz K2_p1gate
K2_p1open:
    s_mov_b64 exec, -1
    s_mov_b32 s5, 131072
K2_p1poll:
    buffer_load_dword v12, v252, s[24:27], 0 offen sc1
    buffer_load_dword v13, v253, s[24:27], 0 offen sc1
    s_sub_u32 s5, s5, 1
    s_cbranch_scc1 K2_p1seen
    s_waitcnt vmcnt(0)
    v_cmp_ne_u32 vcc, s53, v12
    v_cmp_ne_u32 s[6:7], s53, v13
    s_or_b64 vcc, vcc, s[6:7]
    s_cbranch_scc0 K2_p1seen
    s_branch K2_p1poll
K2_p1seen:
    s_barrier
    buffer_load_dwordx4 v[48:51], v251, s[24:27], s60 offen sc1
    buffer_load_dwordx4 v[148:151], v242, s[24:27], s44 offen sc1
    buffer_load_dwordx4 v[164:167], v240, s[24:27], s44 offen sc1
    buffer_load_dwordx4 v[170:173], v240, s[24:27], s44 offen offset:256 sc1
    buffer_load_dwordx4 v[32:35], v240, s[24:27], s56 offen sc1
    buffer_load_dwordx4 v[36:39], v240, s[24:27], s56 offen offset:256 sc1
    buffer_load_dwordx4 v[40:43], v240, s[24:27], s57 offen sc1
    buffer_load_dwordx4 v[44:47], v240, s[24:27], s57 offen offset:256 sc1
    s_mov_b64 exec, s[62:63]
    buffer_load_dwordx4 v[194:197], v238, s[24:27], s44 offen sc1
    buffer_load_dwordx4 v[198:201], v238, s[24:27], s45 offen sc1
    buffer_load_dwordx4 v[202:205], v241, s[24:27], s44 offen sc1
    buffer_load_dwordx4 v[206:209], v241, s[24:27], s45 offen sc1
    s_mov_b64 exec, -1
    buffer_load_dwordx4 v[174:177], v240, s[24:27], s46 offen sc1
    buffer_load_dwordx4 v[180:183], v240, s[24:27], s46 offen offset:256 sc1
    s_mov_b64 exec, s[62:63]
    buffer_load_dwordx4 v[210:213], v238, s[24:27], s46 offen sc1
    buffer_load_dwordx4 v[214:217], v238, s[24:27], s47 offen sc1
    s_mov_b64 exec, -1
    s_barrier
    v_mov_b32 v236, 0xdddddddd
    s_bitcmp0_b32 s36, 0
    s_cselect_b32 s4, -1, 0
    s_cselect_b32 s5, 0, -1
    s_bitcmp1_b32 s40, 0
    s_cbranch_scc1 K2_qsel_7
    s_waitcnt vmcnt(14)
    v_and_b32 v144, s4, v50
    v_and_b32 v145, s5, v51
    v_and_b32 v146, s4, v48
    v_and_b32 v147, s5, v49
    v_mfma_f32_32x32x4_2b_bf16 v[0:31], v[148:149], v[144:145], 0 cbsz:1 abid:0
    s_nop 11
    s_waitcnt vmcnt(10)
    v_mov_b64 v[168:169], v[164:165]
    v_mov_b64 v[128:129], v[34:35]
    v_mov_b64 v[130:131], v[38:39]
    v_mov_b64 v[132:133], v[32:33]
    v_mov_b64 v[134:135], v[36:37]
    v_mfma_f32_32x32x16_bf16 v[0:15], v[168:171], v[128:131], v[0:15]
    s_waitcnt vmcnt(8)
    v_mov_b64 v[136:137], v[42:43]
    v_mov_b64 v[138:139], v[46:47]
    v_mov_b64 v[140:141], v[40:41]
    v_mov_b64 v[142:143], v[44:45]
    v_mfma_f32_32x32x16_bf16 v[16:31], v[168:171], v[136:139], v[16:31]
    s_branch K2_qsel_7_d
K2_qsel_7:
    s_waitcnt vmcnt(14)
    v_and_b32 v144, s4, v48
    v_and_b32 v145, s5, v49
    v_and_b32 v146, s4, v50
    v_and_b32 v147, s5, v51
    v_mfma_f32_32x32x4_2b_bf16 v[0:31], v[148:149], v[144:145], 0 cbsz:1 abid:0
    s_nop 11
    s_waitcnt vmcnt(10)
    v_mov_b64 v[168:169], v[164:165]
    v_mov_b64 v[128:129], v[32:33]
    v_mov_b64 v[130:131], v[36:37]
    v_mov_b64 v[132:133], v[34:35]
    v_mov_b64 v[134:135], v[38:39]
    v_mfma_f32_32x32x16_bf16 v[0:15], v[168:171], v[128:131], v[0:15]
    s_waitcnt vmcnt(8)
    v_mov_b64 v[136:137], v[40:41]
    v_mov_b64 v[138:139], v[44:45]
    v_mov_b64 v[140:141], v[42:43]
    v_mov_b64 v[142:143], v[46:47]
    v_mfma_f32_32x32x16_bf16 v[16:31], v[168:171], v[136:139], v[16:31]
K2_qsel_7_d:
    s_nop 4
    s_setprio 1
    v_exp_f32 v0, v0
    v_exp_f32 v1, v1
    v_exp_f32 v2, v2
    v_exp_f32 v3, v3
    v_exp_f32 v4, v4
    v_mfma_f32_32x32x4_2b_bf16 v[32:63], v[148:149], v[146:147], 0 cbsz:1 abid:0
    v_exp_f32 v5, v5
    v_exp_f32 v6, v6
    v_exp_f32 v7, v7
    v_exp_f32 v8, v8
    v_exp_f32 v9, v9
    v_exp_f32 v10, v10
    v_exp_f32 v11, v11
    v_exp_f32 v12, v12
    s_waitcnt vmcnt(6)
    v_smfmac_f32_32x32x32_bf16 v[64:79], v[194:197], v[0:7], v236
    v_exp_f32 v13, v13
    v_exp_f32 v14, v14
    v_exp_f32 v15, v15
    v_exp_f32 v16, v16
    v_exp_f32 v17, v17
    v_smfmac_f32_32x32x32_bf16 v[64:79], v[198:201], v[8:15], v236
    v_exp_f32 v18, v18
    v_exp_f32 v19, v19
    v_exp_f32 v20, v20
    v_mfma_f32_32x32x16_bf16 v[32:47], v[168:171], v[132:135], v[32:47]
    v_exp_f32 v21, v21
    v_exp_f32 v22, v22
    v_exp_f32 v23, v23
    v_exp_f32 v24, v24
    v_exp_f32 v25, v25
    v_smfmac_f32_32x32x32_bf16 v[96:111], v[194:197], v[16:23], v236
    v_exp_f32 v26, v26
    v_exp_f32 v27, v27
    v_exp_f32 v28, v28
    v_mfma_f32_32x32x16_bf16 v[48:63], v[168:171], v[140:143], v[48:63]
    v_exp_f32 v29, v29
    v_exp_f32 v30, v30
    v_exp_f32 v31, v31
    v_exp_f32 v32, v32
    v_exp_f32 v33, v33
    v_smfmac_f32_32x32x32_bf16 v[96:111], v[198:201], v[24:31], v236
    s_waitcnt vmcnt(4)
    v_exp_f32 v34, v34
    v_exp_f32 v35, v35
    v_exp_f32 v36, v36
    v_mfma_f32_32x32x4_2b_bf16 v[0:31], v[150:151], v[144:145], 0 cbsz:1 abid:0
    v_exp_f32 v37, v37
    v_exp_f32 v38, v38
    v_exp_f32 v39, v39
    v_exp_f32 v40, v40
    v_exp_f32 v41, v41
    v_exp_f32 v42, v42
    v_mov_b64 v[168:169], v[172:173]
    v_exp_f32 v43, v43
    v_exp_f32 v44, v44
    v_smfmac_f32_32x32x32_bf16 v[80:95], v[194:197], v[32:39], v236
    v_exp_f32 v45, v45
    v_exp_f32 v46, v46
    v_exp_f32 v47, v47
    v_exp_f32 v48, v48
    v_exp_f32 v49, v49
    v_smfmac_f32_32x32x32_bf16 v[80:95], v[198:201], v[40:47], v236
    v_exp_f32 v50, v50
    v_exp_f32 v51, v51
    v_exp_f32 v52, v52
    v_mfma_f32_32x32x16_bf16 v[0:15], v[166:169], v[128:131], v[0:15]
    v_exp_f32 v53, v53
    v_exp_f32 v54, v54
    v_exp_f32 v55, v55
    v_exp_f32 v56, v56
    v_exp_f32 v57, v57
    v_smfmac_f32_32x32x32_bf16 v[112:127], v[194:197], v[48:55], v236
    v_exp_f32 v58, v58
    v_exp_f32 v59, v59
    v_exp_f32 v60, v60
    v_mfma_f32_32x32x16_bf16 v[16:31], v[166:169], v[136:139], v[16:31]
    v_exp_f32 v61, v61
    v_exp_f32 v62, v62
    v_exp_f32 v63, v63
    v_exp_f32 v0, v0
    v_exp_f32 v1, v1
    v_smfmac_f32_32x32x32_bf16 v[112:127], v[198:201], v[56:63], v236
    v_exp_f32 v2, v2
    v_exp_f32 v3, v3
    v_exp_f32 v4, v4
    v_mfma_f32_32x32x4_2b_bf16 v[32:63], v[150:151], v[146:147], 0 cbsz:1 abid:0
    v_exp_f32 v5, v5
    v_exp_f32 v6, v6
    v_exp_f32 v7, v7
    v_exp_f32 v8, v8
    v_exp_f32 v9, v9
    v_exp_f32 v10, v10
    v_exp_f32 v11, v11
    v_exp_f32 v12, v12
    v_smfmac_f32_32x32x32_bf16 v[64:79], v[202:205], v[0:7], v236
    v_exp_f32 v13, v13
    v_exp_f32 v14, v14
    v_exp_f32 v15, v15
    v_exp_f32 v16, v16
    s_mov_b64 exec, s[62:63]
    buffer_load_dwordx4 v[218:221], v241, s[24:27], s46 offen sc1
    buffer_load_dwordx4 v[222:225], v241, s[24:27], s47 offen sc1
    s_mov_b64 exec, -1
    v_exp_f32 v17, v17
    v_smfmac_f32_32x32x32_bf16 v[64:79], v[206:209], v[8:15], v236
    v_exp_f32 v18, v18
    v_exp_f32 v19, v19
    v_exp_f32 v20, v20
    v_mfma_f32_32x32x16_bf16 v[32:47], v[166:169], v[132:135], v[32:47]
    v_exp_f32 v21, v21
    v_exp_f32 v22, v22
    v_exp_f32 v23, v23
    v_exp_f32 v24, v24
    buffer_load_dwordx4 v[152:155], v242, s[24:27], s48 offen sc1
    v_exp_f32 v25, v25
    v_smfmac_f32_32x32x32_bf16 v[96:111], v[202:205], v[16:23], v236
    v_exp_f32 v26, v26
    v_exp_f32 v27, v27
    v_exp_f32 v28, v28
    v_mfma_f32_32x32x16_bf16 v[48:63], v[166:169], v[140:143], v[48:63]
    v_exp_f32 v29, v29
    v_exp_f32 v30, v30
    v_exp_f32 v31, v31
    v_exp_f32 v32, v32
    v_exp_f32 v33, v33
    v_smfmac_f32_32x32x32_bf16 v[96:111], v[206:209], v[24:31], v236
    s_waitcnt vmcnt(3)
    v_exp_f32 v34, v34
    v_exp_f32 v35, v35
    v_exp_f32 v36, v36
    v_mfma_f32_32x32x4_2b_bf16 v[0:31], v[148:149], v[144:145], 0 cbsz:1 abid:1
    v_exp_f32 v37, v37
    v_exp_f32 v38, v38
    v_exp_f32 v39, v39
    v_exp_f32 v40, v40
    v_exp_f32 v41, v41
    v_exp_f32 v42, v42
    v_mov_b64 v[178:179], v[174:175]
    v_exp_f32 v43, v43
    v_exp_f32 v44, v44
    v_smfmac_f32_32x32x32_bf16 v[80:95], v[202:205], v[32:39], v236
    v_exp_f32 v45, v45
    v_exp_f32 v46, v46
    v_exp_f32 v47, v47
    v_exp_f32 v48, v48
    buffer_load_dwordx4 v[184:187], v240, s[24:27], s48 offen sc1
    v_exp_f32 v49, v49
    v_smfmac_f32_32x32x32_bf16 v[80:95], v[206:209], v[40:47], v236
    v_exp_f32 v50, v50
    v_exp_f32 v51, v51
    v_exp_f32 v52, v52
    v_mfma_f32_32x32x16_bf16 v[0:15], v[178:181], v[128:131], v[0:15]
    v_exp_f32 v53, v53
    v_exp_f32 v54, v54
    v_exp_f32 v55, v55
    v_exp_f32 v56, v56
    buffer_load_dwordx4 v[190:193], v240, s[24:27], s48 offen offset:256 sc1
    v_exp_f32 v57, v57
    s_mov_b64 exec, s[62:63]
    buffer_load_dwordx4 v[226:229], v238, s[24:27], s48 offen sc1
    buffer_load_dwordx4 v[230:233], v238, s[24:27], s49 offen sc1
    s_mov_b64 exec, -1
    v_smfmac_f32_32x32x32_bf16 v[112:127], v[202:205], v[48:55], v236
    v_exp_f32 v58, v58
    v_exp_f32 v59, v59
    v_exp_f32 v60, v60
    v_mfma_f32_32x32x16_bf16 v[16:31], v[178:181], v[136:139], v[16:31]
    v_exp_f32 v61, v61
    v_exp_f32 v62, v62
    v_exp_f32 v63, v63
    v_exp_f32 v0, v0
    v_exp_f32 v1, v1
    v_smfmac_f32_32x32x32_bf16 v[112:127], v[206:209], v[56:63], v236
    v_exp_f32 v2, v2
    v_exp_f32 v3, v3
    v_exp_f32 v4, v4
    v_mfma_f32_32x32x4_2b_bf16 v[32:63], v[148:149], v[146:147], 0 cbsz:1 abid:1
    v_exp_f32 v5, v5
    v_exp_f32 v6, v6
    v_exp_f32 v7, v7
    v_exp_f32 v8, v8
    v_exp_f32 v9, v9
    v_exp_f32 v10, v10
    v_exp_f32 v11, v11
    s_mov_b32 s4, 7323648
    buffer_load_dwordx4 v[250:253], v237, s[24:27], s4 offen sc1
    v_exp_f32 v12, v12
    v_smfmac_f32_32x32x32_bf16 v[64:79], v[210:213], v[0:7], v236
    v_exp_f32 v13, v13
    v_exp_f32 v14, v14
    v_exp_f32 v15, v15
    v_exp_f32 v16, v16
    s_mov_b64 exec, s[62:63]
    buffer_load_dwordx4 v[194:197], v241, s[24:27], s48 offen sc1
    buffer_load_dwordx4 v[198:201], v241, s[24:27], s49 offen sc1
    s_mov_b64 exec, -1
    v_exp_f32 v17, v17
    v_smfmac_f32_32x32x32_bf16 v[64:79], v[214:217], v[8:15], v236
    v_exp_f32 v18, v18
    v_exp_f32 v19, v19
    v_exp_f32 v20, v20
    v_mfma_f32_32x32x16_bf16 v[32:47], v[178:181], v[132:135], v[32:47]
    v_exp_f32 v21, v21
    v_exp_f32 v22, v22
    v_exp_f32 v23, v23
    v_exp_f32 v24, v24
    v_exp_f32 v25, v25
    v_smfmac_f32_32x32x32_bf16 v[96:111], v[210:213], v[16:23], v236
    v_exp_f32 v26, v26
    v_exp_f32 v27, v27
    v_exp_f32 v28, v28
    v_mfma_f32_32x32x16_bf16 v[48:63], v[178:181], v[140:143], v[48:63]
    v_exp_f32 v29, v29
    v_exp_f32 v30, v30
    v_exp_f32 v31, v31
    v_exp_f32 v32, v32
    v_exp_f32 v33, v33
    v_smfmac_f32_32x32x32_bf16 v[96:111], v[214:217], v[24:31], v236
    s_waitcnt vmcnt(8)
    v_exp_f32 v34, v34
    v_exp_f32 v35, v35
    v_exp_f32 v36, v36
    v_mfma_f32_32x32x4_2b_bf16 v[0:31], v[150:151], v[144:145], 0 cbsz:1 abid:1
    v_exp_f32 v37, v37
    v_exp_f32 v38, v38
    v_exp_f32 v39, v39
    v_exp_f32 v40, v40
    v_exp_f32 v41, v41
    v_exp_f32 v42, v42
    v_mov_b64 v[178:179], v[182:183]
    v_exp_f32 v43, v43
    v_exp_f32 v44, v44
    v_smfmac_f32_32x32x32_bf16 v[80:95], v[210:213], v[32:39], v236
    v_exp_f32 v45, v45
    v_exp_f32 v46, v46
    v_exp_f32 v47, v47
    v_exp_f32 v48, v48
    v_exp_f32 v49, v49
    v_smfmac_f32_32x32x32_bf16 v[80:95], v[214:217], v[40:47], v236
    v_exp_f32 v50, v50
    v_exp_f32 v51, v51
    v_exp_f32 v52, v52
    v_mfma_f32_32x32x16_bf16 v[0:15], v[176:179], v[128:131], v[0:15]
    v_exp_f32 v53, v53
    v_exp_f32 v54, v54
    v_exp_f32 v55, v55
    v_exp_f32 v56, v56
    v_exp_f32 v57, v57
    v_smfmac_f32_32x32x32_bf16 v[112:127], v[210:213], v[48:55], v236
    v_exp_f32 v58, v58
    v_exp_f32 v59, v59
    v_exp_f32 v60, v60
    v_mfma_f32_32x32x16_bf16 v[16:31], v[176:179], v[136:139], v[16:31]
    v_exp_f32 v61, v61
    v_exp_f32 v62, v62
    v_exp_f32 v63, v63
    v_exp_f32 v0, v0
    v_exp_f32 v1, v1
    v_smfmac_f32_32x32x32_bf16 v[112:127], v[214:217], v[56:63], v236
    v_exp_f32 v2, v2
    v_exp_f32 v3, v3
    v_exp_f32 v4, v4
    v_mfma_f32_32x32x4_2b_bf16 v[32:63], v[150:151], v[146:147], 0 cbsz:1 abid:1
    v_exp_f32 v5, v5
    v_exp_f32 v6, v6
    v_exp_f32 v7, v7
    v_exp_f32 v8, v8
    v_exp_f32 v9, v9
    v_exp_f32 v10, v10
    v_exp_f32 v11, v11
    v_exp_f32 v12, v12
    v_smfmac_f32_32x32x32_bf16 v[64:79], v[218:221], v[0:7], v236
    v_exp_f32 v13, v13
    v_exp_f32 v14, v14
    v_exp_f32 v15, v15
    v_exp_f32 v16, v16
    buffer_load_dwordx4 v[164:167], v240, s[24:27], s50 offen sc1
    v_exp_f32 v17, v17
    v_smfmac_f32_32x32x32_bf16 v[64:79], v[222:225], v[8:15], v236
    v_exp_f32 v18, v18
    v_exp_f32 v19, v19
    v_exp_f32 v20, v20
    v_mfma_f32_32x32x16_bf16 v[32:47], v[176:179], v[132:135], v[32:47]
    v_exp_f32 v21, v21
    v_exp_f32 v22, v22
    v_exp_f32 v23, v23
    v_exp_f32 v24, v24
    buffer_load_dwordx4 v[170:173], v240, s[24:27], s50 offen offset:256 sc1
    v_exp_f32 v25, v25
    v_smfmac_f32_32x32x32_bf16 v[96:111], v[218:221], v[16:23], v236
    v_exp_f32 v26, v26
    v_exp_f32 v27, v27
    v_exp_f32 v28, v28
    v_mfma_f32_32x32x16_bf16 v[48:63], v[176:179], v[140:143], v[48:63]
    v_exp_f32 v29, v29
    v_exp_f32 v30, v30
    v_exp_f32 v31, v31
    v_exp_f32 v32, v32
    s_add_u32 m0, s42, 0
    s_add_u32 s67, s54, 0
    buffer_load_dwordx4 v234, s[20:23], s67 offen nt lds
    v_exp_f32 v33, v33
    v_smfmac_f32_32x32x32_bf16 v[96:111], v[222:225], v[24:31], v236
    s_waitcnt vmcnt(6)
    v_exp_f32 v34, v34
    v_exp_f32 v35, v35
    v_exp_f32 v36, v36
    v_mfma_f32_32x32x4_2b_bf16 v[0:31], v[152:153], v[144:145], 0 cbsz:1 abid:0
    v_exp_f32 v37, v37
    v_exp_f32 v38, v38
    v_exp_f32 v39, v39
    v_exp_f32 v40, v40
    v_exp_f32 v41, v41
    v_exp_f32 v42, v42
    v_mov_b64 v[188:189], v[184:185]
    v_exp_f32 v43, v43
    v_exp_f32 v44, v44
    v_smfmac_f32_32x32x32_bf16 v[80:95], v[218:221], v[32:39], v236
    v_exp_f32 v45, v45
    v_exp_f32 v46, v46
    v_exp_f32 v47, v47
    v_exp_f32 v48, v48
    s_mov_b64 exec, s[62:63]
    buffer_load_dwordx4 v[202:205], v238, s[24:27], s50 offen sc1
    buffer_load_dwordx4 v[206:209], v238, s[24:27], s51 offen sc1
    s_mov_b64 exec, -1
    v_exp_f32 v49, v49
    v_smfmac_f32_32x32x32_bf16 v[80:95], v[222:225], v[40:47], v236
    v_exp_f32 v50, v50
    v_exp_f32 v51, v51
    v_exp_f32 v52, v52
    v_mfma_f32_32x32x16_bf16 v[0:15], v[188:191], v[128:131], v[0:15]
    v_exp_f32 v53, v53
    v_exp_f32 v54, v54
    v_exp_f32 v55, v55
    v_exp_f32 v56, v56
    s_mov_b64 exec, s[62:63]
    buffer_load_dwordx4 v[210:213], v241, s[24:27], s50 offen sc1
    buffer_load_dwordx4 v[214:217], v241, s[24:27], s51 offen sc1
    s_mov_b64 exec, -1
    v_exp_f32 v57, v57
    v_smfmac_f32_32x32x32_bf16 v[112:127], v[218:221], v[48:55], v236
    v_exp_f32 v58, v58
    v_exp_f32 v59, v59
    v_exp_f32 v60, v60
    v_mfma_f32_32x32x16_bf16 v[16:31], v[188:191], v[136:139], v[16:31]
    v_exp_f32 v61, v61
    v_exp_f32 v62, v62
    v_exp_f32 v63, v63
    v_exp_f32 v0, v0
    s_add_u32 m0, s9, 0
    s_add_u32 s67, s8, 0
    buffer_load_dwordx4 v237, s[28:31], s67 offen nt lds
    v_exp_f32 v1, v1
    v_smfmac_f32_32x32x32_bf16 v[112:127], v[222:225], v[56:63], v236
    v_exp_f32 v2, v2
    v_exp_f32 v3, v3
    v_exp_f32 v4, v4
    v_mfma_f32_32x32x4_2b_bf16 v[32:63], v[152:153], v[146:147], 0 cbsz:1 abid:0
    v_exp_f32 v5, v5
    v_exp_f32 v6, v6
    v_exp_f32 v7, v7
    v_exp_f32 v8, v8
    v_exp_f32 v9, v9
    v_exp_f32 v10, v10
    v_exp_f32 v11, v11
    v_exp_f32 v12, v12
    v_smfmac_f32_32x32x32_bf16 v[64:79], v[226:229], v[0:7], v236
    v_exp_f32 v13, v13
    v_exp_f32 v14, v14
    v_exp_f32 v15, v15
    v_exp_f32 v16, v16
    buffer_load_dwordx4 v[156:159], v242, s[24:27], s72 offen sc1
    v_exp_f32 v17, v17
    v_smfmac_f32_32x32x32_bf16 v[64:79], v[230:233], v[8:15], v236
    v_exp_f32 v18, v18
    v_exp_f32 v19, v19
    v_exp_f32 v20, v20
    v_mfma_f32_32x32x16_bf16 v[32:47], v[188:191], v[132:135], v[32:47]
    v_exp_f32 v21, v21
    v_exp_f32 v22, v22
    v_exp_f32 v23, v23
    v_exp_f32 v24, v24
    buffer_load_dwordx4 v[174:177], v240, s[24:27], s72 offen sc1
    v_exp_f32 v25, v25
    v_smfmac_f32_32x32x32_bf16 v[96:111], v[226:229], v[16:23], v236
    v_exp_f32 v26, v26
    v_exp_f32 v27, v27
    v_exp_f32 v28, v28
    v_mfma_f32_32x32x16_bf16 v[48:63], v[188:191], v[140:143], v[48:63]
    v_exp_f32 v29, v29
    v_exp_f32 v30, v30
    v_exp_f32 v31, v31
    v_exp_f32 v32, v32
    v_exp_f32 v33, v33
    v_smfmac_f32_32x32x32_bf16 v[96:111], v[230:233], v[24:31], v236
    s_waitcnt vmcnt(10)
    v_exp_f32 v34, v34
    v_exp_f32 v35, v35
    v_exp_f32 v36, v36
    v_mfma_f32_32x32x4_2b_bf16 v[0:31], v[154:155], v[144:145], 0 cbsz:1 abid:0
    v_exp_f32 v37, v37
    v_exp_f32 v38, v38
    v_exp_f32 v39, v39
    v_exp_f32 v40, v40
    v_exp_f32 v41, v41
    v_exp_f32 v42, v42
    v_mov_b64 v[188:189], v[192:193]
    v_exp_f32 v43, v43
    v_exp_f32 v44, v44
    v_smfmac_f32_32x32x32_bf16 v[80:95], v[226:229], v[32:39], v236
    v_exp_f32 v45, v45
    v_exp_f32 v46, v46
    v_exp_f32 v47, v47
    v_exp_f32 v48, v48
    buffer_load_dwordx4 v[180:183], v240, s[24:27], s72 offen offset:256 sc1
    v_exp_f32 v49, v49
    v_smfmac_f32_32x32x32_bf16 v[80:95], v[230:233], v[40:47], v236
    v_exp_f32 v50, v50
    v_exp_f32 v51, v51
    v_exp_f32 v52, v52
    v_mfma_f32_32x32x16_bf16 v[0:15], v[186:189], v[128:131], v[0:15]
    v_exp_f32 v53, v53
    v_exp_f32 v54, v54
    v_exp_f32 v55, v55
    v_exp_f32 v56, v56
    s_mov_b64 exec, s[62:63]
    buffer_load_dwordx4 v[218:221], v238, s[24:27], s72 offen sc1
    buffer_load_dwordx4 v[222:225], v238, s[24:27], s73 offen sc1
    s_mov_b64 exec, -1
    v_exp_f32 v57, v57
    v_smfmac_f32_32x32x32_bf16 v[112:127], v[226:229], v[48:55], v236
    v_exp_f32 v58, v58
    v_exp_f32 v59, v59
    v_exp_f32 v60, v60
    v_mfma_f32_32x32x16_bf16 v[16:31], v[186:189], v[136:139], v[16:31]
    v_exp_f32 v61, v61
    v_exp_f32 v62, v62
    v_exp_f32 v63, v63
    v_exp_f32 v0, v0
    s_add_u32 m0, s42, 1024
    s_add_u32 s67, s54, 73728
    buffer_load_dwordx4 v234, s[20:23], s67 offen nt lds
    v_exp_f32 v1, v1
    v_smfmac_f32_32x32x32_bf16 v[112:127], v[230:233], v[56:63], v236
    v_exp_f32 v2, v2
    v_exp_f32 v3, v3
    v_exp_f32 v4, v4
    v_mfma_f32_32x32x4_2b_bf16 v[32:63], v[154:155], v[146:147], 0 cbsz:1 abid:0
    v_exp_f32 v5, v5
    v_exp_f32 v6, v6
    v_exp_f32 v7, v7
    v_exp_f32 v8, v8
    v_exp_f32 v9, v9
    v_exp_f32 v10, v10
    v_exp_f32 v11, v11
    v_exp_f32 v12, v12
    v_smfmac_f32_32x32x32_bf16 v[64:79], v[194:197], v[0:7], v236
    v_exp_f32 v13, v13
    v_exp_f32 v14, v14
    v_exp_f32 v15, v15
    v_exp_f32 v16, v16
    s_mov_b64 exec, s[62:63]
    buffer_load_dwordx4 v[226:229], v241, s[24:27], s72 offen sc1
    buffer_load_dwordx4 v[230:233], v241, s[24:27], s73 offen sc1
    s_mov_b64 exec, -1
    v_exp_f32 v17, v17
    v_smfmac_f32_32x32x32_bf16 v[64:79], v[198:201], v[8:15], v236
    v_exp_f32 v18, v18
    v_exp_f32 v19, v19
    v_exp_f32 v20, v20
    v_mfma_f32_32x32x16_bf16 v[32:47], v[186:189], v[132:135], v[32:47]
    v_exp_f32 v21, v21
    v_exp_f32 v22, v22
    v_exp_f32 v23, v23
    v_exp_f32 v24, v24
    v_exp_f32 v25, v25
    v_smfmac_f32_32x32x32_bf16 v[96:111], v[194:197], v[16:23], v236
    v_exp_f32 v26, v26
    v_exp_f32 v27, v27
    v_exp_f32 v28, v28
    v_mfma_f32_32x32x16_bf16 v[48:63], v[186:189], v[140:143], v[48:63]
    v_exp_f32 v29, v29
    v_exp_f32 v30, v30
    v_exp_f32 v31, v31
    v_exp_f32 v32, v32
    s_add_u32 m0, s9, 0
    s_add_u32 s67, s8, 0
    buffer_load_dwordx4 v237, s[28:31], s67 offen offset:1024 nt lds
    v_exp_f32 v33, v33
    v_smfmac_f32_32x32x32_bf16 v[96:111], v[198:201], v[24:31], v236
    s_waitcnt vmcnt(12)
    v_exp_f32 v34, v34
    v_exp_f32 v35, v35
    v_exp_f32 v36, v36
    v_mfma_f32_32x32x4_2b_bf16 v[0:31], v[152:153], v[144:145], 0 cbsz:1 abid:1
    v_exp_f32 v37, v37
    v_exp_f32 v38, v38
    v_exp_f32 v39, v39
    v_exp_f32 v40, v40
    v_exp_f32 v41, v41
    v_exp_f32 v42, v42
    v_mov_b64 v[168:169], v[164:165]
    v_exp_f32 v43, v43
    v_exp_f32 v44, v44
    v_smfmac_f32_32x32x32_bf16 v[80:95], v[194:197], v[32:39], v236
    v_exp_f32 v45, v45
    v_exp_f32 v46, v46
    v_exp_f32 v47, v47
    v_exp_f32 v48, v48
    v_exp_f32 v49, v49
    v_smfmac_f32_32x32x32_bf16 v[80:95], v[198:201], v[40:47], v236
    v_exp_f32 v50, v50
    v_exp_f32 v51, v51
    v_exp_f32 v52, v52
    v_mfma_f32_32x32x16_bf16 v[0:15], v[168:171], v[128:131], v[0:15]
    v_exp_f32 v53, v53
    v_exp_f32 v54, v54
    v_exp_f32 v55, v55
    v_exp_f32 v56, v56
    v_exp_f32 v57, v57
    v_smfmac_f32_32x32x32_bf16 v[112:127], v[194:197], v[48:55], v236
    v_exp_f32 v58, v58
    v_exp_f32 v59, v59
    v_exp_f32 v60, v60
    v_mfma_f32_32x32x16_bf16 v[16:31], v[168:171], v[136:139], v[16:31]
    v_exp_f32 v61, v61
    v_exp_f32 v62, v62
    v_exp_f32 v63, v63
    v_exp_f32 v0, v0
    v_cmp_ne_u32 vcc, s53, v251
    v_cmp_ne_u32 s[4:5], s53, v253
    s_or_b64 vcc, vcc, s[4:5]
    s_cbranch_scc1 K2_candspin
K2_candok:
    v_exp_f32 v1, v1
    v_smfmac_f32_32x32x32_bf16 v[112:127], v[198:201], v[56:63], v236
    v_max_u32_dpp v251, v250, v250 quad_perm:[1,0,3,2] row_mask:0xf bank_mask:0xf
    v_exp_f32 v2, v2
    v_exp_f32 v3, v3
    v_max_u32_dpp v251, v251, v251 quad_perm:[2,3,0,1] row_mask:0xf bank_mask:0xf
    v_exp_f32 v4, v4
    v_mfma_f32_32x32x4_2b_bf16 v[32:63], v[152:153], v[146:147], 0 cbsz:1 abid:1
    v_exp_f32 v5, v5
    v_max_u32_dpp v251, v251, v251 row_half_mirror row_mask:0xf bank_mask:0xf
    v_exp_f32 v6, v6
    v_exp_f32 v7, v7
    v_max_u32_dpp v251, v251, v251 row_mirror row_mask:0xf bank_mask:0xf
    v_exp_f32 v8, v8
    v_exp_f32 v9, v9
    v_max_u32_dpp v251, v251, v251 row_bcast:15 row_mask:0xa bank_mask:0xf
    v_exp_f32 v10, v10
    v_exp_f32 v11, v11
    v_max_u32_dpp v251, v251, v251 row_bcast:31 row_mask:0xc bank_mask:0xf
    v_exp_f32 v12, v12
    v_smfmac_f32_32x32x32_bf16 v[64:79], v[202:205], v[0:7], v236
    v_exp_f32 v13, v13
    v_readlane_b32 s68, v251, 63
    v_exp_f32 v14, v14
    v_exp_f32 v15, v15
    v_cmp_ne_u32 vcc, s68, v250
    v_exp_f32 v16, v16
    buffer_load_dwordx4 v[184:187], v240, s[24:27], s74 offen sc1
    v_exp_f32 v17, v17
    v_smfmac_f32_32x32x32_bf16 v[64:79], v[206:209], v[8:15], v236
    v_cndmask_b32 v250, v252, v250, vcc
    v_exp_f32 v18, v18
    v_exp_f32 v19, v19
    v_max_u32_dpp v251, v250, v250 quad_perm:[1,0,3,2] row_mask:0xf bank_mask:0xf
    v_exp_f32 v20, v20
    v_mfma_f32_32x32x16_bf16 v[32:47], v[168:171], v[132:135], v[32:47]
    v_exp_f32 v21, v21
    v_max_u32_dpp v251, v251, v251 quad_perm:[2,3,0,1] row_mask:0xf bank_mask:0xf
    v_exp_f32 v22, v22
    v_exp_f32 v23, v23
    v_max_u32_dpp v251, v251, v251 row_half_mirror row_mask:0xf bank_mask:0xf
    v_exp_f32 v24, v24
    buffer_load_dwordx4 v[190:193], v240, s[24:27], s74 offen offset:256 sc1
    v_exp_f32 v25, v25
    v_smfmac_f32_32x32x32_bf16 v[96:111], v[202:205], v[16:23], v236
    v_max_u32_dpp v251, v251, v251 row_mirror row_mask:0xf bank_mask:0xf
    v_exp_f32 v26, v26
    v_exp_f32 v27, v27
    v_max_u32_dpp v251, v251, v251 row_bcast:15 row_mask:0xa bank_mask:0xf
    v_exp_f32 v28, v28
    v_mfma_f32_32x32x16_bf16 v[48:63], v[168:171], v[140:143], v[48:63]
    v_exp_f32 v29, v29
    v_max_u32_dpp v251, v251, v251 row_bcast:31 row_mask:0xc bank_mask:0xf
    v_exp_f32 v30, v30
    v_exp_f32 v31, v31
    v_readlane_b32 s69, v251, 63
    s_nop 0
    s_not_b32 s70, s68
    s_not_b32 s71, s69
    s_and_b32 s70, s70, 0x7ff
    s_and_b32 s71, s71, 0x7ff
    s_mul_i32 s10, s70, 1152
    s_mul_i32 s11, s71, 1152
    s_add_u32 s10, s10, s58
    s_add_u32 s11, s11, s58
    v_exp_f32 v32, v32
    s_add_u32 m0, s42, 2048
    s_add_u32 s67, s54, 147456
    buffer_load_dwordx4 v234, s[20:23], s67 offen nt lds
    v_exp_f32 v33, v33
    v_smfmac_f32_32x32x32_bf16 v[96:111], v[206:209], v[24:31], v236
    s_waitcnt vmcnt(13)
    v_exp_f32 v34, v34
    v_exp_f32 v35, v35
    v_exp_f32 v36, v36
    v_mfma_f32_32x32x4_2b_bf16 v[0:31], v[154:155], v[144:145], 0 cbsz:1 abid:1
    v_exp_f32 v37, v37
    v_exp_f32 v38, v38
    v_exp_f32 v39, v39
    v_exp_f32 v40, v40
    v_exp_f32 v41, v41
    v_exp_f32 v42, v42
    v_mov_b64 v[168:169], v[172:173]
    v_exp_f32 v43, v43
    v_exp_f32 v44, v44
    v_smfmac_f32_32x32x32_bf16 v[80:95], v[202:205], v[32:39], v236
    v_exp_f32 v45, v45
    v_exp_f32 v46, v46
    v_exp_f32 v47, v47
    v_exp_f32 v48, v48
    s_mov_b64 exec, s[62:63]
    buffer_load_dwordx4 v[194:197], v238, s[24:27], s74 offen sc1
    buffer_load_dwordx4 v[198:201], v238, s[24:27], s75 offen sc1
    s_mov_b64 exec, -1
    v_exp_f32 v49, v49
    v_smfmac_f32_32x32x32_bf16 v[80:95], v[206:209], v[40:47], v236
    v_exp_f32 v50, v50
    v_exp_f32 v51, v51
    v_exp_f32 v52, v52
    v_mfma_f32_32x32x16_bf16 v[0:15], v[166:169], v[128:131], v[0:15]
    v_exp_f32 v53, v53
    v_exp_f32 v54, v54
    v_exp_f32 v55, v55
    v_exp_f32 v56, v56
    v_exp_f32 v57, v57
    v_smfmac_f32_32x32x32_bf16 v[112:127], v[202:205], v[48:55], v236
    v_exp_f32 v58, v58
    v_exp_f32 v59, v59
    v_exp_f32 v60, v60
    v_mfma_f32_32x32x16_bf16 v[16:31], v[166:169], v[136:139], v[16:31]
    v_exp_f32 v61, v61
    v_exp_f32 v62, v62
    v_exp_f32 v63, v63
    v_exp_f32 v0, v0
    s_add_u32 m0, s9, 0
    s_add_u32 s67, s8, 0
    buffer_load_dwordx4 v237, s[28:31], s67 offen offset:2048 nt lds
    v_exp_f32 v1, v1
    v_smfmac_f32_32x32x32_bf16 v[112:127], v[206:209], v[56:63], v236
    v_exp_f32 v2, v2
    v_exp_f32 v3, v3
    v_exp_f32 v4, v4
    v_mfma_f32_32x32x4_2b_bf16 v[32:63], v[154:155], v[146:147], 0 cbsz:1 abid:1
    v_exp_f32 v5, v5
    v_exp_f32 v6, v6
    v_exp_f32 v7, v7
    v_exp_f32 v8, v8
    v_exp_f32 v9, v9
    v_exp_f32 v10, v10
    v_exp_f32 v11, v11
    v_exp_f32 v12, v12
    v_smfmac_f32_32x32x32_bf16 v[64:79], v[210:213], v[0:7], v236
    v_exp_f32 v13, v13
    v_exp_f32 v14, v14
    v_exp_f32 v15, v15
    v_exp_f32 v16, v16
    s_mov_b64 exec, s[62:63]
    buffer_load_dwordx4 v[202:205], v241, s[24:27], s74 offen sc1
    buffer_load_dwordx4 v[206:209], v241, s[24:27], s75 offen sc1
    s_mov_b64 exec, -1
    v_exp_f32 v17, v17
    v_smfmac_f32_32x32x32_bf16 v[64:79], v[214:217], v[8:15], v236
    v_exp_f32 v18, v18
    v_exp_f32 v19, v19
    v_exp_f32 v20, v20
    v_mfma_f32_32x32x16_bf16 v[32:47], v[166:169], v[132:135], v[32:47]
    v_exp_f32 v21, v21
    v_exp_f32 v22, v22
    v_exp_f32 v23, v23
    v_exp_f32 v24, v24
    v_exp_f32 v25, v25
    v_smfmac_f32_32x32x32_bf16 v[96:111], v[210:213], v[16:23], v236
    v_exp_f32 v26, v26
    v_exp_f32 v27, v27
    v_exp_f32 v28, v28
    v_mfma_f32_32x32x16_bf16 v[48:63], v[166:169], v[140:143], v[48:63]
    v_exp_f32 v29, v29
    v_exp_f32 v30, v30
    v_exp_f32 v31, v31
    v_exp_f32 v32, v32
    v_exp_f32 v33, v33
    v_smfmac_f32_32x32x32_bf16 v[96:111], v[214:217], v[24:31], v236
    s_waitcnt vmcnt(12)
    v_exp_f32 v34, v34
    v_exp_f32 v35, v35
    v_exp_f32 v36, v36
    v_mfma_f32_32x32x4_2b_bf16 v[0:31], v[156:157], v[144:145], 0 cbsz:1 abid:0
    v_exp_f32 v37, v37
    v_exp_f32 v38, v38
    v_exp_f32 v39, v39
    v_exp_f32 v40, v40
    v_exp_f32 v41, v41
    v_exp_f32 v42, v42
    v_mov_b64 v[178:179], v[174:175]
    v_exp_f32 v43, v43
    v_exp_f32 v44, v44
    v_smfmac_f32_32x32x32_bf16 v[80:95], v[210:213], v[32:39], v236
    v_exp_f32 v45, v45
    v_exp_f32 v46, v46
    v_exp_f32 v47, v47
    v_exp_f32 v48, v48
    v_exp_f32 v49, v49
    v_smfmac_f32_32x32x32_bf16 v[80:95], v[214:217], v[40:47], v236
    v_exp_f32 v50, v50
    v_exp_f32 v51, v51
    v_exp_f32 v52, v52
    v_mfma_f32_32x32x16_bf16 v[0:15], v[178:181], v[128:131], v[0:15]
    v_exp_f32 v53, v53
    v_exp_f32 v54, v54
    v_exp_f32 v55, v55
    v_exp_f32 v56, v56
    v_exp_f32 v57, v57
    v_smfmac_f32_32x32x32_bf16 v[112:127], v[210:213], v[48:55], v236
    v_exp_f32 v58, v58
    v_exp_f32 v59, v59
    v_exp_f32 v60, v60
    v_mfma_f32_32x32x16_bf16 v[16:31], v[178:181], v[136:139], v[16:31]
    v_exp_f32 v61, v61
    v_exp_f32 v62, v62
    v_exp_f32 v63, v63
    v_exp_f32 v0, v0
    s_add_u32 m0, s42, 3072
    s_add_u32 s67, s54, 221184
    buffer_load_dwordx4 v234, s[20:23], s67 offen nt lds
    v_exp_f32 v1, v1
    v_smfmac_f32_32x32x32_bf16 v[112:127], v[214:217], v[56:63], v236
    v_exp_f32 v2, v2
    v_exp_f32 v3, v3
    v_exp_f32 v4, v4
    v_mfma_f32_32x32x4_2b_bf16 v[32:63], v[156:157], v[146:147], 0 cbsz:1 abid:0
    v_exp_f32 v5, v5
    v_exp_f32 v6, v6
    v_exp_f32 v7, v7
    v_exp_f32 v8, v8
    v_exp_f32 v9, v9
    v_exp_f32 v10, v10
    v_exp_f32 v11, v11
    v_exp_f32 v12, v12
    v_smfmac_f32_32x32x32_bf16 v[64:79], v[218:221], v[0:7], v236
    v_exp_f32 v13, v13
    v_exp_f32 v14, v14
    v_exp_f32 v15, v15
    v_exp_f32 v16, v16
    buffer_load_dwordx4 v[160:163], v242, s[24:27], s76 offen sc1
    v_exp_f32 v17, v17
    v_smfmac_f32_32x32x32_bf16 v[64:79], v[222:225], v[8:15], v236
    v_exp_f32 v18, v18
    v_exp_f32 v19, v19
    v_exp_f32 v20, v20
    v_mfma_f32_32x32x16_bf16 v[32:47], v[178:181], v[132:135], v[32:47]
    v_exp_f32 v21, v21
    v_exp_f32 v22, v22
    v_exp_f32 v23, v23
    v_exp_f32 v24, v24
    buffer_load_dwordx4 v[164:167], v240, s[24:27], s76 offen sc1
    v_exp_f32 v25, v25
    v_smfmac_f32_32x32x32_bf16 v[96:111], v[218:221], v[16:23], v236
    v_exp_f32 v26, v26
    v_exp_f32 v27, v27
    v_exp_f32 v28, v28
    v_mfma_f32_32x32x16_bf16 v[48:63], v[178:181], v[140:143], v[48:63]
    v_exp_f32 v29, v29
    v_exp_f32 v30, v30
    v_exp_f32 v31, v31
    v_exp_f32 v32, v32
    s_add_u32 m0, s9, 0
    s_add_u32 s67, s8, 0
    buffer_load_dwordx4 v237, s[28:31], s67 offen offset:3072 nt lds
    v_exp_f32 v33, v33
    v_smfmac_f32_32x32x32_bf16 v[96:111], v[222:225], v[24:31], v236
    s_waitcnt vmcnt(13)
    v_exp_f32 v34, v34
    v_exp_f32 v35, v35
    v_exp_f32 v36, v36
    v_mfma_f32_32x32x4_2b_bf16 v[0:31], v[158:159], v[144:145], 0 cbsz:1 abid:0
    v_exp_f32 v37, v37
    v_exp_f32 v38, v38
    v_exp_f32 v39, v39
    v_exp_f32 v40, v40
    v_exp_f32 v41, v41
    v_exp_f32 v42, v42
    v_mov_b64 v[178:179], v[182:183]
    v_exp_f32 v43, v43
    v_exp_f32 v44, v44
    v_smfmac_f32_32x32x32_bf16 v[80:95], v[218:221], v[32:39], v236
    v_exp_f32 v45, v45
    v_exp_f32 v46, v46
    v_exp_f32 v47, v47
    v_exp_f32 v48, v48
    buffer_load_dwordx4 v[170:173], v240, s[24:27], s76 offen offset:256 sc1
    v_exp_f32 v49, v49
    v_smfmac_f32_32x32x32_bf16 v[80:95], v[222:225], v[40:47], v236
    v_exp_f32 v50, v50
    v_exp_f32 v51, v51
    v_exp_f32 v52, v52
    v_mfma_f32_32x32x16_bf16 v[0:15], v[176:179], v[128:131], v[0:15]
    v_exp_f32 v53, v53
    v_exp_f32 v54, v54
    v_exp_f32 v55, v55
    v_exp_f32 v56, v56
    s_mov_b64 exec, s[62:63]
    buffer_load_dwordx4 v[210:213], v238, s[24:27], s76 offen sc1
    buffer_load_dwordx4 v[214:217], v238, s[24:27], s77 offen sc1
    s_mov_b64 exec, -1
    v_exp_f32 v57, v57
    v_smfmac_f32_32x32x32_bf16 v[112:127], v[218:221], v[48:55], v236
    v_exp_f32 v58, v58
    v_exp_f32 v59, v59
    v_exp_f32 v60, v60
    v_mfma_f32_32x32x16_bf16 v[16:31], v[176:179], v[136:139], v[16:31]
    v_exp_f32 v61, v61
    v_exp_f32 v62, v62
    v_exp_f32 v63, v63
    v_exp_f32 v0, v0
    v_exp_f32 v1, v1
    v_smfmac_f32_32x32x32_bf16 v[112:127], v[222:225], v[56:63], v236
    v_exp_f32 v2, v2
    v_exp_f32 v3, v3
    v_exp_f32 v4, v4
    v_mfma_f32_32x32x4_2b_bf16 v[32:63], v[158:159], v[146:147], 0 cbsz:1 abid:0
    v_exp_f32 v5, v5
    v_exp_f32 v6, v6
    v_exp_f32 v7, v7
    v_exp_f32 v8, v8
    v_exp_f32 v9, v9
    v_exp_f32 v10, v10
    v_exp_f32 v11, v11
    v_exp_f32 v12, v12
    v_smfmac_f32_32x32x32_bf16 v[64:79], v[226:229], v[0:7], v236
    v_exp_f32 v13, v13
    v_exp_f32 v14, v14
    v_exp_f32 v15, v15
    v_exp_f32 v16, v16
    s_mov_b64 exec, s[62:63]
    buffer_load_dwordx4 v[218:221], v241, s[24:27], s76 offen sc1
    buffer_load_dwordx4 v[222:225], v241, s[24:27], s77 offen sc1
    s_mov_b64 exec, -1
    v_exp_f32 v17, v17
    v_smfmac_f32_32x32x32_bf16 v[64:79], v[230:233], v[8:15], v236
    v_exp_f32 v18, v18
    v_exp_f32 v19, v19
    v_exp_f32 v20, v20
    v_mfma_f32_32x32x16_bf16 v[32:47], v[176:179], v[132:135], v[32:47]
    v_exp_f32 v21, v21
    v_exp_f32 v22, v22
    v_exp_f32 v23, v23
    v_exp_f32 v24, v24
    s_add_u32 m0, s42, 12288
    s_nop 0
    buffer_load_dwordx4 v237, s[16:19], s10 offen lds
    v_exp_f32 v25, v25
    v_smfmac_f32_32x32x32_bf16 v[96:111], v[226:229], v[16:23], v236
    v_exp_f32 v26, v26
    v_exp_f32 v27, v27
    v_exp_f32 v28, v28
    v_mfma_f32_32x32x16_bf16 v[48:63], v[176:179], v[140:143], v[48:63]
    v_exp_f32 v29, v29
    v_exp_f32 v30, v30
    v_exp_f32 v31, v31
    v_exp_f32 v32, v32
    s_add_u32 m0, s42, 4096
    s_add_u32 s67, s54, 294912
    buffer_load_dwordx4 v234, s[20:23], s67 offen nt lds
    v_exp_f32 v33, v33
    v_smfmac_f32_32x32x32_bf16 v[96:111], v[230:233], v[24:31], v236
    s_waitcnt vmcnt(14)
    v_exp_f32 v34, v34
    v_exp_f32 v35, v35
    v_exp_f32 v36, v36
    v_mfma_f32_32x32x4_2b_bf16 v[0:31], v[156:157], v[144:145], 0 cbsz:1 abid:1
    v_exp_f32 v37, v37
    v_exp_f32 v38, v38
    v_exp_f32 v39, v39
    v_exp_f32 v40, v40
    v_exp_f32 v41, v41
    v_exp_f32 v42, v42
    v_mov_b64 v[188:189], v[184:185]
    v_exp_f32 v43, v43
    v_exp_f32 v44, v44
    v_smfmac_f32_32x32x32_bf16 v[80:95], v[226:229], v[32:39], v236
    v_exp_f32 v45, v45
    v_exp_f32 v46, v46
    v_exp_f32 v47, v47
    v_exp_f32 v48, v48
    s_add_u32 m0, s42, 13312
    s_nop 0
    buffer_load_dwordx4 v237, s[16:19], s11 offen lds
    v_exp_f32 v49, v49
    v_smfmac_f32_32x32x32_bf16 v[80:95], v[230:233], v[40:47], v236
    v_exp_f32 v50, v50
    v_exp_f32 v51, v51
    v_exp_f32 v52, v52
    v_mfma_f32_32x32x16_bf16 v[0:15], v[188:191], v[128:131], v[0:15]
    v_exp_f32 v53, v53
    v_exp_f32 v54, v54
    v_exp_f32 v55, v55
    v_exp_f32 v56, v56
    v_exp_f32 v57, v57
    v_smfmac_f32_32x32x32_bf16 v[112:127], v[226:229], v[48:55], v236
    v_exp_f32 v58, v58
    v_exp_f32 v59, v59
    v_exp_f32 v60, v60
    v_mfma_f32_32x32x16_bf16 v[16:31], v[188:191], v[136:139], v[16:31]
    v_exp_f32 v61, v61
    v_exp_f32 v62, v62
    v_exp_f32 v63, v63
    v_exp_f32 v0, v0
    s_add_u32 m0, s9, 4096
    s_add_u32 s67, s8, 4096
    buffer_load_dwordx4 v237, s[28:31], s67 offen nt lds
    v_exp_f32 v1, v1
    v_smfmac_f32_32x32x32_bf16 v[112:127], v[230:233], v[56:63], v236
    v_exp_f32 v2, v2
    v_exp_f32 v3, v3
    v_exp_f32 v4, v4
    v_mfma_f32_32x32x4_2b_bf16 v[32:63], v[156:157], v[146:147], 0 cbsz:1 abid:1
    v_exp_f32 v5, v5
    v_exp_f32 v6, v6
    v_exp_f32 v7, v7
    v_exp_f32 v8, v8
    v_exp_f32 v9, v9
    v_exp_f32 v10, v10
    v_exp_f32 v11, v11
    v_exp_f32 v12, v12
    v_smfmac_f32_32x32x32_bf16 v[64:79], v[194:197], v[0:7], v236
    v_exp_f32 v13, v13
    v_exp_f32 v14, v14
    v_exp_f32 v15, v15
    v_exp_f32 v16, v16
    buffer_load_dwordx4 v[174:177], v240, s[24:27], s78 offen sc1
    v_exp_f32 v17, v17
    v_smfmac_f32_32x32x32_bf16 v[64:79], v[198:201], v[8:15], v236
    v_exp_f32 v18, v18
    v_exp_f32 v19, v19
    v_exp_f32 v20, v20
    v_mfma_f32_32x32x16_bf16 v[32:47], v[188:191], v[132:135], v[32:47]
    v_exp_f32 v21, v21
    v_exp_f32 v22, v22
    v_exp_f32 v23, v23
    v_exp_f32 v24, v24
    buffer_load_dwordx4 v[180:183], v240, s[24:27], s78 offen offset:256 sc1
    v_exp_f32 v25, v25
    v_smfmac_f32_32x32x32_bf16 v[96:111], v[194:197], v[16:23], v236
    v_exp_f32 v26, v26
    v_exp_f32 v27, v27
    v_exp_f32 v28, v28
    v_mfma_f32_32x32x16_bf16 v[48:63], v[188:191], v[140:143], v[48:63]
    v_exp_f32 v29, v29
    v_exp_f32 v30, v30
    v_exp_f32 v31, v31
    v_exp_f32 v32, v32
    s_add_u32 m0, s9, 4096
    s_add_u32 s67, s8, 4096
    buffer_load_dwordx4 v237, s[28:31], s67 offen offset:1024 nt lds
    v_exp_f32 v33, v33
    v_smfmac_f32_32x32x32_bf16 v[96:111], v[198:201], v[24:31], v236
    s_waitcnt vmcnt(16)
    v_exp_f32 v34, v34
    v_exp_f32 v35, v35
    v_exp_f32 v36, v36
    v_mfma_f32_32x32x4_2b_bf16 v[0:31], v[158:159], v[144:145], 0 cbsz:1 abid:1
    v_exp_f32 v37, v37
    v_exp_f32 v38, v38
    v_exp_f32 v39, v39
    v_exp_f32 v40, v40
    v_exp_f32 v41, v41
    v_exp_f32 v42, v42
    v_mov_b64 v[188:189], v[192:193]
    v_exp_f32 v43, v43
    v_exp_f32 v44, v44
    v_smfmac_f32_32x32x32_bf16 v[80:95], v[194:197], v[32:39], v236
    v_exp_f32 v45, v45
    v_exp_f32 v46, v46
    v_exp_f32 v47, v47
    v_exp_f32 v48, v48
    s_mov_b64 exec, s[62:63]
    buffer_load_dwordx4 v[226:229], v238, s[24:27], s78 offen sc1
    buffer_load_dwordx4 v[230:233], v238, s[24:27], s79 offen sc1
    s_mov_b64 exec, -1
    v_exp_f32 v49, v49
    v_smfmac_f32_32x32x32_bf16 v[80:95], v[198:201], v[40:47], v236
    v_exp_f32 v50, v50
    v_exp_f32 v51, v51
    v_exp_f32 v52, v52
    v_mfma_f32_32x32x16_bf16 v[0:15], v[186:189], v[128:131], v[0:15]
    v_exp_f32 v53, v53
    v_exp_f32 v54, v54
    v_exp_f32 v55, v55
    v_exp_f32 v56, v56
    v_exp_f32 v57, v57
    v_smfmac_f32_32x32x32_bf16 v[112:127], v[194:197], v[48:55], v236
    v_exp_f32 v58, v58
    v_exp_f32 v59, v59
    v_exp_f32 v60, v60
    v_mfma_f32_32x32x16_bf16 v[16:31], v[186:189], v[136:139], v[16:31]
    v_exp_f32 v61, v61
    v_exp_f32 v62, v62
    v_exp_f32 v63, v63
    v_exp_f32 v0, v0
    s_add_u32 m0, s42, 5120
    s_add_u32 s67, s54, 368640
    buffer_load_dwordx4 v234, s[20:23], s67 offen nt lds
    v_exp_f32 v1, v1
    v_smfmac_f32_32x32x32_bf16 v[112:127], v[198:201], v[56:63], v236
    v_exp_f32 v2, v2
    v_exp_f32 v3, v3
    v_exp_f32 v4, v4
    v_mfma_f32_32x32x4_2b_bf16 v[32:63], v[158:159], v[146:147], 0 cbsz:1 abid:1
    v_exp_f32 v5, v5
    v_exp_f32 v6, v6
    v_exp_f32 v7, v7
    v_exp_f32 v8, v8
    v_exp_f32 v9, v9
    v_exp_f32 v10, v10
    v_exp_f32 v11, v11
    v_exp_f32 v12, v12
    v_smfmac_f32_32x32x32_bf16 v[64:79], v[202:205], v[0:7], v236
    v_exp_f32 v13, v13
    v_exp_f32 v14, v14
    v_exp_f32 v15, v15
    v_exp_f32 v16, v16
    s_mov_b64 exec, s[62:63]
    buffer_load_dwordx4 v[194:197], v241, s[24:27], s78 offen sc1
    buffer_load_dwordx4 v[198:201], v241, s[24:27], s79 offen sc1
    s_mov_b64 exec, -1
    v_exp_f32 v17, v17
    v_smfmac_f32_32x32x32_bf16 v[64:79], v[206:209], v[8:15], v236
    v_exp_f32 v18, v18
    v_exp_f32 v19, v19
    v_exp_f32 v20, v20
    v_mfma_f32_32x32x16_bf16 v[32:47], v[186:189], v[132:135], v[32:47]
    v_exp_f32 v21, v21
    v_exp_f32 v22, v22
    v_exp_f32 v23, v23
    v_exp_f32 v24, v24
    v_exp_f32 v25, v25
    v_smfmac_f32_32x32x32_bf16 v[96:111], v[202:205], v[16:23], v236
    v_exp_f32 v26, v26
    v_exp_f32 v27, v27
    v_exp_f32 v28, v28
    v_mfma_f32_32x32x16_bf16 v[48:63], v[186:189], v[140:143], v[48:63]
    v_exp_f32 v29, v29
    v_exp_f32 v30, v30
    v_exp_f32 v31, v31
    v_exp_f32 v32, v32
    s_add_u32 m0, s42, 6144
    s_add_u32 s67, s54, 442368
    buffer_load_dwordx4 v234, s[20:23], s67 offen nt lds
    v_exp_f32 v33, v33
    v_smfmac_f32_32x32x32_bf16 v[96:111], v[206:209], v[24:31], v236
    s_waitcnt vmcnt(15)
    v_exp_f32 v34, v34
    v_exp_f32 v35, v35
    v_exp_f32 v36, v36
    v_mfma_f32_32x32x4_2b_bf16 v[0:31], v[160:161], v[144:145], 0 cbsz:1 abid:0
    v_exp_f32 v37, v37
    v_exp_f32 v38, v38
    v_exp_f32 v39, v39
    v_exp_f32 v40, v40
    ds_read_b32 v250, v235 offset:3072
    v_exp_f32 v41, v41
    v_exp_f32 v42, v42
    v_mov_b64 v[168:169], v[164:165]
    v_exp_f32 v43, v43
    v_exp_f32 v44, v44
    v_smfmac_f32_32x32x32_bf16 v[80:95], v[202:205], v[32:39], v236
    v_exp_f32 v45, v45
    v_exp_f32 v46, v46
    v_exp_f32 v47, v47
    v_exp_f32 v48, v48
    s_add_u32 m0, s42, 7168
    s_add_u32 s67, s54, 516096
    buffer_load_dwordx4 v234, s[20:23], s67 offen nt lds
    v_exp_f32 v49, v49
    v_smfmac_f32_32x32x32_bf16 v[80:95], v[206:209], v[40:47], v236
    v_exp_f32 v50, v50
    v_exp_f32 v51, v51
    v_exp_f32 v52, v52
    v_mfma_f32_32x32x16_bf16 v[0:15], v[168:171], v[128:131], v[0:15]
    v_exp_f32 v53, v53
    v_exp_f32 v54, v54
    v_exp_f32 v55, v55
    v_exp_f32 v56, v56
    v_exp_f32 v57, v57
    v_smfmac_f32_32x32x32_bf16 v[112:127], v[202:205], v[48:55], v236
    v_exp_f32 v58, v58
    v_exp_f32 v59, v59
    v_exp_f32 v60, v60
    v_mfma_f32_32x32x16_bf16 v[16:31], v[168:171], v[136:139], v[16:31]
    v_exp_f32 v61, v61
    v_exp_f32 v62, v62
    v_exp_f32 v63, v63
    v_exp_f32 v0, v0
    s_add_u32 m0, s42, 8192
    s_add_u32 s67, s54, 589824
    buffer_load_dwordx4 v234, s[20:23], s67 offen nt lds
    v_exp_f32 v1, v1
    v_smfmac_f32_32x32x32_bf16 v[112:127], v[206:209], v[56:63], v236
    v_exp_f32 v2, v2
    ds_read_b128 v[152:155], v235
    v_exp_f32 v3, v3
    v_exp_f32 v4, v4
    v_mfma_f32_32x32x4_2b_bf16 v[32:63], v[160:161], v[146:147], 0 cbsz:1 abid:0
    v_exp_f32 v5, v5
    v_exp_f32 v6, v6
    v_exp_f32 v7, v7
    v_exp_f32 v8, v8
    v_exp_f32 v9, v9
    v_exp_f32 v10, v10
    v_exp_f32 v11, v11
    s_waitcnt lgkmcnt(0)
    s_add_u32 m0, s97, 0
    s_add_u32 s4, s34, 0
    buffer_load_dwordx4 v250, s[16:19], s4 offen lds
    v_exp_f32 v12, v12
    v_smfmac_f32_32x32x32_bf16 v[64:79], v[210:213], v[0:7], v236
    v_exp_f32 v13, v13
    v_exp_f32 v14, v14
    v_exp_f32 v15, v15
    v_exp_f32 v16, v16
    v_exp_f32 v17, v17
    v_smfmac_f32_32x32x32_bf16 v[64:79], v[214:217], v[8:15], v236
    v_exp_f32 v18, v18
    v_exp_f32 v19, v19
    v_exp_f32 v20, v20
    v_mfma_f32_32x32x16_bf16 v[32:47], v[168:171], v[132:135], v[32:47]
    v_exp_f32 v21, v21
    v_exp_f32 v22, v22
    v_exp_f32 v23, v23
    v_exp_f32 v24, v24
    v_exp_f32 v25, v25
    v_smfmac_f32_32x32x32_bf16 v[96:111], v[210:213], v[16:23], v236
    v_exp_f32 v26, v26
    s_waitcnt lgkmcnt(0)
    v_exp_f32 v27, v27
    buffer_load_dwordx2 v[190:191], v155, s[24:27], s52 offen sc1
    v_exp_f32 v28, v28
    v_mfma_f32_32x32x16_bf16 v[48:63], v[168:171], v[140:143], v[48:63]
    v_exp_f32 v29, v29
    v_exp_f32 v30, v30
    v_exp_f32 v31, v31
    v_exp_f32 v32, v32
    s_add_u32 m0, s42, 9216
    s_add_u32 s67, s54, 663552
    buffer_load_dwordx4 v234, s[20:23], s67 offen nt lds
    v_exp_f32 v33, v33
    v_smfmac_f32_32x32x32_bf16 v[96:111], v[214:217], v[24:31], v236
    s_waitcnt vmcnt(18)
    v_exp_f32 v34, v34
    v_exp_f32 v35, v35
    v_exp_f32 v36, v36
    v_mfma_f32_32x32x4_2b_bf16 v[0:31], v[162:163], v[144:145], 0 cbsz:1 abid:0
    v_exp_f32 v37, v37
    v_exp_f32 v38, v38
    v_exp_f32 v39, v39
    v_exp_f32 v40, v40
    v_exp_f32 v41, v41
    v_exp_f32 v42, v42
    v_mov_b64 v[168:169], v[172:173]
    v_exp_f32 v43, v43
    s_add_u32 m0, s97, 1008
    s_add_u32 s4, s34, 8064
    buffer_load_dwordx4 v250, s[16:19], s4 offen lds
    v_exp_f32 v44, v44
    v_smfmac_f32_32x32x32_bf16 v[80:95], v[210:213], v[32:39], v236
    v_exp_f32 v45, v45
    v_exp_f32 v46, v46
    v_exp_f32 v47, v47
    v_exp_f32 v48, v48
    v_exp_f32 v49, v49
    v_smfmac_f32_32x32x32_bf16 v[80:95], v[214:217], v[40:47], v236
    v_exp_f32 v50, v50
    v_exp_f32 v51, v51
    v_exp_f32 v52, v52
    v_mfma_f32_32x32x16_bf16 v[0:15], v[166:169], v[128:131], v[0:15]
    v_exp_f32 v53, v53
    v_exp_f32 v54, v54
    v_exp_f32 v55, v55
    v_exp_f32 v56, v56
    v_exp_f32 v57, v57
    v_smfmac_f32_32x32x32_bf16 v[112:127], v[210:213], v[48:55], v236
    v_exp_f32 v58, v58
    v_exp_f32 v59, v59
    v_exp_f32 v60, v60
    v_mfma_f32_32x32x16_bf16 v[16:31], v[166:169], v[136:139], v[16:31]
    v_exp_f32 v61, v61
    v_exp_f32 v62, v62
    v_exp_f32 v63, v63
    v_exp_f32 v0, v0
    s_add_u32 m0, s42, 10240
    s_add_u32 s67, s54, 737280
    buffer_load_dwordx4 v234, s[20:23], s67 offen nt lds
    v_exp_f32 v1, v1
    v_smfmac_f32_32x32x32_bf16 v[112:127], v[214:217], v[56:63], v236
    v_exp_f32 v2, v2
    v_exp_f32 v3, v3
    v_exp_f32 v4, v4
    v_mfma_f32_32x32x4_2b_bf16 v[32:63], v[162:163], v[146:147], 0 cbsz:1 abid:0
    v_exp_f32 v5, v5
    v_exp_f32 v6, v6
    v_exp_f32 v7, v7
    v_exp_f32 v8, v8
    v_exp_f32 v9, v9
    v_exp_f32 v10, v10
    v_exp_f32 v11, v11
    s_add_u32 m0, s97, 2016
    s_add_u32 s4, s34, 16128
    buffer_load_dwordx4 v250, s[16:19], s4 offen lds
    v_exp_f32 v12, v12
    v_smfmac_f32_32x32x32_bf16 v[64:79], v[218:221], v[0:7], v236
    v_exp_f32 v13, v13
    v_exp_f32 v14, v14
    v_exp_f32 v15, v15
    v_exp_f32 v16, v16
    s_add_u32 m0, s9, 4096
    s_add_u32 s67, s8, 4096
    buffer_load_dwordx4 v237, s[28:31], s67 offen offset:2048 nt lds
    v_exp_f32 v17, v17
    v_smfmac_f32_32x32x32_bf16 v[64:79], v[222:225], v[8:15], v236
    v_exp_f32 v18, v18
    v_exp_f32 v19, v19
    v_exp_f32 v20, v20
    v_mfma_f32_32x32x16_bf16 v[32:47], v[166:169], v[132:135], v[32:47]
    v_exp_f32 v21, v21
    v_exp_f32 v22, v22
    v_exp_f32 v23, v23
    v_exp_f32 v24, v24
    v_exp_f32 v25, v25
    v_smfmac_f32_32x32x32_bf16 v[96:111], v[218:221], v[16:23], v236
    v_exp_f32 v26, v26
    v_exp_f32 v27, v27
    v_exp_f32 v28, v28
    v_mfma_f32_32x32x16_bf16 v[48:63], v[166:169], v[140:143], v[48:63]
    v_exp_f32 v29, v29
    v_exp_f32 v30, v30
    v_exp_f32 v31, v31
    v_exp_f32 v32, v32
    s_add_u32 m0, s42, 11264
    s_add_u32 s67, s54, 811008
    buffer_load_dwordx4 v234, s[20:23], s67 offen nt lds
    v_exp_f32 v33, v33
    v_smfmac_f32_32x32x32_bf16 v[96:111], v[222:225], v[24:31], v236
    s_waitcnt vmcnt(14)
    v_exp_f32 v34, v34
    v_exp_f32 v35, v35
    v_exp_f32 v36, v36
    v_mfma_f32_32x32x4_2b_bf16 v[0:31], v[160:161], v[144:145], 0 cbsz:1 abid:1
    v_exp_f32 v37, v37
    v_exp_f32 v38, v38
    v_exp_f32 v39, v39
    v_exp_f32 v40, v40
    v_mov_b32 v251, v246
    v_exp_f32 v41, v41
    v_exp_f32 v42, v42
    v_mov_b64 v[178:179], v[174:175]
    v_exp_f32 v43, v43
    v_exp_f32 v44, v44
    v_smfmac_f32_32x32x32_bf16 v[80:95], v[218:221], v[32:39], v236
    v_exp_f32 v45, v45
    v_exp_f32 v46, v46
    v_mov_b32 v253, v246
    v_exp_f32 v47, v47
    v_exp_f32 v48, v48
    s_add_u32 m0, s9, 4096
    s_add_u32 s67, s8, 4096
    buffer_load_dwordx4 v237, s[28:31], s67 offen offset:3072 nt lds
    v_exp_f32 v49, v49
    v_smfmac_f32_32x32x32_bf16 v[80:95], v[222:225], v[40:47], v236
    v_exp_f32 v50, v50
    v_exp_f32 v51, v51
    v_exp_f32 v52, v52
    v_mfma_f32_32x32x16_bf16 v[0:15], v[178:181], v[128:131], v[0:15]
    v_exp_f32 v53, v53
    v_exp_f32 v54, v54
    v_exp_f32 v55, v55
    v_exp_f32 v56, v56
    v_exp_f32 v57, v57
    v_smfmac_f32_32x32x32_bf16 v[112:127], v[218:221], v[48:55], v236
    v_exp_f32 v58, v58
    v_exp_f32 v59, v59
    v_exp_f32 v60, v60
    v_mfma_f32_32x32x16_bf16 v[16:31], v[178:181], v[136:139], v[16:31]
    v_exp_f32 v61, v61
    v_exp_f32 v62, v62
    v_exp_f32 v63, v63
    v_exp_f32 v0, v0
    s_add_u32 m0, s9, 8192
    s_add_u32 s67, s8, 8192
    buffer_load_dwordx4 v237, s[28:31], s67 offen nt lds
    v_exp_f32 v1, v1
    v_smfmac_f32_32x32x32_bf16 v[112:127], v[222:225], v[56:63], v236
    v_exp_f32 v2, v2
    ds_read_b128 v[148:151], v153 offset:12288
    ds_read_b64_tr_b16 v[218:219], v152
    ds_read_b64_tr_b16 v[220:221], v152 offset:512
    ds_read_b64_tr_b16 v[222:223], v152 offset:32
    ds_read_b64_tr_b16 v[224:225], v152 offset:544
    ds_read_b64_tr_b16 v[164:165], v152 offset:64
    ds_read_b64_tr_b16 v[166:167], v152 offset:576
    ds_read_b64_tr_b16 v[168:169], v152 offset:96
    ds_read_b64_tr_b16 v[170:171], v152 offset:608
    v_exp_f32 v3, v3
    v_exp_f32 v4, v4
    v_mfma_f32_32x32x4_2b_bf16 v[32:63], v[160:161], v[146:147], 0 cbsz:1 abid:1
    v_exp_f32 v5, v5
    v_exp_f32 v6, v6
    v_exp_f32 v7, v7
    v_exp_f32 v8, v8
    v_exp_f32 v9, v9
    v_exp_f32 v10, v10
    v_exp_f32 v11, v11
    s_waitcnt lgkmcnt(6)
    v_mfma_f32_16x16x32_bf16 v[202:205], v[148:151], v[218:221], 0
    v_exp_f32 v12, v12
    v_smfmac_f32_32x32x32_bf16 v[64:79], v[226:229], v[0:7], v236
    v_exp_f32 v13, v13
    v_exp_f32 v14, v14
    v_exp_f32 v15, v15
    v_exp_f32 v16, v16
    s_waitcnt lgkmcnt(0)
    v_mfma_f32_16x16x32_bf16 v[206:209], v[148:151], v[222:225], 0
    v_exp_f32 v17, v17
    v_smfmac_f32_32x32x32_bf16 v[64:79], v[230:233], v[8:15], v236
    v_exp_f32 v18, v18
    v_exp_f32 v19, v19
    v_exp_f32 v20, v20
    v_mfma_f32_32x32x16_bf16 v[32:47], v[178:181], v[132:135], v[32:47]
    v_exp_f32 v21, v21
    v_exp_f32 v22, v22
    v_exp_f32 v23, v23
    v_exp_f32 v24, v24
    v_mfma_f32_16x16x32_bf16 v[210:213], v[148:151], v[164:167], 0
    v_exp_f32 v25, v25
    v_smfmac_f32_32x32x32_bf16 v[96:111], v[226:229], v[16:23], v236
    v_exp_f32 v26, v26
    v_exp_f32 v27, v27
    v_exp_f32 v28, v28
    v_mfma_f32_32x32x16_bf16 v[48:63], v[178:181], v[140:143], v[48:63]
    v_exp_f32 v29, v29
    v_exp_f32 v30, v30
    v_exp_f32 v31, v31
    v_mfma_f32_16x16x32_bf16 v[214:217], v[148:151], v[168:171], 0
    v_exp_f32 v32, v32
    v_exp_f32 v33, v33
    v_smfmac_f32_32x32x32_bf16 v[96:111], v[230:233], v[24:31], v236
    s_waitcnt vmcnt(13)
    s_waitcnt vmcnt(11)
    v_exp_f32 v34, v34
    ds_read_b128 v[148:151], v153 offset:12352
    ds_read_b64_tr_b16 v[218:219], v152 offset:4096
    ds_read_b64_tr_b16 v[220:221], v152 offset:4608
    ds_read_b64_tr_b16 v[222:223], v152 offset:4128
    ds_read_b64_tr_b16 v[224:225], v152 offset:4640
    ds_read_b64_tr_b16 v[164:165], v152 offset:4160
    ds_read_b64_tr_b16 v[166:167], v152 offset:4672
    ds_read_b64_tr_b16 v[168:169], v152 offset:4192
    ds_read_b64_tr_b16 v[170:171], v152 offset:4704
    v_exp_f32 v35, v35
    v_exp_f32 v36, v36
    v_mfma_f32_32x32x4_2b_bf16 v[0:31], v[162:163], v[144:145], 0 cbsz:1 abid:1
    v_exp_f32 v37, v37
    v_exp_f32 v38, v38
    v_exp_f32 v39, v39
    v_exp_f32 v40, v40
    v_exp_f32 v41, v41
    v_exp_f32 v42, v42
    v_mov_b64 v[178:179], v[182:183]
    v_exp_f32 v43, v43
    s_waitcnt lgkmcnt(6)
    v_mfma_f32_16x16x32_bf16 v[202:205], v[148:151], v[218:221], v[202:205]
    v_exp_f32 v44, v44
    v_smfmac_f32_32x32x32_bf16 v[80:95], v[226:229], v[32:39], v236
    v_exp_f32 v45, v45
    v_exp_f32 v46, v46
    v_exp_f32 v47, v47
    v_exp_f32 v48, v48
    s_waitcnt lgkmcnt(0)
    v_mfma_f32_16x16x32_bf16 v[206:209], v[148:151], v[222:225], v[206:209]
    v_exp_f32 v49, v49
    v_smfmac_f32_32x32x32_bf16 v[80:95], v[230:233], v[40:47], v236
    v_exp_f32 v50, v50
    v_exp_f32 v51, v51
    v_exp_f32 v52, v52
    v_mfma_f32_32x32x16_bf16 v[0:15], v[176:179], v[128:131], v[0:15]
    v_exp_f32 v53, v53
    v_exp_f32 v54, v54
    v_exp_f32 v55, v55
    v_exp_f32 v56, v56
    v_mfma_f32_16x16x32_bf16 v[210:213], v[148:151], v[164:167], v[210:213]
    v_exp_f32 v57, v57
    v_smfmac_f32_32x32x32_bf16 v[112:127], v[226:229], v[48:55], v236
    v_exp_f32 v58, v58
    v_exp_f32 v59, v59
    v_exp_f32 v60, v60
    v_mfma_f32_32x32x16_bf16 v[16:31], v[176:179], v[136:139], v[16:31]
    v_exp_f32 v61, v61
    v_exp_f32 v62, v62
    v_exp_f32 v63, v63
    v_mfma_f32_16x16x32_bf16 v[214:217], v[148:151], v[168:171], v[214:217]
    v_exp_f32 v0, v0
    s_waitcnt vmcnt(8)
    v_cmp_ne_u32 vcc, s53, v191
    s_cbranch_vccnz K2_gqspin1
K2_gqok1:
    v_exp_f32 v1, v1
    v_smfmac_f32_32x32x32_bf16 v[112:127], v[230:233], v[56:63], v236
    s_waitcnt vmcnt(2)
    v_exp_f32 v2, v2
    ds_read_b128 v[148:151], v153 offset:12416
    ds_read_b64_tr_b16 v[218:219], v152 offset:8192
    ds_read_b64_tr_b16 v[220:221], v152 offset:8704
    ds_read_b64_tr_b16 v[222:223], v152 offset:8224
    ds_read_b64_tr_b16 v[224:225], v152 offset:8736
    ds_read_b64_tr_b16 v[164:165], v152 offset:8256
    ds_read_b64_tr_b16 v[166:167], v152 offset:8768
    ds_read_b64_tr_b16 v[168:169], v152 offset:8288
    ds_read_b64_tr_b16 v[170:171], v152 offset:8800
    v_exp_f32 v3, v3
    v_exp_f32 v4, v4
    v_mfma_f32_32x32x4_2b_bf16 v[32:63], v[162:163], v[146:147], 0 cbsz:1 abid:1
    v_exp_f32 v5, v5
    v_exp_f32 v6, v6
    v_exp_f32 v7, v7
    v_exp_f32 v8, v8
    v_exp_f32 v9, v9
    v_exp_f32 v10, v10
    v_exp_f32 v11, v11
    s_waitcnt lgkmcnt(6)
    v_mfma_f32_16x16x32_bf16 v[202:205], v[148:151], v[218:221], v[202:205]
    v_exp_f32 v12, v12
    v_smfmac_f32_32x32x32_bf16 v[64:79], v[194:197], v[0:7], v236
    v_exp_f32 v13, v13
    v_exp_f32 v14, v14
    v_exp_f32 v15, v15
    v_exp_f32 v16, v16
    s_waitcnt lgkmcnt(0)
    v_mfma_f32_16x16x32_bf16 v[206:209], v[148:151], v[222:225], v[206:209]
    v_exp_f32 v17, v17
    v_smfmac_f32_32x32x32_bf16 v[64:79], v[198:201], v[8:15], v236
    v_exp_f32 v18, v18
    v_exp_f32 v19, v19
    v_exp_f32 v20, v20
    v_mfma_f32_32x32x16_bf16 v[32:47], v[176:179], v[132:135], v[32:47]
    v_exp_f32 v21, v21
    v_exp_f32 v22, v22
    v_exp_f32 v23, v23
    v_exp_f32 v24, v24
    v_mfma_f32_16x16x32_bf16 v[210:213], v[148:151], v[164:167], v[210:213]
    v_exp_f32 v25, v25
    v_smfmac_f32_32x32x32_bf16 v[96:111], v[194:197], v[16:23], v236
    v_exp_f32 v26, v26
    v_exp_f32 v27, v27
    v_exp_f32 v28, v28
    v_mfma_f32_32x32x16_bf16 v[48:63], v[176:179], v[140:143], v[48:63]
    v_exp_f32 v29, v29
    v_exp_f32 v30, v30
    v_exp_f32 v31, v31
    v_mfma_f32_16x16x32_bf16 v[214:217], v[148:151], v[168:171], v[214:217]
    v_exp_f32 v32, v32
    ds_write_b128 v243, v[64:67]
    v_exp_f32 v33, v33
    v_smfmac_f32_32x32x32_bf16 v[96:111], v[198:201], v[24:31], v236
    v_exp_f32 v34, v34
    v_exp_f32 v35, v35
    v_exp_f32 v36, v36
    ds_write_b128 v243, v[68:71] offset:1024
    v_exp_f32 v37, v37
    v_exp_f32 v38, v38
    v_exp_f32 v39, v39
    s_mov_b32 s10, 0
    s_mov_b32 s11, -1
    s_add_u32 s4, s59, 6144
    v_cndmask_b32 v250, v202, v206, s[10:11]
    buffer_store_dwordx2 v[250:251], v154, s[24:27], s59 offen sc1
    v_exp_f32 v40, v40
    ds_write_b64 v243, v[72:73] offset:6144
    v_exp_f32 v41, v41
    v_cndmask_b32 v252, v210, v214, s[10:11]
    buffer_store_dwordx2 v[252:253], v154, s[24:27], s4 offen sc1
    v_exp_f32 v42, v42
    v_exp_f32 v43, v43
    v_exp_f32 v44, v44
    v_smfmac_f32_32x32x32_bf16 v[80:95], v[194:197], v[32:39], v236
    v_exp_f32 v45, v45
    ds_write_b128 v243, v[96:99] offset:4096
    v_exp_f32 v46, v46
    v_exp_f32 v47, v47
    v_exp_f32 v48, v48
    v_exp_f32 v49, v49
    v_smfmac_f32_32x32x32_bf16 v[80:95], v[198:201], v[40:47], v236
    v_exp_f32 v50, v50
    ds_write_b128 v243, v[100:103] offset:5120
    v_exp_f32 v51, v51
    v_exp_f32 v52, v52
    v_exp_f32 v53, v53
    v_exp_f32 v54, v54
    v_exp_f32 v55, v55
    ds_write_b64 v243, v[104:105] offset:7168
    v_exp_f32 v56, v56
    v_exp_f32 v57, v57
    v_smfmac_f32_32x32x32_bf16 v[112:127], v[194:197], v[48:55], v236
    v_exp_f32 v58, v58
    v_exp_f32 v59, v59
    v_exp_f32 v60, v60
    ds_write_b128 v243, v[80:83] offset:2048
    v_exp_f32 v61, v61
    v_exp_f32 v62, v62
    ds_write_b128 v243, v[84:87] offset:3072
    v_exp_f32 v63, v63
    ds_write_b64 v243, v[88:89] offset:6152
    s_nop 1
    v_smfmac_f32_32x32x32_bf16 v[112:127], v[198:201], v[56:63], v236
    s_and_b32 s4, s40, 1
    s_lshl_b32 s4, s4, 1
    s_lshr_b32 s5, s40, 1
    s_add_u32 s4, s4, s5
    s_lshl_b32 s5, s41, 2
    s_add_u32 s4, s4, s5
    s_mul_i32 s4, s4, 1536
    s_add_u32 s67, s4, 11534336
    s_cmp_eq_u32 s64, 0
    s_cbranch_scc1 K2_fin0
    buffer_load_dwordx2 v[184:185], v154, s[24:27], s67 offen sc1
    buffer_load_dwordx2 v[186:187], v154, s[24:27], s67 offen offset:512 sc1
    buffer_load_dwordx2 v[188:189], v154, s[24:27], s67 offen offset:1024 sc1
    s_branch K2_fin0
K2_young2:
    s_mul_i32 s4, s40, 8192
    s_add_u32 s4, s4, 129024
    v_add_u32 v243, s4, v237
    s_xor_b32 s4, s40, 3
    s_mul_i32 s4, s4, 8192
    s_add_u32 s4, s4, 129024
    v_add_u32 v247, s4, v237
    s_xor_b32 s4, s40, 2
    s_mul_i32 s4, s4, 8192
    s_add_u32 s4, s4, 129024
    v_add_u32 v248, s4, v237
    s_xor_b32 s4, s40, 1
    s_mul_i32 s4, s4, 8192
    s_add_u32 s4, s4, 129024
    v_add_u32 v249, s4, v237
    v_bfe_u32 v244, v239, 4, 1
    v_lshlrev_b32 v244, 14, v244
    v_lshrrev_b32 v245, 5, v239
    v_lshl_add_u32 v244, v245, 8, v244
    v_and_b32 v245, 0xff, v237
    v_add_u32 v244, v244, v245
    v_and_b32 v245, 31, v239
    v_lshlrev_b32 v245, 2, v245
    s_lshl_b32 s4, s39, 6
    s_lshl_b32 s5, s37, 2
    s_add_u32 s4, s4, s5
    s_add_u32 s4, s4, s40
    s_lshl_b32 s5, s4, 1
    s_and_b32 s6, s40, 1
    s_sub_u32 s5, s5, s6
    s_lshl_b32 s5, s5, 13
    s_lshl_b32 s6, s43, 9
    s_add_u32 s5, s5, s6
    s_add_u32 s65, s5, 7340032
    s_lshl_b32 s4, s4, 4
    s_add_u32 s4, s4, s43
    s_lshl_b32 s4, s4, 7
    s_add_u32 s66, s4, 9437184
    s_lshl_b32 s4, s37, 10
    s_lshr_b32 s5, s40, 1
    s_lshl_b32 s5, s5, 9
    s_add_u32 s4, s4, s5
    s_and_b32 s5, s40, 1
    s_lshl_b32 s5, s5, 7
    s_add_u32 s4, s4, s5
    s_add_u32 s52, s4, 7307264
    s_lshl2_add_u32 s4, s37, s40
    s_lshl_b32 s4, s4, 7
    s_lshl2_add_u32 s4, s43, s4
    s_add_u32 s61, s4, 10485760
    v_mov_b32 v255, 163340
    v_mov_b32 v254, 1
    s_barrier
    s_mul_i32 s42, s40, 14336
    s_mul_i32 s4, s40, 3072
    s_add_u32 s97, s4, 94208
    s_mul_i32 s4, s40, 5120
    s_add_u32 s4, s4, 106496
    v_add_u32 v235, s4, v237
    v_and_b32 v3, 15, v239
    v_lshrrev_b32 v4, 4, v239
    v_bfe_u32 v5, v239, 2, 2
    v_lshl_add_u32 v7, v4, 3, v5
    v_and_b32 v5, 1, v5
    v_and_b32 v6, 1, v4
    v_lshlrev_b32 v18, 3, v239
    v_and_b32 v8, 24, v18
    v_lshl_add_u32 v16, v7, 7, s42
    v_add_u32 v16, v16, v8
    v_lshl_add_u32 v17, v4, 4, s42
    v_lshl_add_u32 v17, v5, 10, v17
    v_and_b32 v19, 64, v245
    v_add_lshl_u32 v19, v19, v245, 1
    v_lshlrev_b32 v9, 2, v239
    v_add_u32 v21, 161792, v9
    s_lshl_b32 s4, s40, 8
    v_add_u32 v20, s4, v21
    s_mul_i32 s4, s40, 288
    s_and_b32 s4, s4, 0xffc0
    s_add_u32 s5, s4, 57344
    v_mul_u32_u24 v22, 1152, v7
    v_add3_u32 v22, v22, v8, s5
    s_lshl_b32 s5, s40, 7
    s_add_u32 s5, s5, 162816
    v_lshl_add_u32 v23, v4, 4, s5
    v_lshl_add_u32 v23, v5, 6, v23
    v_and_b32 v10, 32, v239
    v_lshl_add_u32 v24, v3, 1, s5
    v_lshl_add_u32 v24, v6, 6, v24
    v_add_u32 v24, v24, v10
    v_lshlrev_b32 v26, 2, v3
    v_mul_u32_u24 v25, 2304, v6
    v_lshl_add_u32 v25, v10, 1, v25
    s_lshl_b32 s4, s4, 1
    v_add3_u32 v25, v25, v26, s4
    v_lshlrev_b32 v27, 3, v3
    v_mul_u32_u24 v11, 7282, v239
    v_lshrrev_b32 v11, 16, v11
    v_mul_u32_u24 v11, 1008, v11
    v_add_u32 v60, v11, v237
    v_mul_u32_u24 v11, 144, v3
    v_add_u32 v11, s97, v11
    v_lshl_add_u32 v61, v4, 3, v11
    v_lshl_add_u32 v62, v6, 3, v11
    v_lshl_add_u32 v63, v4, 9, v26
    v_add_u32 v28, 46080, v237
    v_add_u32 v29, s97, v237
    ds_write_b128 v235, v[16:19]
    ds_write_b128 v235, v[20:23] offset:1024
    ds_write_b128 v235, v[24:27] offset:2048
    ds_write_b128 v235, v[60:63] offset:3072
    ds_write_b64 v235, v[28:29] offset:4096
    v_mov_b32 v234, v19
    s_waitcnt lgkmcnt(0)
    s_barrier
    s_barrier
    buffer_load_dwordx4 v[48:51], v251, s[24:27], s60 offen sc1
    buffer_load_dwordx4 v[148:151], v242, s[24:27], s44 offen sc1
    buffer_load_dwordx4 v[164:167], v240, s[24:27], s44 offen sc1
    buffer_load_dwordx4 v[170:173], v240, s[24:27], s44 offen offset:256 sc1
    buffer_load_dwordx4 v[32:35], v240, s[24:27], s56 offen sc1
    buffer_load_dwordx4 v[36:39], v240, s[24:27], s56 offen offset:256 sc1
    buffer_load_dwordx4 v[40:43], v240, s[24:27], s57 offen sc1
    buffer_load_dwordx4 v[44:47], v240, s[24:27], s57 offen offset:256 sc1
    s_mov_b64 exec, s[62:63]
    buffer_load_dwordx4 v[194:197], v238, s[24:27], s44 offen sc1
    buffer_load_dwordx4 v[198:201], v238, s[24:27], s45 offen sc1
    buffer_load_dwordx4 v[202:205], v241, s[24:27], s44 offen sc1
    buffer_load_dwordx4 v[206:209], v241, s[24:27], s45 offen sc1
    s_mov_b64 exec, -1
    v_mov_b64 v[250:251], -1
    v_mov_b64 v[252:253], -1
    v_mov_b32 v236, 0xdddddddd
    s_bitcmp0_b32 s36, 0
    s_cselect_b32 s4, -1, 0
    s_cselect_b32 s5, 0, -1
    s_bitcmp1_b32 s40, 0
    s_cbranch_scc1 K2_qsel_8
    s_waitcnt vmcnt(10)
    v_and_b32 v144, s4, v50
    v_and_b32 v145, s5, v51
    v_and_b32 v146, s4, v48
    v_and_b32 v147, s5, v49
    v_mfma_f32_32x32x4_2b_bf16 v[0:31], v[148:149], v[144:145], 0 cbsz:1 abid:0
    s_nop 11
    s_waitcnt vmcnt(6)
    v_mov_b64 v[168:169], v[164:165]
    v_mov_b64 v[128:129], v[34:35]
    v_mov_b64 v[130:131], v[38:39]
    v_mov_b64 v[132:133], v[32:33]
    v_mov_b64 v[134:135], v[36:37]
    v_mfma_f32_32x32x16_bf16 v[0:15], v[168:171], v[128:131], v[0:15]
    s_waitcnt vmcnt(4)
    v_mov_b64 v[136:137], v[42:43]
    v_mov_b64 v[138:139], v[46:47]
    v_mov_b64 v[140:141], v[40:41]
    v_mov_b64 v[142:143], v[44:45]
    v_mfma_f32_32x32x16_bf16 v[16:31], v[168:171], v[136:139], v[16:31]
    s_branch K2_qsel_8_d
K2_qsel_8:
    s_waitcnt vmcnt(10)
    v_and_b32 v144, s4, v48
    v_and_b32 v145, s5, v49
    v_and_b32 v146, s4, v50
    v_and_b32 v147, s5, v51
    v_mfma_f32_32x32x4_2b_bf16 v[0:31], v[148:149], v[144:145], 0 cbsz:1 abid:0
    s_nop 11
    s_waitcnt vmcnt(6)
    v_mov_b64 v[168:169], v[164:165]
    v_mov_b64 v[128:129], v[32:33]
    v_mov_b64 v[130:131], v[36:37]
    v_mov_b64 v[132:133], v[34:35]
    v_mov_b64 v[134:135], v[38:39]
    v_mfma_f32_32x32x16_bf16 v[0:15], v[168:171], v[128:131], v[0:15]
    s_waitcnt vmcnt(4)
    v_mov_b64 v[136:137], v[40:41]
    v_mov_b64 v[138:139], v[44:45]
    v_mov_b64 v[140:141], v[42:43]
    v_mov_b64 v[142:143], v[46:47]
    v_mfma_f32_32x32x16_bf16 v[16:31], v[168:171], v[136:139], v[16:31]
K2_qsel_8_d:
    s_nop 4
    s_setprio 0
    v_exp_f32 v0, v0
    v_exp_f32 v1, v1
    v_exp_f32 v2, v2
    buffer_load_dwordx4 v[174:177], v240, s[24:27], s46 offen sc1
    v_exp_f32 v3, v3
    v_exp_f32 v4, v4
    v_mfma_f32_32x32x4_2b_bf16 v[32:63], v[148:149], v[146:147], 0 cbsz:1 abid:0
    v_exp_f32 v5, v5
    v_exp_f32 v6, v6
    v_exp_f32 v7, v7
    v_exp_f32 v8, v8
    v_exp_f32 v9, v9
    v_exp_f32 v10, v10
    v_exp_f32 v11, v11
    v_exp_f32 v12, v12
    s_waitcnt vmcnt(3)
    v_smfmac_f32_32x32x32_bf16 v[64:79], v[194:197], v[0:7], v236
    v_exp_f32 v13, v13
    v_exp_f32 v14, v14
    buffer_load_dwordx4 v[180:183], v240, s[24:27], s46 offen offset:256 sc1
    v_exp_f32 v15, v15
    v_exp_f32 v16, v16
    v_exp_f32 v17, v17
    v_smfmac_f32_32x32x32_bf16 v[64:79], v[198:201], v[8:15], v236
    v_exp_f32 v18, v18
    v_exp_f32 v19, v19
    v_exp_f32 v20, v20
    v_mfma_f32_32x32x16_bf16 v[32:47], v[168:171], v[132:135], v[32:47]
    v_exp_f32 v21, v21
    v_exp_f32 v22, v22
    v_exp_f32 v23, v23
    v_exp_f32 v24, v24
    v_exp_f32 v25, v25
    v_smfmac_f32_32x32x32_bf16 v[96:111], v[194:197], v[16:23], v236
    v_exp_f32 v26, v26
    s_mov_b64 exec, s[62:63]
    buffer_load_dwordx4 v[210:213], v238, s[24:27], s46 offen sc1
    buffer_load_dwordx4 v[214:217], v238, s[24:27], s47 offen sc1
    s_mov_b64 exec, -1
    v_exp_f32 v27, v27
    v_exp_f32 v28, v28
    v_mfma_f32_32x32x16_bf16 v[48:63], v[168:171], v[140:143], v[48:63]
    v_exp_f32 v29, v29
    v_exp_f32 v30, v30
    v_exp_f32 v31, v31
    v_exp_f32 v32, v32
    v_exp_f32 v33, v33
    v_smfmac_f32_32x32x32_bf16 v[96:111], v[198:201], v[24:31], v236
    s_waitcnt vmcnt(4)
    v_exp_f32 v34, v34
    v_exp_f32 v35, v35
    v_exp_f32 v36, v36
    v_mfma_f32_32x32x4_2b_bf16 v[0:31], v[150:151], v[144:145], 0 cbsz:1 abid:0
    v_exp_f32 v37, v37
    v_exp_f32 v38, v38
    v_exp_f32 v39, v39
    v_exp_f32 v40, v40
    v_exp_f32 v41, v41
    v_exp_f32 v42, v42
    v_mov_b64 v[168:169], v[172:173]
    v_exp_f32 v43, v43
    v_exp_f32 v44, v44
    v_smfmac_f32_32x32x32_bf16 v[80:95], v[194:197], v[32:39], v236
    v_exp_f32 v45, v45
    v_exp_f32 v46, v46
    v_exp_f32 v47, v47
    v_exp_f32 v48, v48
    v_exp_f32 v49, v49
    v_smfmac_f32_32x32x32_bf16 v[80:95], v[198:201], v[40:47], v236
    v_exp_f32 v50, v50
    buffer_store_dwordx4 v[250:253], v244, s[24:27], s65 offen sc1
    v_exp_f32 v51, v51
    v_exp_f32 v52, v52
    buffer_store_dword v250, v245, s[24:27], s66 offen sc1
    v_mfma_f32_32x32x16_bf16 v[0:15], v[166:169], v[128:131], v[0:15]
    v_exp_f32 v53, v53
    v_exp_f32 v54, v54
    v_exp_f32 v55, v55
    v_exp_f32 v56, v56
    v_exp_f32 v57, v57
    v_smfmac_f32_32x32x32_bf16 v[112:127], v[194:197], v[48:55], v236
    v_exp_f32 v58, v58
    v_exp_f32 v59, v59
    v_exp_f32 v60, v60
    v_mfma_f32_32x32x16_bf16 v[16:31], v[166:169], v[136:139], v[16:31]
    v_exp_f32 v61, v61
    v_exp_f32 v62, v62
    v_exp_f32 v63, v63
    v_exp_f32 v0, v0
    v_exp_f32 v1, v1
    v_smfmac_f32_32x32x32_bf16 v[112:127], v[198:201], v[56:63], v236
    v_exp_f32 v2, v2
    s_mov_b64 exec, s[62:63]
    buffer_load_dwordx4 v[218:221], v241, s[24:27], s46 offen sc1
    buffer_load_dwordx4 v[222:225], v241, s[24:27], s47 offen sc1
    s_mov_b64 exec, -1
    v_exp_f32 v3, v3
    v_exp_f32 v4, v4
    v_mfma_f32_32x32x4_2b_bf16 v[32:63], v[150:151], v[146:147], 0 cbsz:1 abid:0
    v_exp_f32 v5, v5
    v_exp_f32 v6, v6
    v_exp_f32 v7, v7
    v_exp_f32 v8, v8
    v_exp_f32 v9, v9
    v_exp_f32 v10, v10
    v_exp_f32 v11, v11
    v_exp_f32 v12, v12
    v_smfmac_f32_32x32x32_bf16 v[64:79], v[202:205], v[0:7], v236
    v_exp_f32 v13, v13
    v_exp_f32 v14, v14
    buffer_load_dwordx4 v[152:155], v242, s[24:27], s48 offen sc1
    v_exp_f32 v15, v15
    v_exp_f32 v16, v16
    v_exp_f32 v17, v17
    v_smfmac_f32_32x32x32_bf16 v[64:79], v[206:209], v[8:15], v236
    v_exp_f32 v18, v18
    v_exp_f32 v19, v19
    v_exp_f32 v20, v20
    v_mfma_f32_32x32x16_bf16 v[32:47], v[166:169], v[132:135], v[32:47]
    v_exp_f32 v21, v21
    v_exp_f32 v22, v22
    v_exp_f32 v23, v23
    v_exp_f32 v24, v24
    v_exp_f32 v25, v25
    v_smfmac_f32_32x32x32_bf16 v[96:111], v[202:205], v[16:23], v236
    v_exp_f32 v26, v26
    buffer_load_dwordx4 v[184:187], v240, s[24:27], s48 offen sc1
    v_exp_f32 v27, v27
    v_exp_f32 v28, v28
    v_mfma_f32_32x32x16_bf16 v[48:63], v[166:169], v[140:143], v[48:63]
    v_exp_f32 v29, v29
    v_exp_f32 v30, v30
    v_exp_f32 v31, v31
    v_exp_f32 v32, v32
    v_exp_f32 v33, v33
    v_smfmac_f32_32x32x32_bf16 v[96:111], v[206:209], v[24:31], v236
    s_waitcnt vmcnt(6)
    v_exp_f32 v34, v34
    v_exp_f32 v35, v35
    v_exp_f32 v36, v36
    v_mfma_f32_32x32x4_2b_bf16 v[0:31], v[148:149], v[144:145], 0 cbsz:1 abid:1
    v_exp_f32 v37, v37
    v_exp_f32 v38, v38
    v_exp_f32 v39, v39
    v_exp_f32 v40, v40
    buffer_load_dwordx4 v[190:193], v240, s[24:27], s48 offen offset:256 sc1
    v_exp_f32 v41, v41
    v_exp_f32 v42, v42
    v_mov_b64 v[178:179], v[174:175]
    v_exp_f32 v43, v43
    v_exp_f32 v44, v44
    v_smfmac_f32_32x32x32_bf16 v[80:95], v[202:205], v[32:39], v236
    v_exp_f32 v45, v45
    v_exp_f32 v46, v46
    v_exp_f32 v47, v47
    v_exp_f32 v48, v48
    v_exp_f32 v49, v49
    v_smfmac_f32_32x32x32_bf16 v[80:95], v[206:209], v[40:47], v236
    v_exp_f32 v50, v50
    v_exp_f32 v51, v51
    v_exp_f32 v52, v52
    v_mfma_f32_32x32x16_bf16 v[0:15], v[178:181], v[128:131], v[0:15]
    v_exp_f32 v53, v53
    v_exp_f32 v54, v54
    s_mov_b64 exec, s[62:63]
    buffer_load_dwordx4 v[226:229], v238, s[24:27], s48 offen sc1
    buffer_load_dwordx4 v[230:233], v238, s[24:27], s49 offen sc1
    s_mov_b64 exec, -1
    v_exp_f32 v55, v55
    v_exp_f32 v56, v56
    v_exp_f32 v57, v57
    v_smfmac_f32_32x32x32_bf16 v[112:127], v[202:205], v[48:55], v236
    v_exp_f32 v58, v58
    v_exp_f32 v59, v59
    v_exp_f32 v60, v60
    v_mfma_f32_32x32x16_bf16 v[16:31], v[178:181], v[136:139], v[16:31]
    v_exp_f32 v61, v61
    v_exp_f32 v62, v62
    v_exp_f32 v63, v63
    v_exp_f32 v0, v0
    v_exp_f32 v1, v1
    v_smfmac_f32_32x32x32_bf16 v[112:127], v[206:209], v[56:63], v236
    v_exp_f32 v2, v2
    s_mov_b64 exec, s[62:63]
    buffer_load_dwordx4 v[194:197], v241, s[24:27], s48 offen sc1
    buffer_load_dwordx4 v[198:201], v241, s[24:27], s49 offen sc1
    s_mov_b64 exec, -1
    v_exp_f32 v3, v3
    v_exp_f32 v4, v4
    v_mfma_f32_32x32x4_2b_bf16 v[32:63], v[148:149], v[146:147], 0 cbsz:1 abid:1
    v_exp_f32 v5, v5
    v_exp_f32 v6, v6
    v_exp_f32 v7, v7
    v_exp_f32 v8, v8
    v_exp_f32 v9, v9
    v_exp_f32 v10, v10
    v_exp_f32 v11, v11
    v_exp_f32 v12, v12
    v_smfmac_f32_32x32x32_bf16 v[64:79], v[210:213], v[0:7], v236
    v_exp_f32 v13, v13
    v_exp_f32 v14, v14
    v_exp_f32 v15, v15
    v_exp_f32 v16, v16
    v_exp_f32 v17, v17
    v_smfmac_f32_32x32x32_bf16 v[64:79], v[214:217], v[8:15], v236
    v_exp_f32 v18, v18
    v_exp_f32 v19, v19
    v_exp_f32 v20, v20
    v_mfma_f32_32x32x16_bf16 v[32:47], v[178:181], v[132:135], v[32:47]
    v_exp_f32 v21, v21
    v_exp_f32 v22, v22
    v_exp_f32 v23, v23
    v_exp_f32 v24, v24
    v_exp_f32 v25, v25
    v_smfmac_f32_32x32x32_bf16 v[96:111], v[210:213], v[16:23], v236
    v_exp_f32 v26, v26
    v_exp_f32 v27, v27
    v_exp_f32 v28, v28
    v_mfma_f32_32x32x16_bf16 v[48:63], v[178:181], v[140:143], v[48:63]
    v_exp_f32 v29, v29
    v_exp_f32 v30, v30
    v_exp_f32 v31, v31
    v_exp_f32 v32, v32
    v_exp_f32 v33, v33
    v_smfmac_f32_32x32x32_bf16 v[96:111], v[214:217], v[24:31], v236
    s_waitcnt vmcnt(7)
    v_exp_f32 v34, v34
    v_exp_f32 v35, v35
    v_exp_f32 v36, v36
    v_mfma_f32_32x32x4_2b_bf16 v[0:31], v[150:151], v[144:145], 0 cbsz:1 abid:1
    v_exp_f32 v37, v37
    v_exp_f32 v38, v38
    s_mov_b64 exec, 1
    ds_add_u32 v255, v254 offset:12
    s_mov_b64 exec, -1
    v_exp_f32 v39, v39
    v_exp_f32 v40, v40
    v_exp_f32 v41, v41
    v_exp_f32 v42, v42
    v_mov_b64 v[178:179], v[182:183]
    v_exp_f32 v43, v43
    v_exp_f32 v44, v44
    v_smfmac_f32_32x32x32_bf16 v[80:95], v[210:213], v[32:39], v236
    v_exp_f32 v45, v45
    v_exp_f32 v46, v46
    v_exp_f32 v47, v47
    v_exp_f32 v48, v48
    v_exp_f32 v49, v49
    v_smfmac_f32_32x32x32_bf16 v[80:95], v[214:217], v[40:47], v236
    v_exp_f32 v50, v50
    buffer_load_dwordx2 v[250:251], v234, s[24:27], s52 offen sc1
    v_exp_f32 v51, v51
    v_exp_f32 v52, v52
    v_mfma_f32_32x32x16_bf16 v[0:15], v[176:179], v[128:131], v[0:15]
    v_exp_f32 v53, v53
    v_exp_f32 v54, v54
    v_exp_f32 v55, v55
    v_exp_f32 v56, v56
    v_exp_f32 v57, v57
    v_smfmac_f32_32x32x32_bf16 v[112:127], v[210:213], v[48:55], v236
    v_exp_f32 v58, v58
    v_exp_f32 v59, v59
    v_exp_f32 v60, v60
    v_mfma_f32_32x32x16_bf16 v[16:31], v[176:179], v[136:139], v[16:31]
    v_exp_f32 v61, v61
    v_exp_f32 v62, v62
    v_exp_f32 v63, v63
    v_exp_f32 v0, v0
    v_exp_f32 v1, v1
    v_smfmac_f32_32x32x32_bf16 v[112:127], v[214:217], v[56:63], v236
    v_exp_f32 v2, v2
    buffer_load_dwordx4 v[164:167], v240, s[24:27], s50 offen sc1
    v_exp_f32 v3, v3
    v_exp_f32 v4, v4
    v_mfma_f32_32x32x4_2b_bf16 v[32:63], v[150:151], v[146:147], 0 cbsz:1 abid:1
    v_exp_f32 v5, v5
    v_exp_f32 v6, v6
    v_exp_f32 v7, v7
    v_exp_f32 v8, v8
    v_exp_f32 v9, v9
    v_exp_f32 v10, v10
    v_exp_f32 v11, v11
    v_exp_f32 v12, v12
    v_smfmac_f32_32x32x32_bf16 v[64:79], v[218:221], v[0:7], v236
    v_exp_f32 v13, v13
    v_exp_f32 v14, v14
    buffer_load_dwordx4 v[170:173], v240, s[24:27], s50 offen offset:256 sc1
    v_exp_f32 v15, v15
    v_exp_f32 v16, v16
    v_exp_f32 v17, v17
    v_smfmac_f32_32x32x32_bf16 v[64:79], v[222:225], v[8:15], v236
    v_exp_f32 v18, v18
    v_exp_f32 v19, v19
    v_exp_f32 v20, v20
    v_mfma_f32_32x32x16_bf16 v[32:47], v[176:179], v[132:135], v[32:47]
    v_exp_f32 v21, v21
    v_exp_f32 v22, v22
    v_exp_f32 v23, v23
    v_exp_f32 v24, v24
    v_exp_f32 v25, v25
    v_smfmac_f32_32x32x32_bf16 v[96:111], v[218:221], v[16:23], v236
    v_exp_f32 v26, v26
    s_mov_b64 exec, s[62:63]
    buffer_load_dwordx4 v[202:205], v238, s[24:27], s50 offen sc1
    buffer_load_dwordx4 v[206:209], v238, s[24:27], s51 offen sc1
    s_mov_b64 exec, -1
    v_exp_f32 v27, v27
    v_exp_f32 v28, v28
    v_mfma_f32_32x32x16_bf16 v[48:63], v[176:179], v[140:143], v[48:63]
    v_exp_f32 v29, v29
    v_exp_f32 v30, v30
    v_exp_f32 v31, v31
    v_exp_f32 v32, v32
    v_exp_f32 v33, v33
    v_smfmac_f32_32x32x32_bf16 v[96:111], v[222:225], v[24:31], v236
    s_waitcnt vmcnt(7)
    v_exp_f32 v34, v34
    v_exp_f32 v35, v35
    v_exp_f32 v36, v36
    v_mfma_f32_32x32x4_2b_bf16 v[0:31], v[152:153], v[144:145], 0 cbsz:1 abid:0
    v_exp_f32 v37, v37
    v_exp_f32 v38, v38
    v_exp_f32 v39, v39
    v_exp_f32 v40, v40
    s_mov_b64 exec, s[62:63]
    buffer_load_dwordx4 v[210:213], v241, s[24:27], s50 offen sc1
    buffer_load_dwordx4 v[214:217], v241, s[24:27], s51 offen sc1
    s_mov_b64 exec, -1
    v_exp_f32 v41, v41
    v_exp_f32 v42, v42
    v_mov_b64 v[188:189], v[184:185]
    v_exp_f32 v43, v43
    v_exp_f32 v44, v44
    v_smfmac_f32_32x32x32_bf16 v[80:95], v[218:221], v[32:39], v236
    v_exp_f32 v45, v45
    v_exp_f32 v46, v46
    v_exp_f32 v47, v47
    v_exp_f32 v48, v48
    v_exp_f32 v49, v49
    v_smfmac_f32_32x32x32_bf16 v[80:95], v[222:225], v[40:47], v236
    v_exp_f32 v50, v50
    v_exp_f32 v51, v51
    v_exp_f32 v52, v52
    v_mfma_f32_32x32x16_bf16 v[0:15], v[188:191], v[128:131], v[0:15]
    v_exp_f32 v53, v53
    v_exp_f32 v54, v54
    v_exp_f32 v55, v55
    v_exp_f32 v56, v56
    v_exp_f32 v57, v57
    v_smfmac_f32_32x32x32_bf16 v[112:127], v[218:221], v[48:55], v236
    v_exp_f32 v58, v58
    v_exp_f32 v59, v59
    v_exp_f32 v60, v60
    v_mfma_f32_32x32x16_bf16 v[16:31], v[188:191], v[136:139], v[16:31]
    v_exp_f32 v61, v61
    v_exp_f32 v62, v62
    v_exp_f32 v63, v63
    v_exp_f32 v0, v0
    v_exp_f32 v1, v1
    v_smfmac_f32_32x32x32_bf16 v[112:127], v[222:225], v[56:63], v236
    v_exp_f32 v2, v2
    buffer_load_dwordx4 v[156:159], v242, s[24:27], s72 offen sc1
    v_exp_f32 v3, v3
    v_exp_f32 v4, v4
    v_mfma_f32_32x32x4_2b_bf16 v[32:63], v[152:153], v[146:147], 0 cbsz:1 abid:0
    v_exp_f32 v5, v5
    v_exp_f32 v6, v6
    v_exp_f32 v7, v7
    v_exp_f32 v8, v8
    v_exp_f32 v9, v9
    v_exp_f32 v10, v10
    v_exp_f32 v11, v11
    v_exp_f32 v12, v12
    v_smfmac_f32_32x32x32_bf16 v[64:79], v[226:229], v[0:7], v236
    v_exp_f32 v13, v13
    v_exp_f32 v14, v14
    buffer_load_dwordx4 v[174:177], v240, s[24:27], s72 offen sc1
    v_exp_f32 v15, v15
    v_exp_f32 v16, v16
    v_exp_f32 v17, v17
    v_smfmac_f32_32x32x32_bf16 v[64:79], v[230:233], v[8:15], v236
    v_exp_f32 v18, v18
    v_exp_f32 v19, v19
    v_exp_f32 v20, v20
    v_mfma_f32_32x32x16_bf16 v[32:47], v[188:191], v[132:135], v[32:47]
    v_exp_f32 v21, v21
    v_exp_f32 v22, v22
    v_exp_f32 v23, v23
    v_exp_f32 v24, v24
    v_exp_f32 v25, v25
    v_smfmac_f32_32x32x32_bf16 v[96:111], v[226:229], v[16:23], v236
    v_exp_f32 v26, v26
    buffer_load_dwordx4 v[180:183], v240, s[24:27], s72 offen offset:256 sc1
    v_exp_f32 v27, v27
    v_exp_f32 v28, v28
    v_mfma_f32_32x32x16_bf16 v[48:63], v[188:191], v[140:143], v[48:63]
    v_exp_f32 v29, v29
    v_exp_f32 v30, v30
    v_exp_f32 v31, v31
    v_exp_f32 v32, v32
    v_exp_f32 v33, v33
    v_smfmac_f32_32x32x32_bf16 v[96:111], v[230:233], v[24:31], v236
    s_waitcnt vmcnt(10)
    v_exp_f32 v34, v34
    v_exp_f32 v35, v35
    v_exp_f32 v36, v36
    v_mfma_f32_32x32x4_2b_bf16 v[0:31], v[154:155], v[144:145], 0 cbsz:1 abid:0
    v_exp_f32 v37, v37
    v_exp_f32 v38, v38
    v_exp_f32 v39, v39
    v_exp_f32 v40, v40
    v_exp_f32 v41, v41
    v_exp_f32 v42, v42
    v_mov_b64 v[188:189], v[192:193]
    v_exp_f32 v43, v43
    v_exp_f32 v44, v44
    v_smfmac_f32_32x32x32_bf16 v[80:95], v[226:229], v[32:39], v236
    v_exp_f32 v45, v45
    v_exp_f32 v46, v46
    v_exp_f32 v47, v47
    v_exp_f32 v48, v48
    v_exp_f32 v49, v49
    v_smfmac_f32_32x32x32_bf16 v[80:95], v[230:233], v[40:47], v236
    v_exp_f32 v50, v50
    v_exp_f32 v51, v51
    v_exp_f32 v52, v52
    v_mfma_f32_32x32x16_bf16 v[0:15], v[186:189], v[128:131], v[0:15]
    v_exp_f32 v53, v53
    v_exp_f32 v54, v54
    v_exp_f32 v55, v55
    v_exp_f32 v56, v56
    v_exp_f32 v57, v57
    v_smfmac_f32_32x32x32_bf16 v[112:127], v[226:229], v[48:55], v236
    v_exp_f32 v58, v58
    v_exp_f32 v59, v59
    v_exp_f32 v60, v60
    v_mfma_f32_32x32x16_bf16 v[16:31], v[186:189], v[136:139], v[16:31]
    v_exp_f32 v61, v61
    v_exp_f32 v62, v62
    v_exp_f32 v63, v63
    v_exp_f32 v0, v0
    v_exp_f32 v1, v1
    v_smfmac_f32_32x32x32_bf16 v[112:127], v[230:233], v[56:63], v236
    v_exp_f32 v2, v2
    s_mov_b64 exec, s[62:63]
    buffer_load_dwordx4 v[218:221], v238, s[24:27], s72 offen sc1
    buffer_load_dwordx4 v[222:225], v238, s[24:27], s73 offen sc1
    buffer_load_dwordx4 v[226:229], v241, s[24:27], s72 offen sc1
    buffer_load_dwordx4 v[230:233], v241, s[24:27], s73 offen sc1
    s_mov_b64 exec, -1
    v_exp_f32 v3, v3
    v_exp_f32 v4, v4
    v_mfma_f32_32x32x4_2b_bf16 v[32:63], v[154:155], v[146:147], 0 cbsz:1 abid:0
    v_exp_f32 v5, v5
    v_exp_f32 v6, v6
    v_exp_f32 v7, v7
    v_exp_f32 v8, v8
    v_exp_f32 v9, v9
    v_exp_f32 v10, v10
    v_exp_f32 v11, v11
    v_exp_f32 v12, v12
    v_smfmac_f32_32x32x32_bf16 v[64:79], v[194:197], v[0:7], v236
    v_exp_f32 v13, v13
    v_exp_f32 v14, v14
    v_exp_f32 v15, v15
    v_exp_f32 v16, v16
    v_exp_f32 v17, v17
    v_smfmac_f32_32x32x32_bf16 v[64:79], v[198:201], v[8:15], v236
    v_exp_f32 v18, v18
    v_exp_f32 v19, v19
    v_exp_f32 v20, v20
    v_mfma_f32_32x32x16_bf16 v[32:47], v[186:189], v[132:135], v[32:47]
    v_exp_f32 v21, v21
    v_exp_f32 v22, v22
    v_exp_f32 v23, v23
    v_exp_f32 v24, v24
    v_exp_f32 v25, v25
    v_smfmac_f32_32x32x32_bf16 v[96:111], v[194:197], v[16:23], v236
    v_exp_f32 v26, v26
    v_exp_f32 v27, v27
    v_exp_f32 v28, v28
    v_mfma_f32_32x32x16_bf16 v[48:63], v[186:189], v[140:143], v[48:63]
    v_exp_f32 v29, v29
    v_exp_f32 v30, v30
    v_exp_f32 v31, v31
    v_exp_f32 v32, v32
    v_exp_f32 v33, v33
    v_smfmac_f32_32x32x32_bf16 v[96:111], v[198:201], v[24:31], v236
    s_waitcnt vmcnt(9)
    v_exp_f32 v34, v34
    v_exp_f32 v35, v35
    v_exp_f32 v36, v36
    v_mfma_f32_32x32x4_2b_bf16 v[0:31], v[152:153], v[144:145], 0 cbsz:1 abid:1
    v_exp_f32 v37, v37
    v_exp_f32 v38, v38
    v_exp_f32 v39, v39
    v_exp_f32 v40, v40
    v_exp_f32 v41, v41
    v_exp_f32 v42, v42
    v_mov_b64 v[168:169], v[164:165]
    v_exp_f32 v43, v43
    v_exp_f32 v44, v44
    v_smfmac_f32_32x32x32_bf16 v[80:95], v[194:197], v[32:39], v236
    v_exp_f32 v45, v45
    v_exp_f32 v46, v46
    v_exp_f32 v47, v47
    v_exp_f32 v48, v48
    v_exp_f32 v49, v49
    v_smfmac_f32_32x32x32_bf16 v[80:95], v[198:201], v[40:47], v236
    v_exp_f32 v50, v50
    v_exp_f32 v51, v51
    v_exp_f32 v52, v52
    v_mfma_f32_32x32x16_bf16 v[0:15], v[168:171], v[128:131], v[0:15]
    v_exp_f32 v53, v53
    v_exp_f32 v54, v54
    v_exp_f32 v55, v55
    v_exp_f32 v56, v56
    v_exp_f32 v57, v57
    v_smfmac_f32_32x32x32_bf16 v[112:127], v[194:197], v[48:55], v236
    v_exp_f32 v58, v58
    v_exp_f32 v59, v59
    v_exp_f32 v60, v60
    v_mfma_f32_32x32x16_bf16 v[16:31], v[168:171], v[136:139], v[16:31]
    v_exp_f32 v61, v61
    v_exp_f32 v62, v62
    v_exp_f32 v63, v63
    v_exp_f32 v0, v0
    v_exp_f32 v1, v1
    v_smfmac_f32_32x32x32_bf16 v[112:127], v[198:201], v[56:63], v236
    v_exp_f32 v2, v2
    buffer_load_dwordx4 v[184:187], v240, s[24:27], s74 offen sc1
    v_exp_f32 v3, v3
    v_exp_f32 v4, v4
    v_mfma_f32_32x32x4_2b_bf16 v[32:63], v[152:153], v[146:147], 0 cbsz:1 abid:1
    v_exp_f32 v5, v5
    v_exp_f32 v6, v6
    v_exp_f32 v7, v7
    v_exp_f32 v8, v8
    v_exp_f32 v9, v9
    v_exp_f32 v10, v10
    v_exp_f32 v11, v11
    v_exp_f32 v12, v12
    v_smfmac_f32_32x32x32_bf16 v[64:79], v[202:205], v[0:7], v236
    v_exp_f32 v13, v13
    v_exp_f32 v14, v14
    buffer_load_dwordx4 v[190:193], v240, s[24:27], s74 offen offset:256 sc1
    v_exp_f32 v15, v15
    v_exp_f32 v16, v16
    v_exp_f32 v17, v17
    v_smfmac_f32_32x32x32_bf16 v[64:79], v[206:209], v[8:15], v236
    v_exp_f32 v18, v18
    v_exp_f32 v19, v19
    v_exp_f32 v20, v20
    v_mfma_f32_32x32x16_bf16 v[32:47], v[168:171], v[132:135], v[32:47]
    v_exp_f32 v21, v21
    v_exp_f32 v22, v22
    v_exp_f32 v23, v23
    v_exp_f32 v24, v24
    v_exp_f32 v25, v25
    v_smfmac_f32_32x32x32_bf16 v[96:111], v[202:205], v[16:23], v236
    v_exp_f32 v26, v26
    v_exp_f32 v27, v27
    v_exp_f32 v28, v28
    v_mfma_f32_32x32x16_bf16 v[48:63], v[168:171], v[140:143], v[48:63]
    v_exp_f32 v29, v29
    v_exp_f32 v30, v30
    v_exp_f32 v31, v31
    v_exp_f32 v32, v32
    v_exp_f32 v33, v33
    v_smfmac_f32_32x32x32_bf16 v[96:111], v[206:209], v[24:31], v236
    s_waitcnt vmcnt(9)
    v_exp_f32 v34, v34
    v_exp_f32 v35, v35
    v_exp_f32 v36, v36
    v_mfma_f32_32x32x4_2b_bf16 v[0:31], v[154:155], v[144:145], 0 cbsz:1 abid:1
    v_exp_f32 v37, v37
    v_exp_f32 v38, v38
    v_exp_f32 v39, v39
    v_exp_f32 v40, v40
    v_exp_f32 v41, v41
    v_exp_f32 v42, v42
    v_mov_b64 v[168:169], v[172:173]
    v_exp_f32 v43, v43
    v_exp_f32 v44, v44
    v_smfmac_f32_32x32x32_bf16 v[80:95], v[202:205], v[32:39], v236
    v_exp_f32 v45, v45
    v_exp_f32 v46, v46
    v_exp_f32 v47, v47
    v_exp_f32 v48, v48
    v_exp_f32 v49, v49
    v_smfmac_f32_32x32x32_bf16 v[80:95], v[206:209], v[40:47], v236
    v_exp_f32 v50, v50
    v_exp_f32 v51, v51
    v_exp_f32 v52, v52
    v_mfma_f32_32x32x16_bf16 v[0:15], v[166:169], v[128:131], v[0:15]
    v_exp_f32 v53, v53
    v_exp_f32 v54, v54
    v_exp_f32 v55, v55
    v_exp_f32 v56, v56
    v_exp_f32 v57, v57
    v_smfmac_f32_32x32x32_bf16 v[112:127], v[202:205], v[48:55], v236
    v_exp_f32 v58, v58
    v_exp_f32 v59, v59
    v_exp_f32 v60, v60
    v_mfma_f32_32x32x16_bf16 v[16:31], v[166:169], v[136:139], v[16:31]
    v_exp_f32 v61, v61
    v_exp_f32 v62, v62
    v_exp_f32 v63, v63
    v_exp_f32 v0, v0
    v_exp_f32 v1, v1
    v_smfmac_f32_32x32x32_bf16 v[112:127], v[206:209], v[56:63], v236
    v_exp_f32 v2, v2
    s_mov_b64 exec, s[62:63]
    buffer_load_dwordx4 v[194:197], v238, s[24:27], s74 offen sc1
    buffer_load_dwordx4 v[198:201], v238, s[24:27], s75 offen sc1
    buffer_load_dwordx4 v[202:205], v241, s[24:27], s74 offen sc1
    buffer_load_dwordx4 v[206:209], v241, s[24:27], s75 offen sc1
    s_mov_b64 exec, -1
    v_exp_f32 v3, v3
    v_exp_f32 v4, v4
    v_mfma_f32_32x32x4_2b_bf16 v[32:63], v[154:155], v[146:147], 0 cbsz:1 abid:1
    v_exp_f32 v5, v5
    v_exp_f32 v6, v6
    v_exp_f32 v7, v7
    v_exp_f32 v8, v8
    v_exp_f32 v9, v9
    v_exp_f32 v10, v10
    v_exp_f32 v11, v11
    v_exp_f32 v12, v12
    v_smfmac_f32_32x32x32_bf16 v[64:79], v[210:213], v[0:7], v236
    v_exp_f32 v13, v13
    v_exp_f32 v14, v14
    v_exp_f32 v15, v15
    v_exp_f32 v16, v16
    v_exp_f32 v17, v17
    v_smfmac_f32_32x32x32_bf16 v[64:79], v[214:217], v[8:15], v236
    v_exp_f32 v18, v18
    v_exp_f32 v19, v19
    v_exp_f32 v20, v20
    v_mfma_f32_32x32x16_bf16 v[32:47], v[166:169], v[132:135], v[32:47]
    v_exp_f32 v21, v21
    v_exp_f32 v22, v22
    v_exp_f32 v23, v23
    v_exp_f32 v24, v24
    v_exp_f32 v25, v25
    v_smfmac_f32_32x32x32_bf16 v[96:111], v[210:213], v[16:23], v236
    v_exp_f32 v26, v26
    v_exp_f32 v27, v27
    v_exp_f32 v28, v28
    v_mfma_f32_32x32x16_bf16 v[48:63], v[166:169], v[140:143], v[48:63]
    v_exp_f32 v29, v29
    v_exp_f32 v30, v30
    v_exp_f32 v31, v31
    v_exp_f32 v32, v32
    v_exp_f32 v33, v33
    v_smfmac_f32_32x32x32_bf16 v[96:111], v[214:217], v[24:31], v236
    s_waitcnt vmcnt(6)
    v_exp_f32 v34, v34
    v_exp_f32 v35, v35
    v_exp_f32 v36, v36
    v_mfma_f32_32x32x4_2b_bf16 v[0:31], v[156:157], v[144:145], 0 cbsz:1 abid:0
    v_exp_f32 v37, v37
    v_exp_f32 v38, v38
    v_exp_f32 v39, v39
    v_exp_f32 v40, v40
    v_exp_f32 v41, v41
    v_exp_f32 v42, v42
    v_mov_b64 v[178:179], v[174:175]
    v_exp_f32 v43, v43
    v_exp_f32 v44, v44
    v_smfmac_f32_32x32x32_bf16 v[80:95], v[210:213], v[32:39], v236
    v_exp_f32 v45, v45
    v_exp_f32 v46, v46
    v_exp_f32 v47, v47
    v_exp_f32 v48, v48
    v_exp_f32 v49, v49
    v_smfmac_f32_32x32x32_bf16 v[80:95], v[214:217], v[40:47], v236
    v_exp_f32 v50, v50
    v_exp_f32 v51, v51
    v_exp_f32 v52, v52
    v_mfma_f32_32x32x16_bf16 v[0:15], v[178:181], v[128:131], v[0:15]
    v_exp_f32 v53, v53
    v_exp_f32 v54, v54
    v_exp_f32 v55, v55
    v_exp_f32 v56, v56
    v_exp_f32 v57, v57
    v_smfmac_f32_32x32x32_bf16 v[112:127], v[210:213], v[48:55], v236
    v_exp_f32 v58, v58
    v_exp_f32 v59, v59
    v_exp_f32 v60, v60
    v_mfma_f32_32x32x16_bf16 v[16:31], v[178:181], v[136:139], v[16:31]
    v_exp_f32 v61, v61
    v_exp_f32 v62, v62
    v_exp_f32 v63, v63
    v_exp_f32 v0, v0
    v_exp_f32 v1, v1
    v_smfmac_f32_32x32x32_bf16 v[112:127], v[214:217], v[56:63], v236
    v_exp_f32 v2, v2
    buffer_load_dwordx4 v[160:163], v242, s[24:27], s76 offen sc1
    v_exp_f32 v3, v3
    v_exp_f32 v4, v4
    v_mfma_f32_32x32x4_2b_bf16 v[32:63], v[156:157], v[146:147], 0 cbsz:1 abid:0
    v_exp_f32 v5, v5
    v_exp_f32 v6, v6
    v_exp_f32 v7, v7
    v_exp_f32 v8, v8
    v_exp_f32 v9, v9
    v_exp_f32 v10, v10
    v_exp_f32 v11, v11
    v_exp_f32 v12, v12
    v_smfmac_f32_32x32x32_bf16 v[64:79], v[218:221], v[0:7], v236
    v_exp_f32 v13, v13
    v_exp_f32 v14, v14
    buffer_load_dwordx4 v[164:167], v240, s[24:27], s76 offen sc1
    v_exp_f32 v15, v15
    v_exp_f32 v16, v16
    v_exp_f32 v17, v17
    v_smfmac_f32_32x32x32_bf16 v[64:79], v[222:225], v[8:15], v236
    v_exp_f32 v18, v18
    v_exp_f32 v19, v19
    v_exp_f32 v20, v20
    v_mfma_f32_32x32x16_bf16 v[32:47], v[178:181], v[132:135], v[32:47]
    v_exp_f32 v21, v21
    v_exp_f32 v22, v22
    v_exp_f32 v23, v23
    v_exp_f32 v24, v24
    v_exp_f32 v25, v25
    v_smfmac_f32_32x32x32_bf16 v[96:111], v[218:221], v[16:23], v236
    v_exp_f32 v26, v26
    buffer_load_dwordx4 v[170:173], v240, s[24:27], s76 offen offset:256 sc1
    v_exp_f32 v27, v27
    v_exp_f32 v28, v28
    v_mfma_f32_32x32x16_bf16 v[48:63], v[178:181], v[140:143], v[48:63]
    v_exp_f32 v29, v29
    v_exp_f32 v30, v30
    v_exp_f32 v31, v31
    v_exp_f32 v32, v32
    v_exp_f32 v33, v33
    v_smfmac_f32_32x32x32_bf16 v[96:111], v[222:225], v[24:31], v236
    v_exp_f32 v34, v34
    v_exp_f32 v35, v35
    v_exp_f32 v36, v36
    v_mfma_f32_32x32x4_2b_bf16 v[0:31], v[158:159], v[144:145], 0 cbsz:1 abid:0
    v_exp_f32 v37, v37
    v_exp_f32 v38, v38
    v_exp_f32 v39, v39
    v_exp_f32 v40, v40
    v_exp_f32 v41, v41
    v_exp_f32 v42, v42
    v_mov_b64 v[178:179], v[182:183]
    v_exp_f32 v43, v43
    v_exp_f32 v44, v44
    v_smfmac_f32_32x32x32_bf16 v[80:95], v[218:221], v[32:39], v236
    v_exp_f32 v45, v45
    v_exp_f32 v46, v46
    v_exp_f32 v47, v47
    v_exp_f32 v48, v48
    v_exp_f32 v49, v49
    v_smfmac_f32_32x32x32_bf16 v[80:95], v[222:225], v[40:47], v236
    v_exp_f32 v50, v50
    v_exp_f32 v51, v51
    v_exp_f32 v52, v52
    v_mfma_f32_32x32x16_bf16 v[0:15], v[176:179], v[128:131], v[0:15]
    v_exp_f32 v53, v53
    v_exp_f32 v54, v54
    v_exp_f32 v55, v55
    v_exp_f32 v56, v56
    v_exp_f32 v57, v57
    v_smfmac_f32_32x32x32_bf16 v[112:127], v[218:221], v[48:55], v236
    v_exp_f32 v58, v58
    v_exp_f32 v59, v59
    v_exp_f32 v60, v60
    v_mfma_f32_32x32x16_bf16 v[16:31], v[176:179], v[136:139], v[16:31]
    v_exp_f32 v61, v61
    v_exp_f32 v62, v62
    v_exp_f32 v63, v63
    v_exp_f32 v0, v0
    v_exp_f32 v1, v1
    v_smfmac_f32_32x32x32_bf16 v[112:127], v[222:225], v[56:63], v236
    v_exp_f32 v2, v2
    s_mov_b64 exec, s[62:63]
    buffer_load_dwordx4 v[210:213], v238, s[24:27], s76 offen sc1
    buffer_load_dwordx4 v[214:217], v238, s[24:27], s77 offen sc1
    buffer_load_dwordx4 v[218:221], v241, s[24:27], s76 offen sc1
    buffer_load_dwordx4 v[222:225], v241, s[24:27], s77 offen sc1
    s_mov_b64 exec, -1
    v_exp_f32 v3, v3
    v_exp_f32 v4, v4
    v_mfma_f32_32x32x4_2b_bf16 v[32:63], v[158:159], v[146:147], 0 cbsz:1 abid:0
    v_exp_f32 v5, v5
    v_exp_f32 v6, v6
    v_exp_f32 v7, v7
    v_exp_f32 v8, v8
    v_exp_f32 v9, v9
    v_exp_f32 v10, v10
    v_exp_f32 v11, v11
    v_exp_f32 v12, v12
    v_smfmac_f32_32x32x32_bf16 v[64:79], v[226:229], v[0:7], v236
    v_exp_f32 v13, v13
    v_exp_f32 v14, v14
    v_exp_f32 v15, v15
    v_exp_f32 v16, v16
    v_exp_f32 v17, v17
    v_smfmac_f32_32x32x32_bf16 v[64:79], v[230:233], v[8:15], v236
    v_exp_f32 v18, v18
    v_exp_f32 v19, v19
    v_exp_f32 v20, v20
    v_mfma_f32_32x32x16_bf16 v[32:47], v[176:179], v[132:135], v[32:47]
    v_exp_f32 v21, v21
    v_exp_f32 v22, v22
    v_exp_f32 v23, v23
    v_exp_f32 v24, v24
    v_exp_f32 v25, v25
    v_smfmac_f32_32x32x32_bf16 v[96:111], v[226:229], v[16:23], v236
    v_exp_f32 v26, v26
    v_exp_f32 v27, v27
    v_exp_f32 v28, v28
    v_mfma_f32_32x32x16_bf16 v[48:63], v[176:179], v[140:143], v[48:63]
    v_exp_f32 v29, v29
    v_exp_f32 v30, v30
    v_exp_f32 v31, v31
    v_exp_f32 v32, v32
    v_exp_f32 v33, v33
    v_smfmac_f32_32x32x32_bf16 v[96:111], v[230:233], v[24:31], v236
    s_waitcnt vmcnt(7)
    v_exp_f32 v34, v34
    v_exp_f32 v35, v35
    v_exp_f32 v36, v36
    v_mfma_f32_32x32x4_2b_bf16 v[0:31], v[156:157], v[144:145], 0 cbsz:1 abid:1
    v_exp_f32 v37, v37
    v_exp_f32 v38, v38
    v_exp_f32 v39, v39
    v_exp_f32 v40, v40
    v_exp_f32 v41, v41
    v_exp_f32 v42, v42
    v_mov_b64 v[188:189], v[184:185]
    v_exp_f32 v43, v43
    v_exp_f32 v44, v44
    v_smfmac_f32_32x32x32_bf16 v[80:95], v[226:229], v[32:39], v236
    v_exp_f32 v45, v45
    v_exp_f32 v46, v46
    v_exp_f32 v47, v47
    v_exp_f32 v48, v48
    v_exp_f32 v49, v49
    v_smfmac_f32_32x32x32_bf16 v[80:95], v[230:233], v[40:47], v236
    v_exp_f32 v50, v50
    v_exp_f32 v51, v51
    v_exp_f32 v52, v52
    v_mfma_f32_32x32x16_bf16 v[0:15], v[188:191], v[128:131], v[0:15]
    v_exp_f32 v53, v53
    v_exp_f32 v54, v54
    v_exp_f32 v55, v55
    v_exp_f32 v56, v56
    v_exp_f32 v57, v57
    v_smfmac_f32_32x32x32_bf16 v[112:127], v[226:229], v[48:55], v236
    v_exp_f32 v58, v58
    v_exp_f32 v59, v59
    v_exp_f32 v60, v60
    v_mfma_f32_32x32x16_bf16 v[16:31], v[188:191], v[136:139], v[16:31]
    v_exp_f32 v61, v61
    v_exp_f32 v62, v62
    v_exp_f32 v63, v63
    v_exp_f32 v0, v0
    v_exp_f32 v1, v1
    v_smfmac_f32_32x32x32_bf16 v[112:127], v[230:233], v[56:63], v236
    v_exp_f32 v2, v2
    buffer_load_dwordx4 v[174:177], v240, s[24:27], s78 offen sc1
    v_exp_f32 v3, v3
    v_exp_f32 v4, v4
    v_mfma_f32_32x32x4_2b_bf16 v[32:63], v[156:157], v[146:147], 0 cbsz:1 abid:1
    v_exp_f32 v5, v5
    v_exp_f32 v6, v6
    v_exp_f32 v7, v7
    v_exp_f32 v8, v8
    v_exp_f32 v9, v9
    v_exp_f32 v10, v10
    v_exp_f32 v11, v11
    v_exp_f32 v12, v12
    v_smfmac_f32_32x32x32_bf16 v[64:79], v[194:197], v[0:7], v236
    v_exp_f32 v13, v13
    v_exp_f32 v14, v14
    buffer_load_dwordx4 v[180:183], v240, s[24:27], s78 offen offset:256 sc1
    v_exp_f32 v15, v15
    v_exp_f32 v16, v16
    v_exp_f32 v17, v17
    v_smfmac_f32_32x32x32_bf16 v[64:79], v[198:201], v[8:15], v236
    v_exp_f32 v18, v18
    v_exp_f32 v19, v19
    v_exp_f32 v20, v20
    v_mfma_f32_32x32x16_bf16 v[32:47], v[188:191], v[132:135], v[32:47]
    v_exp_f32 v21, v21
    v_exp_f32 v22, v22
    v_exp_f32 v23, v23
    v_exp_f32 v24, v24
    v_exp_f32 v25, v25
    v_smfmac_f32_32x32x32_bf16 v[96:111], v[194:197], v[16:23], v236
    v_exp_f32 v26, v26
    v_exp_f32 v27, v27
    v_exp_f32 v28, v28
    v_mfma_f32_32x32x16_bf16 v[48:63], v[188:191], v[140:143], v[48:63]
    v_exp_f32 v29, v29
    v_exp_f32 v30, v30
    v_exp_f32 v31, v31
    v_exp_f32 v32, v32
    v_exp_f32 v33, v33
    v_smfmac_f32_32x32x32_bf16 v[96:111], v[198:201], v[24:31], v236
    v_exp_f32 v34, v34
    v_exp_f32 v35, v35
    v_exp_f32 v36, v36
    v_mfma_f32_32x32x4_2b_bf16 v[0:31], v[158:159], v[144:145], 0 cbsz:1 abid:1
    v_exp_f32 v37, v37
    v_exp_f32 v38, v38
    v_exp_f32 v39, v39
    v_exp_f32 v40, v40
    v_exp_f32 v41, v41
    v_exp_f32 v42, v42
    v_mov_b64 v[188:189], v[192:193]
    v_exp_f32 v43, v43
    v_exp_f32 v44, v44
    v_smfmac_f32_32x32x32_bf16 v[80:95], v[194:197], v[32:39], v236
    v_exp_f32 v45, v45
    v_exp_f32 v46, v46
    v_exp_f32 v47, v47
    v_exp_f32 v48, v48
    v_exp_f32 v49, v49
    v_smfmac_f32_32x32x32_bf16 v[80:95], v[198:201], v[40:47], v236
    v_exp_f32 v50, v50
    v_exp_f32 v51, v51
    v_exp_f32 v52, v52
    v_mfma_f32_32x32x16_bf16 v[0:15], v[186:189], v[128:131], v[0:15]
    v_exp_f32 v53, v53
    v_exp_f32 v54, v54
    v_exp_f32 v55, v55
    v_exp_f32 v56, v56
    v_exp_f32 v57, v57
    v_smfmac_f32_32x32x32_bf16 v[112:127], v[194:197], v[48:55], v236
    v_exp_f32 v58, v58
    v_exp_f32 v59, v59
    v_exp_f32 v60, v60
    v_mfma_f32_32x32x16_bf16 v[16:31], v[186:189], v[136:139], v[16:31]
    v_exp_f32 v61, v61
    v_exp_f32 v62, v62
    v_exp_f32 v63, v63
    v_exp_f32 v0, v0
    v_exp_f32 v1, v1
    v_smfmac_f32_32x32x32_bf16 v[112:127], v[198:201], v[56:63], v236
    v_exp_f32 v2, v2
    s_mov_b64 exec, s[62:63]
    buffer_load_dwordx4 v[226:229], v238, s[24:27], s78 offen sc1
    buffer_load_dwordx4 v[230:233], v238, s[24:27], s79 offen sc1
    buffer_load_dwordx4 v[194:197], v241, s[24:27], s78 offen sc1
    buffer_load_dwordx4 v[198:201], v241, s[24:27], s79 offen sc1
    s_mov_b64 exec, -1
    v_exp_f32 v3, v3
    v_exp_f32 v4, v4
    v_mfma_f32_32x32x4_2b_bf16 v[32:63], v[158:159], v[146:147], 0 cbsz:1 abid:1
    v_exp_f32 v5, v5
    v_exp_f32 v6, v6
    v_exp_f32 v7, v7
    v_exp_f32 v8, v8
    v_exp_f32 v9, v9
    v_exp_f32 v10, v10
    v_exp_f32 v11, v11
    v_exp_f32 v12, v12
    v_smfmac_f32_32x32x32_bf16 v[64:79], v[202:205], v[0:7], v236
    v_exp_f32 v13, v13
    v_exp_f32 v14, v14
    v_exp_f32 v15, v15
    v_exp_f32 v16, v16
    v_exp_f32 v17, v17
    v_smfmac_f32_32x32x32_bf16 v[64:79], v[206:209], v[8:15], v236
    v_exp_f32 v18, v18
    v_exp_f32 v19, v19
    v_exp_f32 v20, v20
    v_mfma_f32_32x32x16_bf16 v[32:47], v[186:189], v[132:135], v[32:47]
    v_exp_f32 v21, v21
    v_exp_f32 v22, v22
    v_exp_f32 v23, v23
    v_exp_f32 v24, v24
    v_exp_f32 v25, v25
    v_smfmac_f32_32x32x32_bf16 v[96:111], v[202:205], v[16:23], v236
    v_exp_f32 v26, v26
    v_exp_f32 v27, v27
    v_exp_f32 v28, v28
    v_mfma_f32_32x32x16_bf16 v[48:63], v[186:189], v[140:143], v[48:63]
    v_exp_f32 v29, v29
    v_exp_f32 v30, v30
    v_exp_f32 v31, v31
    v_exp_f32 v32, v32
    v_exp_f32 v33, v33
    v_smfmac_f32_32x32x32_bf16 v[96:111], v[206:209], v[24:31], v236
    s_waitcnt vmcnt(6)
    v_exp_f32 v34, v34
    v_exp_f32 v35, v35
    v_exp_f32 v36, v36
    v_mfma_f32_32x32x4_2b_bf16 v[0:31], v[160:161], v[144:145], 0 cbsz:1 abid:0
    v_exp_f32 v37, v37
    v_exp_f32 v38, v38
    v_exp_f32 v39, v39
    v_exp_f32 v40, v40
    v_exp_f32 v41, v41
    v_exp_f32 v42, v42
    v_mov_b64 v[168:169], v[164:165]
    v_exp_f32 v43, v43
    v_exp_f32 v44, v44
    v_smfmac_f32_32x32x32_bf16 v[80:95], v[202:205], v[32:39], v236
    v_exp_f32 v45, v45
    v_exp_f32 v46, v46
    v_exp_f32 v47, v47
    v_exp_f32 v48, v48
    v_exp_f32 v49, v49
    v_smfmac_f32_32x32x32_bf16 v[80:95], v[206:209], v[40:47], v236
    v_exp_f32 v50, v50
    v_exp_f32 v51, v51
    v_exp_f32 v52, v52
    v_mfma_f32_32x32x16_bf16 v[0:15], v[168:171], v[128:131], v[0:15]
    v_exp_f32 v53, v53
    v_exp_f32 v54, v54
    v_exp_f32 v55, v55
    v_exp_f32 v56, v56
    v_exp_f32 v57, v57
    v_smfmac_f32_32x32x32_bf16 v[112:127], v[202:205], v[48:55], v236
    v_exp_f32 v58, v58
    v_exp_f32 v59, v59
    v_exp_f32 v60, v60
    v_mfma_f32_32x32x16_bf16 v[16:31], v[168:171], v[136:139], v[16:31]
    v_exp_f32 v61, v61
    v_exp_f32 v62, v62
    v_exp_f32 v63, v63
    v_exp_f32 v0, v0
    v_exp_f32 v1, v1
    v_smfmac_f32_32x32x32_bf16 v[112:127], v[206:209], v[56:63], v236
    v_exp_f32 v2, v2
    v_exp_f32 v3, v3
    v_exp_f32 v4, v4
    v_mfma_f32_32x32x4_2b_bf16 v[32:63], v[160:161], v[146:147], 0 cbsz:1 abid:0
    v_exp_f32 v5, v5
    v_exp_f32 v6, v6
    v_cmp_ne_u32 vcc, s53, v251
    s_cbranch_vccnz K2_gqspin0
K2_gqok0:
    v_exp_f32 v7, v7
    v_exp_f32 v8, v8
    v_exp_f32 v9, v9
    v_mov_b32 v190, v250
    v_exp_f32 v10, v10
    v_exp_f32 v11, v11
    v_exp_f32 v12, v12
    v_smfmac_f32_32x32x32_bf16 v[64:79], v[210:213], v[0:7], v236
    v_exp_f32 v13, v13
    v_exp_f32 v14, v14
    v_exp_f32 v15, v15
    v_exp_f32 v16, v16
    v_exp_f32 v17, v17
    v_smfmac_f32_32x32x32_bf16 v[64:79], v[214:217], v[8:15], v236
    v_exp_f32 v18, v18
    v_exp_f32 v19, v19
    v_exp_f32 v20, v20
    v_mfma_f32_32x32x16_bf16 v[32:47], v[168:171], v[132:135], v[32:47]
    v_exp_f32 v21, v21
    v_exp_f32 v22, v22
    v_exp_f32 v23, v23
    v_exp_f32 v24, v24
    v_exp_f32 v25, v25
    v_smfmac_f32_32x32x32_bf16 v[96:111], v[210:213], v[16:23], v236
    v_exp_f32 v26, v26
    v_exp_f32 v27, v27
    v_exp_f32 v28, v28
    v_mfma_f32_32x32x16_bf16 v[48:63], v[168:171], v[140:143], v[48:63]
    v_exp_f32 v29, v29
    v_exp_f32 v30, v30
    v_exp_f32 v31, v31
    v_exp_f32 v32, v32
    v_exp_f32 v33, v33
    v_smfmac_f32_32x32x32_bf16 v[96:111], v[214:217], v[24:31], v236
    v_exp_f32 v34, v34
    v_exp_f32 v35, v35
    v_exp_f32 v36, v36
    v_mfma_f32_32x32x4_2b_bf16 v[0:31], v[162:163], v[144:145], 0 cbsz:1 abid:0
    v_exp_f32 v37, v37
    v_exp_f32 v38, v38
    v_exp_f32 v39, v39
    v_exp_f32 v40, v40
    v_exp_f32 v41, v41
    v_exp_f32 v42, v42
    v_mov_b64 v[168:169], v[172:173]
    v_exp_f32 v43, v43
    v_exp_f32 v44, v44
    v_smfmac_f32_32x32x32_bf16 v[80:95], v[210:213], v[32:39], v236
    v_exp_f32 v45, v45
    v_exp_f32 v46, v46
    v_exp_f32 v47, v47
    v_exp_f32 v48, v48
    v_exp_f32 v49, v49
    v_smfmac_f32_32x32x32_bf16 v[80:95], v[214:217], v[40:47], v236
    v_exp_f32 v50, v50
    v_exp_f32 v51, v51
    v_exp_f32 v52, v52
    v_mfma_f32_32x32x16_bf16 v[0:15], v[166:169], v[128:131], v[0:15]
    v_exp_f32 v53, v53
    v_exp_f32 v54, v54
    v_exp_f32 v55, v55
    v_exp_f32 v56, v56
    v_exp_f32 v57, v57
    v_smfmac_f32_32x32x32_bf16 v[112:127], v[210:213], v[48:55], v236
    v_exp_f32 v58, v58
    v_exp_f32 v59, v59
    v_exp_f32 v60, v60
    v_mfma_f32_32x32x16_bf16 v[16:31], v[166:169], v[136:139], v[16:31]
    v_exp_f32 v61, v61
    v_exp_f32 v62, v62
    v_exp_f32 v63, v63
    v_exp_f32 v0, v0
    v_exp_f32 v1, v1
    v_smfmac_f32_32x32x32_bf16 v[112:127], v[214:217], v[56:63], v236
    v_exp_f32 v2, v2
    v_exp_f32 v3, v3
    v_exp_f32 v4, v4
    v_mfma_f32_32x32x4_2b_bf16 v[32:63], v[162:163], v[146:147], 0 cbsz:1 abid:0
    v_exp_f32 v5, v5
    v_exp_f32 v6, v6
    v_exp_f32 v7, v7
    v_exp_f32 v8, v8
    v_exp_f32 v9, v9
    v_exp_f32 v10, v10
    v_exp_f32 v11, v11
    v_exp_f32 v12, v12
    v_smfmac_f32_32x32x32_bf16 v[64:79], v[218:221], v[0:7], v236
    v_exp_f32 v13, v13
    v_exp_f32 v14, v14
    v_exp_f32 v15, v15
    v_exp_f32 v16, v16
    v_exp_f32 v17, v17
    v_smfmac_f32_32x32x32_bf16 v[64:79], v[222:225], v[8:15], v236
    v_exp_f32 v18, v18
    v_exp_f32 v19, v19
    v_exp_f32 v20, v20
    v_mfma_f32_32x32x16_bf16 v[32:47], v[166:169], v[132:135], v[32:47]
    v_exp_f32 v21, v21
    v_exp_f32 v22, v22
    v_exp_f32 v23, v23
    v_exp_f32 v24, v24
    v_exp_f32 v25, v25
    v_smfmac_f32_32x32x32_bf16 v[96:111], v[218:221], v[16:23], v236
    v_exp_f32 v26, v26
    v_exp_f32 v27, v27
    v_exp_f32 v28, v28
    v_mfma_f32_32x32x16_bf16 v[48:63], v[166:169], v[140:143], v[48:63]
    v_exp_f32 v29, v29
    v_exp_f32 v30, v30
    v_exp_f32 v31, v31
    v_exp_f32 v32, v32
    v_exp_f32 v33, v33
    v_smfmac_f32_32x32x32_bf16 v[96:111], v[222:225], v[24:31], v236
    s_waitcnt vmcnt(0)
    v_exp_f32 v34, v34
    v_exp_f32 v35, v35
    v_exp_f32 v36, v36
    v_mfma_f32_32x32x4_2b_bf16 v[0:31], v[160:161], v[144:145], 0 cbsz:1 abid:1
    v_exp_f32 v37, v37
    v_exp_f32 v38, v38
    v_exp_f32 v39, v39
    v_exp_f32 v40, v40
    v_exp_f32 v41, v41
    v_exp_f32 v42, v42
    v_mov_b64 v[178:179], v[174:175]
    v_exp_f32 v43, v43
    v_exp_f32 v44, v44
    v_smfmac_f32_32x32x32_bf16 v[80:95], v[218:221], v[32:39], v236
    v_exp_f32 v45, v45
    v_exp_f32 v46, v46
    v_exp_f32 v47, v47
    v_exp_f32 v48, v48
    v_exp_f32 v49, v49
    v_smfmac_f32_32x32x32_bf16 v[80:95], v[222:225], v[40:47], v236
    v_exp_f32 v50, v50
    v_exp_f32 v51, v51
    v_exp_f32 v52, v52
    v_mfma_f32_32x32x16_bf16 v[0:15], v[178:181], v[128:131], v[0:15]
    v_exp_f32 v53, v53
    v_exp_f32 v54, v54
    v_exp_f32 v55, v55
    v_exp_f32 v56, v56
    v_exp_f32 v57, v57
    v_smfmac_f32_32x32x32_bf16 v[112:127], v[218:221], v[48:55], v236
    v_exp_f32 v58, v58
    v_exp_f32 v59, v59
    v_exp_f32 v60, v60
    v_mfma_f32_32x32x16_bf16 v[16:31], v[178:181], v[136:139], v[16:31]
    v_exp_f32 v61, v61
    v_exp_f32 v62, v62
    v_exp_f32 v63, v63
    v_exp_f32 v0, v0
    v_exp_f32 v1, v1
    v_smfmac_f32_32x32x32_bf16 v[112:127], v[222:225], v[56:63], v236
    v_exp_f32 v2, v2
    v_exp_f32 v3, v3
    v_exp_f32 v4, v4
    v_mfma_f32_32x32x4_2b_bf16 v[32:63], v[160:161], v[146:147], 0 cbsz:1 abid:1
    v_exp_f32 v5, v5
    v_exp_f32 v6, v6
    v_exp_f32 v7, v7
    v_exp_f32 v8, v8
    v_exp_f32 v9, v9
    v_exp_f32 v10, v10
    v_exp_f32 v11, v11
    v_exp_f32 v12, v12
    v_smfmac_f32_32x32x32_bf16 v[64:79], v[226:229], v[0:7], v236
    v_exp_f32 v13, v13
    v_exp_f32 v14, v14
    v_exp_f32 v15, v15
    v_exp_f32 v16, v16
    v_exp_f32 v17, v17
    v_smfmac_f32_32x32x32_bf16 v[64:79], v[230:233], v[8:15], v236
    v_exp_f32 v18, v18
    v_exp_f32 v19, v19
    v_exp_f32 v20, v20
    v_mfma_f32_32x32x16_bf16 v[32:47], v[178:181], v[132:135], v[32:47]
    v_exp_f32 v21, v21
    v_exp_f32 v22, v22
    v_exp_f32 v23, v23
    v_exp_f32 v24, v24
    v_exp_f32 v25, v25
    v_smfmac_f32_32x32x32_bf16 v[96:111], v[226:229], v[16:23], v236
    v_exp_f32 v26, v26
    v_exp_f32 v27, v27
    v_exp_f32 v28, v28
    v_mfma_f32_32x32x16_bf16 v[48:63], v[178:181], v[140:143], v[48:63]
    v_exp_f32 v29, v29
    v_exp_f32 v30, v30
    v_exp_f32 v31, v31
    v_exp_f32 v32, v32
    v_exp_f32 v33, v33
    v_smfmac_f32_32x32x32_bf16 v[96:111], v[230:233], v[24:31], v236
    v_exp_f32 v34, v34
    v_exp_f32 v35, v35
    v_exp_f32 v36, v36
    v_mfma_f32_32x32x4_2b_bf16 v[0:31], v[162:163], v[144:145], 0 cbsz:1 abid:1
    v_exp_f32 v37, v37
    v_exp_f32 v38, v38
    v_exp_f32 v39, v39
    v_exp_f32 v40, v40
    v_exp_f32 v41, v41
    v_exp_f32 v42, v42
    v_mov_b64 v[178:179], v[182:183]
    v_exp_f32 v43, v43
    v_exp_f32 v44, v44
    v_smfmac_f32_32x32x32_bf16 v[80:95], v[226:229], v[32:39], v236
    v_exp_f32 v45, v45
    v_exp_f32 v46, v46
    v_exp_f32 v47, v47
    v_exp_f32 v48, v48
    v_exp_f32 v49, v49
    v_smfmac_f32_32x32x32_bf16 v[80:95], v[230:233], v[40:47], v236
    v_exp_f32 v50, v50
    v_exp_f32 v51, v51
    v_exp_f32 v52, v52
    v_mfma_f32_32x32x16_bf16 v[0:15], v[176:179], v[128:131], v[0:15]
    v_exp_f32 v53, v53
    v_exp_f32 v54, v54
    v_exp_f32 v55, v55
    v_exp_f32 v56, v56
    v_exp_f32 v57, v57
    v_smfmac_f32_32x32x32_bf16 v[112:127], v[226:229], v[48:55], v236
    v_exp_f32 v58, v58
    v_exp_f32 v59, v59
    v_exp_f32 v60, v60
    v_mfma_f32_32x32x16_bf16 v[16:31], v[176:179], v[136:139], v[16:31]
    v_exp_f32 v61, v61
    v_exp_f32 v62, v62
    v_exp_f32 v63, v63
    v_exp_f32 v0, v0
    v_exp_f32 v1, v1
    v_smfmac_f32_32x32x32_bf16 v[112:127], v[230:233], v[56:63], v236
    v_exp_f32 v2, v2
    v_exp_f32 v3, v3
    v_exp_f32 v4, v4
    v_mfma_f32_32x32x4_2b_bf16 v[32:63], v[162:163], v[146:147], 0 cbsz:1 abid:1
    v_exp_f32 v5, v5
    v_exp_f32 v6, v6
    v_exp_f32 v7, v7
    v_exp_f32 v8, v8
    v_exp_f32 v9, v9
    v_exp_f32 v10, v10
    v_exp_f32 v11, v11
    v_exp_f32 v12, v12
    v_smfmac_f32_32x32x32_bf16 v[64:79], v[194:197], v[0:7], v236
    v_exp_f32 v13, v13
    v_exp_f32 v14, v14
    v_exp_f32 v15, v15
    v_exp_f32 v16, v16
    v_exp_f32 v17, v17
    v_smfmac_f32_32x32x32_bf16 v[64:79], v[198:201], v[8:15], v236
    v_exp_f32 v18, v18
    v_exp_f32 v19, v19
    v_exp_f32 v20, v20
    v_mfma_f32_32x32x16_bf16 v[32:47], v[176:179], v[132:135], v[32:47]
    v_exp_f32 v21, v21
    v_exp_f32 v22, v22
    v_exp_f32 v23, v23
    v_exp_f32 v24, v24
    v_exp_f32 v25, v25
    v_smfmac_f32_32x32x32_bf16 v[96:111], v[194:197], v[16:23], v236
    v_exp_f32 v26, v26
    v_exp_f32 v27, v27
    v_exp_f32 v28, v28
    v_mfma_f32_32x32x16_bf16 v[48:63], v[176:179], v[140:143], v[48:63]
    v_exp_f32 v29, v29
    v_exp_f32 v30, v30
    v_exp_f32 v31, v31
    v_exp_f32 v32, v32
    ds_write_b128 v243, v[64:67]
    v_exp_f32 v33, v33
    v_smfmac_f32_32x32x32_bf16 v[96:111], v[198:201], v[24:31], v236
    v_exp_f32 v34, v34
    v_exp_f32 v35, v35
    v_exp_f32 v36, v36
    ds_write_b128 v243, v[68:71] offset:1024
    v_exp_f32 v37, v37
    v_exp_f32 v38, v38
    v_exp_f32 v39, v39
    v_exp_f32 v40, v40
    ds_write_b64 v243, v[72:73] offset:6144
    v_exp_f32 v41, v41
    v_exp_f32 v42, v42
    v_exp_f32 v43, v43
    v_exp_f32 v44, v44
    v_smfmac_f32_32x32x32_bf16 v[80:95], v[194:197], v[32:39], v236
    v_exp_f32 v45, v45
    ds_write_b128 v243, v[96:99] offset:4096
    v_exp_f32 v46, v46
    v_exp_f32 v47, v47
    v_exp_f32 v48, v48
    v_exp_f32 v49, v49
    v_smfmac_f32_32x32x32_bf16 v[80:95], v[198:201], v[40:47], v236
    v_exp_f32 v50, v50
    ds_write_b128 v243, v[100:103] offset:5120
    v_exp_f32 v51, v51
    v_exp_f32 v52, v52
    v_exp_f32 v53, v53
    v_exp_f32 v54, v54
    v_exp_f32 v55, v55
    ds_write_b64 v243, v[104:105] offset:7168
    v_exp_f32 v56, v56
    v_exp_f32 v57, v57
    v_smfmac_f32_32x32x32_bf16 v[112:127], v[194:197], v[48:55], v236
    v_exp_f32 v58, v58
    v_exp_f32 v59, v59
    v_exp_f32 v60, v60
    ds_write_b128 v243, v[80:83] offset:2048
    v_exp_f32 v61, v61
    v_exp_f32 v62, v62
    ds_write_b128 v243, v[84:87] offset:3072
    v_exp_f32 v63, v63
    ds_write_b64 v243, v[88:89] offset:6152
    s_nop 1
    v_smfmac_f32_32x32x32_bf16 v[112:127], v[198:201], v[56:63], v236
K2_fin0:
    s_setprio 2
    s_mov_b32 s5, 8388608
    s_mov_b64 exec, 1
    ds_add_u32 v255, v254
    s_mov_b64 exec, -1
K2_fin1:
    ds_read_b32 v0, v255
    ds_read_b128 v[64:67], v247
    ds_read_b128 v[68:71], v247 offset:1024
    ds_read_b64 v[72:73], v247 offset:6144
    ds_read_b128 v[80:83], v248 offset:2048
    ds_read_b128 v[84:87], v248 offset:3072
    ds_read_b64 v[88:89], v248 offset:6152
    ds_read_b128 v[96:99], v249 offset:4096
    ds_read_b128 v[100:103], v249 offset:5120
    ds_read_b64 v[104:105], v249 offset:7168
    s_waitcnt lgkmcnt(9)
    v_readfirstlane_b32 s4, v0
    s_cmp_lt_u32 s4, 4
    s_cbranch_scc1 K2_finwait
K2_fin2:
    s_mov_b32 s4, 813694976
    v_mov_b32 v9, 1568669696
    s_waitcnt lgkmcnt(6)
    v_pk_add_f32 v[112:113], v[112:113], v[64:65]
    v_pk_add_f32 v[114:115], v[114:115], v[66:67]
    v_pk_add_f32 v[116:117], v[116:117], v[68:69]
    v_pk_add_f32 v[118:119], v[118:119], v[70:71]
    v_pk_add_f32 v[120:121], v[120:121], v[72:73]
    s_waitcnt lgkmcnt(3)
    v_pk_add_f32 v[112:113], v[112:113], v[80:81]
    v_pk_add_f32 v[114:115], v[114:115], v[82:83]
    v_pk_add_f32 v[116:117], v[116:117], v[84:85]
    v_pk_add_f32 v[118:119], v[118:119], v[86:87]
    v_pk_add_f32 v[120:121], v[120:121], v[88:89]
    s_waitcnt lgkmcnt(0)
    v_pk_add_f32 v[120:121], v[120:121], v[104:105]
    v_pk_add_f32 v[112:113], v[112:113], v[96:97]
    v_rcp_f32 v0, v121
    v_pk_add_f32 v[114:115], v[114:115], v[98:99]
    v_pk_add_f32 v[116:117], v[116:117], v[100:101]
    v_pk_add_f32 v[118:119], v[118:119], v[102:103]
    v_mul_f32 v0, v0, v190
    v_maximum3_f32 v10, abs(v112), abs(v113), abs(v114)
    v_maximum3_f32 v11, abs(v115), abs(v116), abs(v120)
    v_maximum3_f32 v12, abs(v117), abs(v118), abs(v119)
    v_med3_f32 v8, v121, s4, v9
    v_maximum3_f32 v10, v10, v11, abs(v0)
    v_cmp_eq_f32 s[6:7], v8, v121
    v_maximum3_f32 v10, v10, v10, v12
    v_mul_f32 v2, v120, v0
    v_cmp_gt_f32 vcc, 1820327936, v10
    v_mul_f32 v3, v120, v0
    v_pk_mul_f32 v[112:113], v[112:113], v[0:1] op_sel_hi:[1,0]
    v_pk_mul_f32 v[114:115], v[114:115], v[0:1] op_sel_hi:[1,0]
    v_pk_mul_f32 v[116:117], v[116:117], v[0:1] op_sel_hi:[1,0]
    v_pk_mul_f32 v[118:119], v[118:119], v[0:1] op_sel_hi:[1,0]
    v_permlane32_swap_b32 v2, v3
    s_and_b64 vcc, vcc, s[6:7]
    v_cvt_pk_bf16_f32 v4, v112, v113
    v_cvt_pk_bf16_f32 v5, v114, v115
    s_cmp_eq_u64 vcc, exec
    v_cvt_pk_bf16_f32 v6, v116, v117
    v_cvt_pk_bf16_f32 v7, v118, v119
    v_cvt_pk_bf16_f32 v2, v2, v3
    s_cbranch_scc0 K2_slow
K2_fin:
    buffer_store_dwordx4 v[4:7], v244, s[24:27], s65 offen sc1
    buffer_store_dword v2, v245, s[24:27], s66 offen sc1
    s_cmp_eq_u32 s39, 0
    s_cbranch_scc1 K2_old2
    s_mov_b64 exec, 1
    ds_add_u32 v255, v254 offset:4
K2_end:
    s_endpgm
K2_old2:
    s_load_dwordx2 s[76:77], s[0:1], 72
    s_mov_b32 s78, 2359296
    s_mov_b32 s79, 0x00020000
    ds_read_b128 v[208:211], v235 offset:1024
    ds_read_b128 v[212:215], v235 offset:2048
    ds_read_b128 v[240:243], v235 offset:3072
    ds_read_b64 v[248:249], v235 offset:4096
    s_lshl_b32 s4, s32, 7
    s_add_u32 s52, s4, 7307264
    s_lshl_b32 s42, s40, 11
    s_add_u32 s66, s35, s42
    s_waitcnt vmcnt(2) lgkmcnt(0)
    s_cmp_eq_u32 s64, 0
    s_cbranch_scc1 K2_nop
    s_mov_b32 s5, 131072
K2_pchk:
    v_cmp_ne_u32 vcc, s53, v185
    v_cmp_ne_u32 s[8:9], s53, v187
    v_cmp_ne_u32 s[10:11], s53, v189
    s_or_b64 s[8:9], s[8:9], vcc
    s_or_b64 s[8:9], s[8:9], s[10:11]
    s_cbranch_scc0 K2_pok
    s_sleep 4
    buffer_load_dwordx2 v[184:185], v154, s[24:27], s67 offen sc1
    buffer_load_dwordx2 v[186:187], v154, s[24:27], s67 offen offset:512 sc1
    buffer_load_dwordx2 v[188:189], v154, s[24:27], s67 offen offset:1024 sc1
    s_sub_u32 s5, s5, 1
    s_waitcnt vmcnt(0)
    s_cbranch_scc0 K2_pchk
K2_pok:
    v_add_f32 v10, v184, v186
    v_add_f32 v10, v10, v188
    ds_write_b32 v208, v10
K2_nop:
    s_mov_b64 exec, 1
    ds_add_u32 v255, v254 offset:4
    s_mov_b64 exec, -1
    buffer_load_dwordx2 v[244:245], v215, s[24:27], s52 offen sc1
    s_mov_b32 s5, 8388608
K2_gw_9:
    ds_read_b32 v247, v255 offset:4
    s_waitcnt lgkmcnt(0)
    v_readfirstlane_b32 s4, v247
    s_cmp_ge_u32 s4, 4
    s_cbranch_scc1 K2_gw_9_d
    s_sleep 1
    s_sub_u32 s5, s5, 1
    s_cbranch_scc0 K2_gw_9
K2_gw_9_d:
    s_mov_b32 s5, 8388608
K2_gw_10:
    ds_read_b32 v247, v255 offset:24
    s_waitcnt lgkmcnt(0)
    v_readfirstlane_b32 s4, v247
    s_cmp_ge_u32 s4, 4
    s_cbranch_scc1 K2_gw_10_d
    s_sleep 1
    s_sub_u32 s5, s5, 1
    s_cbranch_scc0 K2_gw_10
K2_gw_10_d:
    s_mov_b64 exec, 1
    s_waitcnt vmcnt(1)
    buffer_store_dword v246, off, s[24:27], s61 sc1
    s_mov_b64 exec, -1
    s_cmp_eq_u32 s64, 0
    s_cbranch_scc0 K2_st2
    s_mov_b64 exec, 1
    ds_add_u32 v255, v254 offset:28
    s_mov_b64 exec, -1
    s_add_u32 m0, s42, 0
    s_add_u32 s67, s66, 0
    buffer_load_dwordx4 v237, s[24:27], s67 offen sc1 lds
    buffer_load_dwordx4 v237, s[24:27], s67 offen offset:1024 sc1 lds
    s_waitcnt vmcnt(4)
    s_add_u32 m0, s42, 8192
    s_add_u32 s67, s66, 8192
    buffer_load_dwordx4 v237, s[24:27], s67 offen sc1 lds
    buffer_load_dwordx4 v237, s[24:27], s67 offen offset:1024 sc1 lds
    s_waitcnt vmcnt(4)
    s_add_u32 m0, s42, 16384
    s_add_u32 s67, s66, 16384
    buffer_load_dwordx4 v237, s[24:27], s67 offen sc1 lds
    buffer_load_dwordx4 v237, s[24:27], s67 offen offset:1024 sc1 lds
    s_waitcnt vmcnt(4)
    s_add_u32 m0, s42, 24576
    s_add_u32 s67, s66, 24576
    buffer_load_dwordx4 v237, s[24:27], s67 offen sc1 lds
    buffer_load_dwordx4 v237, s[24:27], s67 offen offset:1024 sc1 lds
    s_waitcnt vmcnt(4)
    s_branch K2_nost2
K2_st2:
    s_add_u32 m0, s42, 0
    s_add_u32 s67, s66, 0
    buffer_load_dwordx4 v237, s[24:27], s67 offen sc1 lds
    buffer_load_dwordx4 v237, s[24:27], s67 offen offset:1024 sc1 lds
    ds_read2st64_b32 v[10:11], v209 offset0:0 offset1:1
    ds_read2st64_b32 v[12:13], v209 offset0:2 offset1:3
    ds_read_b64_tr_b16 v[24:25], v210
    ds_read_b64_tr_b16 v[26:27], v210 offset:4608
    ds_read_b64_tr_b16 v[28:29], v210 offset:32
    ds_read_b64_tr_b16 v[30:31], v210 offset:4640
    ds_read_b64_tr_b16 v[32:33], v210 offset:64
    ds_read_b64_tr_b16 v[34:35], v210 offset:4672
    ds_read_b64_tr_b16 v[36:37], v210 offset:96
    ds_read_b64_tr_b16 v[38:39], v210 offset:4704
    ds_read_b64_tr_b16 v[40:41], v210 offset:128
    ds_read_b64_tr_b16 v[42:43], v210 offset:4736
    s_waitcnt lgkmcnt(10)
    v_pk_add_f32 v[10:11], v[10:11], v[12:13]
    v_cvt_pk_bf16_f32 v11, v10, v11
    v_lshlrev_b32 v10, 16, v11
    v_mul_f32 v12, 3216550459, v10
    v_exp_f32 v12, v12
    v_and_b32 v11, 0xffff0000, v11
    v_add_f32 v12, 1.0, v12
    s_add_u32 m0, s42, 8192
    s_add_u32 s67, s66, 8192
    buffer_load_dwordx4 v237, s[24:27], s67 offen sc1 lds
    buffer_load_dwordx4 v237, s[24:27], s67 offen offset:1024 sc1 lds
    v_rcp_f32 v12, v12
    s_mul_i32 s4, s41, 4608
    v_mul_f32 v10, v10, v12
    v_cvt_pk_bf16_f32 v10, 0, v10
    v_mul_f32 v10, v10, v11
    v_cvt_pk_bf16_f32 v10, v10, v10
    ds_write_b16 v212, v10
    ds_read_b128 v[12:15], v211
    ds_read_b64_tr_b16 v[44:45], v210 offset:160
    ds_read_b64_tr_b16 v[46:47], v210 offset:4768
    ds_read_b64_tr_b16 v[48:49], v210 offset:192
    ds_read_b64_tr_b16 v[50:51], v210 offset:4800
    ds_read_b64_tr_b16 v[52:53], v210 offset:224
    ds_read_b64_tr_b16 v[54:55], v210 offset:4832
    ds_read_b64_tr_b16 v[56:57], v210 offset:256
    ds_read_b64_tr_b16 v[58:59], v210 offset:4864
    ds_read_b64_tr_b16 v[60:61], v210 offset:288
    ds_read_b64_tr_b16 v[62:63], v210 offset:4896
    s_add_u32 s5, s4, 9699328
    s_mov_b32 s10, 0
    s_mov_b32 s11, -1
    s_waitcnt lgkmcnt(10)
    v_mfma_f32_16x16x32_bf16 v[128:131], v[12:15], v[24:27], 0
    v_mfma_f32_16x16x32_bf16 v[132:135], v[12:15], v[28:31], 0
    v_mfma_f32_16x16x32_bf16 v[136:139], v[12:15], v[32:35], 0
    v_mfma_f32_16x16x32_bf16 v[140:143], v[12:15], v[36:39], 0
    v_mfma_f32_16x16x32_bf16 v[144:147], v[12:15], v[40:43], 0
    s_waitcnt lgkmcnt(0)
    v_mfma_f32_16x16x32_bf16 v[148:151], v[12:15], v[44:47], 0
    v_mfma_f32_16x16x32_bf16 v[152:155], v[12:15], v[48:51], 0
    v_mfma_f32_16x16x32_bf16 v[156:159], v[12:15], v[52:55], 0
    v_mfma_f32_16x16x32_bf16 v[160:163], v[12:15], v[56:59], 0
    v_mfma_f32_16x16x32_bf16 v[164:167], v[12:15], v[60:63], 0
    s_nop 1
    v_cndmask_b32 v128, v128, v132, s[10:11]
    buffer_store_dword v128, v213, s[24:27], s5 offen sc1
    v_cndmask_b32 v136, v136, v140, s[10:11]
    buffer_store_dword v136, v213, s[24:27], s5 offen offset:128 sc1
    v_cndmask_b32 v144, v144, v148, s[10:11]
    buffer_store_dword v144, v213, s[24:27], s5 offen offset:256 sc1
    v_cndmask_b32 v152, v152, v156, s[10:11]
    buffer_store_dword v152, v213, s[24:27], s5 offen offset:384 sc1
    v_cndmask_b32 v160, v160, v164, s[10:11]
    buffer_store_dword v160, v213, s[24:27], s5 offen offset:512 sc1
    s_mov_b64 exec, 1
    ds_add_u32 v255, v254 offset:28
    s_mov_b64 exec, -1
    s_lshl_b32 s4, s41, 7
    s_lshl_b32 s5, s40, 2
    s_add_u32 s4, s4, s5
    s_add_u32 s4, s4, 10747904
    s_mov_b64 exec, 1
    s_waitcnt vmcnt(0)
    buffer_store_dword v246, off, s[24:27], s4 sc1
    s_mov_b64 exec, -1
    s_add_u32 m0, s42, 16384
    s_add_u32 s67, s66, 16384
    buffer_load_dwordx4 v237, s[24:27], s67 offen sc1 lds
    buffer_load_dwordx4 v237, s[24:27], s67 offen offset:1024 sc1 lds
    s_waitcnt vmcnt(4)
    s_add_u32 m0, s42, 24576
    s_add_u32 s67, s66, 24576
    buffer_load_dwordx4 v237, s[24:27], s67 offen sc1 lds
    buffer_load_dwordx4 v237, s[24:27], s67 offen offset:1024 sc1 lds
    s_waitcnt vmcnt(4)
K2_nost2:
    s_add_u32 m0, s42, 32768
    s_add_u32 s67, s66, 32768
    buffer_load_dwordx4 v237, s[24:27], s67 offen sc1 lds
    buffer_load_dwordx4 v237, s[24:27], s67 offen offset:1024 sc1 lds
    s_waitcnt vmcnt(4)
    s_add_u32 m0, s42, 40960
    s_add_u32 s67, s66, 40960
    buffer_load_dwordx4 v237, s[24:27], s67 offen sc1 lds
    buffer_load_dwordx4 v237, s[24:27], s67 offen offset:1024 sc1 lds
    s_waitcnt vmcnt(4)
    s_add_u32 m0, s42, 49152
    s_add_u32 s67, s66, 49152
    buffer_load_dwordx4 v237, s[24:27], s67 offen sc1 lds
    buffer_load_dwordx4 v237, s[24:27], s67 offen offset:1024 sc1 lds
    s_waitcnt vmcnt(4)
    s_mov_b32 s5, 8388608
K2_gw_11:
    ds_read_b32 v247, v255 offset:28
    s_waitcnt lgkmcnt(0)
    v_readfirstlane_b32 s4, v247
    s_cmp_ge_u32 s4, 4
    s_cbranch_scc1 K2_gw_11_d
    s_sleep 1
    s_sub_u32 s5, s5, 1
    s_cbranch_scc0 K2_gw_11
K2_gw_11_d:
    s_add_u32 m0, s42, 57344
    s_add_u32 s67, s66, 57344
    buffer_load_dwordx4 v237, s[24:27], s67 offen sc1 lds
    buffer_load_dwordx4 v237, s[24:27], s67 offen offset:1024 sc1 lds
    s_waitcnt vmcnt(4)
    s_add_u32 m0, s42, 65536
    s_add_u32 s67, s66, 65536
    buffer_load_dwordx4 v237, s[24:27], s67 offen sc1 lds
    buffer_load_dwordx4 v237, s[24:27], s67 offen offset:1024 sc1 lds
    s_waitcnt vmcnt(4)
    s_add_u32 m0, s42, 73728
    s_add_u32 s67, s66, 73728
    buffer_load_dwordx4 v237, s[24:27], s67 offen sc1 lds
    buffer_load_dwordx4 v237, s[24:27], s67 offen offset:1024 sc1 lds
    s_waitcnt vmcnt(4)
    s_mov_b32 s5, 131072
K2_gchk:
    v_cmp_ne_u32 vcc, s53, v245
    s_cbranch_vccz K2_gok
    buffer_load_dwordx2 v[244:245], v215, s[24:27], s52 offen sc1
    s_sub_u32 s5, s5, 1
    s_waitcnt vmcnt(0)
    s_cbranch_scc0 K2_gchk
K2_gok:
    v_sub_f32 v244, 1.0, v244
    v_cvt_pk_bf16_f32 v245, v244, 0
    v_lshlrev_b32 v244, 16, v245
    s_add_u32 m0, s42, 81920
    s_add_u32 s67, s66, 81920
    buffer_load_dwordx4 v237, s[24:27], s67 offen sc1 lds
    buffer_load_dwordx4 v237, s[24:27], s67 offen offset:1024 sc1 lds
    s_sub_u32 s66, s66, s42
    s_mov_b32 s42, 0
    s_add_u32 m0, s42, 90112
    s_add_u32 s67, s66, 90112
    buffer_load_dwordx4 v237, s[24:27], s67 offen sc1 lds
    buffer_load_dwordx4 v237, s[24:27], s67 offen offset:1024 sc1 lds
    s_lshr_b32 s6, s32, 2
    s_lshr_b32 s4, s70, 6
    s_cmp_eq_u32 s4, s6
    s_cselect_b32 s64, 1, 0
    s_lshr_b32 s4, s71, 6
    s_cmp_eq_u32 s4, s6
    s_cselect_b32 s4, 2, 0
    s_or_b32 s64, s64, s4
    s_cbranch_scc0 K2_noy0
    v_min_u32 v114, 35, v239
    v_lshlrev_b32 v114, 7, v114
    s_mul_i32 s65, s40, 4608
    s_add_u32 s65, s65, 10747904
    buffer_load_dwordx4 v[104:107], v114, s[24:27], s65 offen sc1
K2_noy0:
    s_mov_b32 s5, 131072
K2_poll_12:
    buffer_load_dword v112, v214, s[24:27], s100 offen sc1
    s_sub_u32 s5, s5, 1
    s_cbranch_scc1 K2_poll_12_d
    s_waitcnt vmcnt(0)
    v_cmp_ne_u32 vcc, s53, v112
    s_cbranch_vccnz K2_poll_12
K2_poll_12_d:
    s_waitcnt vmcnt(0)
    s_mov_b64 exec, 1
    ds_add_u32 v255, v254 offset:8
    s_mov_b64 exec, -1
    s_cmp_eq_u32 s64, 0
    s_cbranch_scc1 K2_noy1
    s_mov_b32 s5, 131072
K2_ypoll:
    v_cmp_ne_u32 vcc, s53, v104
    v_cmp_ne_u32 s[8:9], s53, v105
    v_cmp_ne_u32 s[10:11], s53, v106
    s_or_b64 s[8:9], s[8:9], vcc
    v_cmp_ne_u32 vcc, s53, v107
    s_or_b64 s[8:9], s[8:9], s[10:11]
    s_or_b64 s[8:9], s[8:9], vcc
    s_cbranch_scc0 K2_ypolled
    buffer_load_dwordx4 v[104:107], v114, s[24:27], s65 offen sc1
    s_sub_u32 s5, s5, 1
    s_waitcnt vmcnt(0)
    s_cbranch_scc0 K2_ypoll
K2_ypolled:
    v_min_u32 v112, 53, v239
    v_mul_u32_u24 v113, 3641, v112
    v_lshrrev_b32 v113, 16, v113
    v_mul_u32_u24 v113, 4320, v113
    v_lshl_add_u32 v112, v112, 4, v113
    s_lshl_b32 s6, s33, 1
    s_mul_i32 s7, s40, 165888
    s_add_u32 s6, s6, s7
    s_add_u32 s65, s6, 9699328
    s_bitcmp1_b32 s64, 0
    s_cselect_b32 s6, 0, 2304
    s_cselect_b32 s7, 0, 1024
    s_add_u32 s6, s6, s65
    v_add_u32 v113, s7, v235
    buffer_load_dwordx4 v[56:59], v112, s[24:27], s6 offen sc1
    s_add_u32 s6, s6, 13824
    buffer_load_dwordx4 v[60:63], v112, s[24:27], s6 offen sc1
    s_add_u32 s6, s6, 13824
    buffer_load_dwordx4 v[64:67], v112, s[24:27], s6 offen sc1
    s_add_u32 s6, s6, 13824
    buffer_load_dwordx4 v[68:71], v112, s[24:27], s6 offen sc1
    s_add_u32 s6, s6, 13824
    buffer_load_dwordx4 v[72:75], v112, s[24:27], s6 offen sc1
    s_add_u32 s6, s6, 13824
    buffer_load_dwordx4 v[76:79], v112, s[24:27], s6 offen sc1
    s_add_u32 s6, s6, 13824
    buffer_load_dwordx4 v[80:83], v112, s[24:27], s6 offen sc1
    s_add_u32 s6, s6, 13824
    buffer_load_dwordx4 v[84:87], v112, s[24:27], s6 offen sc1
    s_add_u32 s6, s6, 13824
    buffer_load_dwordx4 v[88:91], v112, s[24:27], s6 offen sc1
    s_add_u32 s6, s6, 13824
    buffer_load_dwordx4 v[92:95], v112, s[24:27], s6 offen sc1
    s_add_u32 s6, s6, 13824
    buffer_load_dwordx4 v[96:99], v112, s[24:27], s6 offen sc1
    s_add_u32 s6, s6, 13824
    buffer_load_dwordx4 v[100:103], v112, s[24:27], s6 offen sc1
    s_add_u32 s6, s6, 13824
K2_noy1:
    buffer_load_dwordx4 v[20:23], v237, s[24:27], s98 offen sc1
    buffer_load_dwordx4 v[24:27], v237, s[24:27], s98 offen offset:1024 sc1
    buffer_load_dwordx4 v[28:31], v237, s[24:27], s98 offen offset:2048 sc1
    buffer_load_dwordx4 v[32:35], v237, s[24:27], s98 offen offset:3072 sc1
    buffer_load_dwordx4 v[36:39], v237, s[24:27], s101 offen sc1
    buffer_load_dwordx4 v[40:43], v237, s[24:27], s101 offen offset:1024 sc1
    buffer_load_dwordx4 v[44:47], v237, s[24:27], s101 offen offset:2048 sc1
    buffer_load_dwordx4 v[48:51], v237, s[24:27], s101 offen offset:3072 sc1
    buffer_load_dword v52, v243, s[24:27], s99 offen sc1
    buffer_load_dword v53, v243, s[24:27], s99 offen offset:128 sc1
    buffer_load_dword v54, v243, s[24:27], s99 offen offset:256 sc1
    buffer_load_dword v55, v243, s[24:27], s99 offen offset:384 sc1
    s_add_u32 s98, s98, 1048576
    s_add_u32 s101, s101, 1048576
    s_add_u32 s99, s99, 131072
    s_add_u32 s6, s34, 8064
    s_add_u32 s7, s34, 16128
    s_mov_b64 s[62:63], s[6:7]
    s_mov_b32 s5, 8388608
K2_gw_13:
    ds_read_b32 v247, v255 offset:8
    s_waitcnt lgkmcnt(0)
    v_readfirstlane_b32 s4, v247
    s_cmp_ge_u32 s4, 4
    s_cbranch_scc1 K2_gw_13_d
    s_sleep 1
    s_sub_u32 s5, s5, 1
    s_cbranch_scc0 K2_gw_13
K2_gw_13_d:
    ds_read_b128 v[116:119], v237 offset:15360
    ds_read_b128 v[120:123], v237 offset:16384
    ds_read_b128 v[124:127], v237 offset:17408
    ds_read_b128 v[128:131], v237 offset:18432
    ds_read_b128 v[132:135], v237 offset:19456
    ds_read_b128 v[136:139], v237 offset:20480
    ds_read_b128 v[140:143], v237 offset:21504
    ds_read_b128 v[144:147], v237 offset:22528
    ds_read_b128 v[148:151], v237 offset:23552
    ds_read_b128 v[152:155], v237 offset:24576
    ds_read_b128 v[156:159], v237 offset:25600
    ds_read_b128 v[160:163], v237 offset:26624
    ds_read_b128 v[164:167], v237 offset:27648
    ds_read_b128 v[168:171], v237 offset:28672
    ds_read_b128 v[172:175], v237 offset:29696
    ds_read_b128 v[176:179], v237 offset:30720
    ds_read_b128 v[180:183], v237 offset:31744
    ds_read_b128 v[184:187], v237 offset:32768
    ds_read_b128 v[188:191], v237 offset:33792
    ds_read_b128 v[192:195], v237 offset:34816
    ds_read_b128 v[196:199], v237 offset:35840
    ds_read_b128 v[200:203], v237 offset:36864
    ds_read_b128 v[204:207], v237 offset:37888
    ds_read_b128 v[208:211], v237 offset:38912
    ds_read_b128 v[212:215], v237 offset:39936
    s_cmp_eq_u32 s64, 0
    s_cbranch_scc1 K2_noy2
    s_waitcnt vmcnt(12)
K2_ysum:
    v_pk_add_f32 v[56:57], v[56:57], v[60:61]
    v_pk_add_f32 v[58:59], v[58:59], v[62:63]
    v_pk_add_f32 v[56:57], v[56:57], v[64:65]
    v_pk_add_f32 v[58:59], v[58:59], v[66:67]
    v_pk_add_f32 v[56:57], v[56:57], v[68:69]
    v_pk_add_f32 v[58:59], v[58:59], v[70:71]
    v_pk_add_f32 v[56:57], v[56:57], v[72:73]
    v_pk_add_f32 v[58:59], v[58:59], v[74:75]
    v_pk_add_f32 v[56:57], v[56:57], v[76:77]
    v_pk_add_f32 v[58:59], v[58:59], v[78:79]
    v_pk_add_f32 v[56:57], v[56:57], v[80:81]
    v_pk_add_f32 v[58:59], v[58:59], v[82:83]
    v_pk_add_f32 v[56:57], v[56:57], v[84:85]
    v_pk_add_f32 v[58:59], v[58:59], v[86:87]
    v_pk_add_f32 v[56:57], v[56:57], v[88:89]
    v_pk_add_f32 v[58:59], v[58:59], v[90:91]
    v_pk_add_f32 v[56:57], v[56:57], v[92:93]
    v_pk_add_f32 v[58:59], v[58:59], v[94:95]
    v_pk_add_f32 v[56:57], v[56:57], v[96:97]
    v_pk_add_f32 v[58:59], v[58:59], v[98:99]
    v_pk_add_f32 v[56:57], v[56:57], v[100:101]
    v_pk_add_f32 v[58:59], v[58:59], v[102:103]
    ds_write_b128 v113, v[56:59]
    s_cmp_lg_u32 s64, 3
    s_cbranch_scc1 K2_ydone
    s_mov_b32 s64, 2
    s_add_u32 s6, s65, 2304
    s_waitcnt lgkmcnt(0)
    v_add_u32 v113, 1024, v235
    buffer_load_dwordx4 v[56:59], v112, s[24:27], s6 offen sc1
    s_add_u32 s6, s6, 13824
    buffer_load_dwordx4 v[60:63], v112, s[24:27], s6 offen sc1
    s_add_u32 s6, s6, 13824
    buffer_load_dwordx4 v[64:67], v112, s[24:27], s6 offen sc1
    s_add_u32 s6, s6, 13824
    buffer_load_dwordx4 v[68:71], v112, s[24:27], s6 offen sc1
    s_add_u32 s6, s6, 13824
    buffer_load_dwordx4 v[72:75], v112, s[24:27], s6 offen sc1
    s_add_u32 s6, s6, 13824
    buffer_load_dwordx4 v[76:79], v112, s[24:27], s6 offen sc1
    s_add_u32 s6, s6, 13824
    buffer_load_dwordx4 v[80:83], v112, s[24:27], s6 offen sc1
    s_add_u32 s6, s6, 13824
    buffer_load_dwordx4 v[84:87], v112, s[24:27], s6 offen sc1
    s_add_u32 s6, s6, 13824
    buffer_load_dwordx4 v[88:91], v112, s[24:27], s6 offen sc1
    s_add_u32 s6, s6, 13824
    buffer_load_dwordx4 v[92:95], v112, s[24:27], s6 offen sc1
    s_add_u32 s6, s6, 13824
    buffer_load_dwordx4 v[96:99], v112, s[24:27], s6 offen sc1
    s_add_u32 s6, s6, 13824
    buffer_load_dwordx4 v[100:103], v112, s[24:27], s6 offen sc1
    s_add_u32 s6, s6, 13824
    s_waitcnt vmcnt(0)
    s_branch K2_ysum
K2_ydone:
    s_mov_b64 exec, 1
    ds_add_u32 v255, v254 offset:20
    s_mov_b64 exec, -1
K2_noy2:
    s_lshr_b32 s4, s70, 4
    s_cmp_lg_u32 s4, s32
    s_cbranch_scc1 K2_nosel0
    s_mov_b32 s5, 8388608
K2_gw_14:
    ds_read_b32 v247, v255 offset:20
    s_waitcnt lgkmcnt(0)
    v_readfirstlane_b32 s4, v247
    s_cmp_ge_u32 s4, 4
    s_cbranch_scc1 K2_gw_14_d
    s_sleep 1
    s_sub_u32 s5, s5, 1
    s_cbranch_scc0 K2_gw_14
K2_gw_14_d:
    s_mov_b32 s4, 106496
    v_lshl_add_u32 v113, v239, 3, s4
    s_and_b32 s4, s70, 15
    s_mul_i32 s4, s4, 144
    s_add_u32 s4, s4, s97
    v_lshl_add_u32 v112, v239, 2, s4
    ds_read_b64 v[56:57], v113
    ds_read_b64 v[58:59], v113 offset:288
    ds_read_b64 v[60:61], v113 offset:576
    ds_read_b64 v[62:63], v113 offset:5120
    ds_read_b64 v[64:65], v113 offset:5408
    ds_read_b64 v[66:67], v113 offset:5696
    ds_read_b64 v[68:69], v113 offset:10240
    ds_read_b64 v[70:71], v113 offset:10528
    ds_read_b64 v[72:73], v113 offset:10816
    ds_read_b64 v[74:75], v113 offset:15360
    ds_read_b64 v[76:77], v113 offset:15648
    ds_read_b64 v[78:79], v113 offset:15936
    ds_read_b32 v81, v112
    s_ashr_i32 s6, s68, 31
    s_not_b32 s6, s6
    s_or_b32 s6, s6, 0x80000000
    s_xor_b32 s6, s6, s68
    s_and_b32 s6, s6, 0xffff0000
    v_mov_b32 v114, 3216550459
    v_mul_f32 v114, s6, v114
    v_exp_f32 v114, v114
    s_mov_b32 s6, -1
    v_add_f32 v114, 1.0, v114
    v_rcp_f32 v114, v114
    s_mov_b32 s7, 15
    s_waitcnt lgkmcnt(0)
    v_pk_add_f32 v[56:57], v[56:57], v[68:69]
    v_pk_add_f32 v[58:59], v[58:59], v[70:71]
    v_pk_add_f32 v[60:61], v[60:61], v[72:73]
    v_pk_add_f32 v[62:63], v[62:63], v[74:75]
    v_pk_add_f32 v[64:65], v[64:65], v[76:77]
    v_pk_add_f32 v[66:67], v[66:67], v[78:79]
    v_pk_add_f32 v[56:57], v[56:57], v[62:63]
    v_pk_add_f32 v[58:59], v[58:59], v[64:65]
    v_pk_add_f32 v[60:61], v[60:61], v[66:67]
    v_lshlrev_b32 v80, 16, v81
    v_pk_add_f32 v[56:57], v[56:57], v[58:59]
    v_and_b32 v81, 0xffff0000, v81
    v_pk_add_f32 v[56:57], v[56:57], v[60:61]
    v_cvt_pk_bf16_f32 v114, 0, v114
    v_cvt_pk_bf16_f32 v56, 0, v56
    v_cvt_pk_bf16_f32 v57, 0, v57
    v_pk_mul_f32 v[56:57], v[56:57], v[114:115] op_sel_hi:[1,0]
    v_cvt_pk_bf16_f32 v56, 0, v56
    v_cvt_pk_bf16_f32 v57, 0, v57
    v_pk_add_f32 v[56:57], v[56:57], v[80:81]
    v_cvt_pk_bf16_f32 v56, v56, v57
    s_mov_b64 exec, s[6:7]
    ds_write_b32 v112, v56
    s_mov_b64 exec, -1
K2_nosel0:
    s_lshr_b32 s4, s71, 4
    s_cmp_lg_u32 s4, s32
    s_cbranch_scc1 K2_nosel1
    s_mov_b32 s5, 8388608
K2_gw_15:
    ds_read_b32 v247, v255 offset:20
    s_waitcnt lgkmcnt(0)
    v_readfirstlane_b32 s4, v247
    s_cmp_ge_u32 s4, 4
    s_cbranch_scc1 K2_gw_15_d
    s_sleep 1
    s_sub_u32 s5, s5, 1
    s_cbranch_scc0 K2_gw_15
K2_gw_15_d:
    s_mov_b32 s4, 107520
    v_lshl_add_u32 v113, v239, 3, s4
    s_and_b32 s4, s71, 15
    s_mul_i32 s4, s4, 144
    s_add_u32 s4, s4, s97
    v_lshl_add_u32 v112, v239, 2, s4
    ds_read_b64 v[56:57], v113
    ds_read_b64 v[58:59], v113 offset:288
    ds_read_b64 v[60:61], v113 offset:576
    ds_read_b64 v[62:63], v113 offset:5120
    ds_read_b64 v[64:65], v113 offset:5408
    ds_read_b64 v[66:67], v113 offset:5696
    ds_read_b64 v[68:69], v113 offset:10240
    ds_read_b64 v[70:71], v113 offset:10528
    ds_read_b64 v[72:73], v113 offset:10816
    ds_read_b64 v[74:75], v113 offset:15360
    ds_read_b64 v[76:77], v113 offset:15648
    ds_read_b64 v[78:79], v113 offset:15936
    ds_read_b32 v81, v112
    s_ashr_i32 s6, s69, 31
    s_not_b32 s6, s6
    s_or_b32 s6, s6, 0x80000000
    s_xor_b32 s6, s6, s69
    s_and_b32 s6, s6, 0xffff0000
    v_mov_b32 v114, 3216550459
    v_mul_f32 v114, s6, v114
    v_exp_f32 v114, v114
    s_mov_b32 s6, -1
    v_add_f32 v114, 1.0, v114
    v_rcp_f32 v114, v114
    s_mov_b32 s7, 15
    s_waitcnt lgkmcnt(0)
    v_pk_add_f32 v[56:57], v[56:57], v[68:69]
    v_pk_add_f32 v[58:59], v[58:59], v[70:71]
    v_pk_add_f32 v[60:61], v[60:61], v[72:73]
    v_pk_add_f32 v[62:63], v[62:63], v[74:75]
    v_pk_add_f32 v[64:65], v[64:65], v[76:77]
    v_pk_add_f32 v[66:67], v[66:67], v[78:79]
    v_pk_add_f32 v[56:57], v[56:57], v[62:63]
    v_pk_add_f32 v[58:59], v[58:59], v[64:65]
    v_pk_add_f32 v[60:61], v[60:61], v[66:67]
    v_lshlrev_b32 v80, 16, v81
    v_pk_add_f32 v[56:57], v[56:57], v[58:59]
    v_and_b32 v81, 0xffff0000, v81
    v_pk_add_f32 v[56:57], v[56:57], v[60:61]
    v_cvt_pk_bf16_f32 v114, 0, v114
    v_cvt_pk_bf16_f32 v56, 0, v56
    v_cvt_pk_bf16_f32 v57, 0, v57
    v_pk_mul_f32 v[56:57], v[56:57], v[114:115] op_sel_hi:[1,0]
    v_cvt_pk_bf16_f32 v56, 0, v56
    v_cvt_pk_bf16_f32 v57, 0, v57
    v_pk_add_f32 v[56:57], v[56:57], v[80:81]
    v_cvt_pk_bf16_f32 v56, v56, v57
    s_mov_b64 exec, s[6:7]
    ds_write_b32 v112, v56
    s_mov_b64 exec, -1
K2_nosel1:
    ds_read_b128 v[56:59], v237
    ds_read_b128 v[60:63], v237 offset:1024
    ds_read_b128 v[64:67], v237 offset:2048
    ds_read_b128 v[68:71], v237 offset:3072
    ds_read_b128 v[72:75], v237 offset:4096
    ds_read_b128 v[76:79], v237 offset:5120
    ds_read_b128 v[80:83], v237 offset:6144
    ds_read_b128 v[84:87], v237 offset:7168
    ds_read_b128 v[88:91], v237 offset:8192
    ds_read_b128 v[92:95], v237 offset:9216
    ds_read_b128 v[96:99], v237 offset:10240
    ds_read_b128 v[100:103], v237 offset:11264
    ds_read_b128 v[104:107], v237 offset:12288
    ds_read_b128 v[108:111], v237 offset:13312
    ds_read_b128 v[112:115], v237 offset:14336
    ds_read_b128 v[216:219], v237 offset:40960
    ds_read_b128 v[220:223], v237 offset:41984
    ds_read_b128 v[224:227], v237 offset:43008
    ds_read_b128 v[228:231], v237 offset:44032
    ds_read_b128 v[232:235], v237 offset:45056
    s_mov_b32 s5, 8388608
K2_gw_16:
    ds_read_b32 v247, v255 offset:16
    s_waitcnt lgkmcnt(0)
    v_readfirstlane_b32 s4, v247
    s_cmp_ge_u32 s4, 4
    s_cbranch_scc1 K2_gw_16_d
    s_sleep 2
    s_sub_u32 s5, s5, 1
    s_cbranch_scc0 K2_gw_16
K2_gw_16_d:
    s_setprio 0
    s_waitcnt vmcnt(0)
    v_mfma_f32_16x16x32_bf16 v[0:3], v[216:219], v[52:55], 0
    v_mfma_f32_16x16x32_bf16 v[4:7], v[220:223], v[52:55], 0
    v_mfma_f32_16x16x32_bf16 v[8:11], v[224:227], v[52:55], 0
    v_mfma_f32_16x16x32_bf16 v[12:15], v[228:231], v[52:55], 0
    v_mfma_f32_16x16x32_bf16 v[16:19], v[232:235], v[52:55], 0
    v_mfma_f32_16x16x32_bf16 v[0:3], v[56:59], v[20:23], v[0:3]
    ds_read_b128 v[216:219], v248 offset:40960
    v_mfma_f32_16x16x32_bf16 v[4:7], v[60:63], v[20:23], v[4:7]
    ds_read_b128 v[220:223], v248 offset:41984
    v_mfma_f32_16x16x32_bf16 v[8:11], v[64:67], v[20:23], v[8:11]
    ds_read_b128 v[224:227], v248 offset:43008
    v_mfma_f32_16x16x32_bf16 v[12:15], v[68:71], v[20:23], v[12:15]
    ds_read_b128 v[228:231], v248 offset:44032
    v_mfma_f32_16x16x32_bf16 v[16:19], v[72:75], v[20:23], v[16:19]
    ds_read_b128 v[232:235], v248 offset:45056
    v_mfma_f32_16x16x32_bf16 v[0:3], v[76:79], v[24:27], v[0:3]
    ds_read_b128 v[56:59], v248
    v_mfma_f32_16x16x32_bf16 v[4:7], v[80:83], v[24:27], v[4:7]
    ds_read_b128 v[60:63], v248 offset:1024
    v_mfma_f32_16x16x32_bf16 v[8:11], v[84:87], v[24:27], v[8:11]
    ds_read_b128 v[64:67], v248 offset:2048
    v_mfma_f32_16x16x32_bf16 v[12:15], v[88:91], v[24:27], v[12:15]
    ds_read_b128 v[68:71], v248 offset:3072
    v_mfma_f32_16x16x32_bf16 v[16:19], v[92:95], v[24:27], v[16:19]
    ds_read_b128 v[72:75], v248 offset:4096
    v_mfma_f32_16x16x32_bf16 v[0:3], v[96:99], v[28:31], v[0:3]
    ds_read_b128 v[76:79], v248 offset:5120
    v_mfma_f32_16x16x32_bf16 v[4:7], v[100:103], v[28:31], v[4:7]
    ds_read_b128 v[80:83], v248 offset:6144
    v_mfma_f32_16x16x32_bf16 v[8:11], v[104:107], v[28:31], v[8:11]
    ds_read_b128 v[84:87], v248 offset:7168
    v_mfma_f32_16x16x32_bf16 v[12:15], v[108:111], v[28:31], v[12:15]
    ds_read_b128 v[88:91], v248 offset:8192
    v_mfma_f32_16x16x32_bf16 v[16:19], v[112:115], v[28:31], v[16:19]
    ds_read_b128 v[92:95], v248 offset:9216
    v_mfma_f32_16x16x32_bf16 v[0:3], v[116:119], v[32:35], v[0:3]
    ds_read_b128 v[96:99], v248 offset:10240
    v_mfma_f32_16x16x32_bf16 v[4:7], v[120:123], v[32:35], v[4:7]
    ds_read_b128 v[100:103], v248 offset:11264
    v_mfma_f32_16x16x32_bf16 v[8:11], v[124:127], v[32:35], v[8:11]
    ds_read_b128 v[104:107], v248 offset:12288
    v_mfma_f32_16x16x32_bf16 v[12:15], v[128:131], v[32:35], v[12:15]
    ds_read_b128 v[108:111], v248 offset:13312
    v_mfma_f32_16x16x32_bf16 v[16:19], v[132:135], v[32:35], v[16:19]
    ds_read_b128 v[112:115], v248 offset:14336
    v_mfma_f32_16x16x32_bf16 v[0:3], v[136:139], v[36:39], v[0:3]
    ds_read_b128 v[116:119], v248 offset:15360
    v_mfma_f32_16x16x32_bf16 v[4:7], v[140:143], v[36:39], v[4:7]
    ds_read_b128 v[120:123], v248 offset:16384
    v_mfma_f32_16x16x32_bf16 v[8:11], v[144:147], v[36:39], v[8:11]
    ds_read_b128 v[124:127], v248 offset:17408
    v_mfma_f32_16x16x32_bf16 v[12:15], v[148:151], v[36:39], v[12:15]
    ds_read_b128 v[128:131], v248 offset:18432
    v_mfma_f32_16x16x32_bf16 v[16:19], v[152:155], v[36:39], v[16:19]
    ds_read_b128 v[132:135], v248 offset:19456
    v_mfma_f32_16x16x32_bf16 v[0:3], v[156:159], v[40:43], v[0:3]
    ds_read_b128 v[136:139], v248 offset:20480
    v_mfma_f32_16x16x32_bf16 v[4:7], v[160:163], v[40:43], v[4:7]
    ds_read_b128 v[140:143], v248 offset:21504
    v_mfma_f32_16x16x32_bf16 v[8:11], v[164:167], v[40:43], v[8:11]
    ds_read_b128 v[144:147], v248 offset:22528
    v_mfma_f32_16x16x32_bf16 v[12:15], v[168:171], v[40:43], v[12:15]
    ds_read_b128 v[148:151], v248 offset:23552
    v_mfma_f32_16x16x32_bf16 v[16:19], v[172:175], v[40:43], v[16:19]
    ds_read_b128 v[152:155], v248 offset:24576
    v_mfma_f32_16x16x32_bf16 v[0:3], v[176:179], v[44:47], v[0:3]
    ds_read_b128 v[156:159], v248 offset:25600
    v_mfma_f32_16x16x32_bf16 v[4:7], v[180:183], v[44:47], v[4:7]
    ds_read_b128 v[160:163], v248 offset:26624
    v_mfma_f32_16x16x32_bf16 v[8:11], v[184:187], v[44:47], v[8:11]
    ds_read_b128 v[164:167], v248 offset:27648
    v_mfma_f32_16x16x32_bf16 v[12:15], v[188:191], v[44:47], v[12:15]
    ds_read_b128 v[168:171], v248 offset:28672
    v_mfma_f32_16x16x32_bf16 v[16:19], v[192:195], v[44:47], v[16:19]
    ds_read_b128 v[172:175], v248 offset:29696
    v_mfma_f32_16x16x32_bf16 v[0:3], v[196:199], v[48:51], v[0:3]
    ds_read_b64 v[20:21], v241
    ds_read_b64 v[22:23], v241 offset:32
    v_mfma_f32_16x16x32_bf16 v[4:7], v[200:203], v[48:51], v[4:7]
    ds_read_b64 v[24:25], v241 offset:64
    ds_read_b64 v[26:27], v241 offset:96
    v_mfma_f32_16x16x32_bf16 v[8:11], v[204:207], v[48:51], v[8:11]
    ds_read_b64 v[28:29], v242 offset:128
    ds_read_b128 v[176:179], v248 offset:30720
    v_mfma_f32_16x16x32_bf16 v[12:15], v[208:211], v[48:51], v[12:15]
    ds_read_b128 v[180:183], v248 offset:31744
    ds_read_b128 v[184:187], v248 offset:32768
    v_mfma_f32_16x16x32_bf16 v[16:19], v[212:215], v[48:51], v[16:19]
    ds_read_b128 v[188:191], v248 offset:33792
    ds_read_b128 v[192:195], v248 offset:34816
    buffer_load_dword v52, v243, s[24:27], s99 offen sc1
    buffer_load_dword v53, v243, s[24:27], s99 offen offset:128 sc1
    buffer_load_dword v54, v243, s[24:27], s99 offen offset:256 sc1
    buffer_load_dword v55, v243, s[24:27], s99 offen offset:384 sc1
    ds_read_b128 v[196:199], v248 offset:35840
    ds_read_b128 v[200:203], v248 offset:36864
    ds_read_b128 v[204:207], v248 offset:37888
    ds_read_b128 v[208:211], v248 offset:38912
    ds_read_b128 v[212:215], v248 offset:39936
    s_waitcnt lgkmcnt(10)
    v_dot2c_f32_bf16 v0, v20, v245
    v_dot2c_f32_bf16 v1, v20, v244
    v_dot2c_f32_bf16 v2, v21, v245
    v_dot2c_f32_bf16 v3, v21, v244
    v_dot2c_f32_bf16 v4, v22, v245
    v_dot2c_f32_bf16 v5, v22, v244
    v_dot2c_f32_bf16 v6, v23, v245
    v_dot2c_f32_bf16 v7, v23, v244
    v_dot2c_f32_bf16 v8, v24, v245
    v_dot2c_f32_bf16 v9, v24, v244
    v_dot2c_f32_bf16 v10, v25, v245
    v_dot2c_f32_bf16 v11, v25, v244
    v_dot2c_f32_bf16 v12, v26, v245
    v_dot2c_f32_bf16 v13, v26, v244
    v_dot2c_f32_bf16 v14, v27, v245
    v_dot2c_f32_bf16 v15, v27, v244
    v_dot2c_f32_bf16 v16, v28, v245
    v_dot2c_f32_bf16 v17, v28, v244
    v_dot2c_f32_bf16 v18, v29, v245
    v_dot2c_f32_bf16 v19, v29, v244
    s_nop 2
    s_mov_b32 s5, 131072
K2_epoll:
    s_waitcnt vmcnt(0)
    v_max3_u32 v252, v52, v53, v54
    v_max_u32 v252, v252, v55
    v_cmp_eq_u32 vcc, -1, v252
    s_cbranch_vccz K2_eseen
    buffer_load_dword v52, v243, s[24:27], s99 offen sc1
    buffer_load_dword v53, v243, s[24:27], s99 offen offset:128 sc1
    buffer_load_dword v54, v243, s[24:27], s99 offen offset:256 sc1
    buffer_load_dword v55, v243, s[24:27], s99 offen offset:384 sc1
    s_sub_u32 s5, s5, 1
    s_cbranch_scc0 K2_epoll
    s_mov_b32 s5, 0
    s_waitcnt vmcnt(0)
K2_eseen:
    buffer_load_dwordx4 v[20:23], v237, s[24:27], s98 offen sc1
    buffer_load_dwordx4 v[24:27], v237, s[24:27], s98 offen offset:1024 sc1
    buffer_load_dwordx4 v[28:31], v237, s[24:27], s98 offen offset:2048 sc1
    buffer_load_dwordx4 v[32:35], v237, s[24:27], s98 offen offset:3072 sc1
    buffer_load_dwordx4 v[36:39], v237, s[24:27], s101 offen sc1
    buffer_load_dwordx4 v[40:43], v237, s[24:27], s101 offen offset:1024 sc1
    buffer_load_dwordx4 v[44:47], v237, s[24:27], s101 offen offset:2048 sc1
    buffer_load_dwordx4 v[48:51], v237, s[24:27], s101 offen offset:3072 sc1
    s_waitcnt lgkmcnt(0)
    v_mfma_f32_16x16x32_bf16 v[0:3], v[216:219], v[52:55], v[0:3]
    v_mfma_f32_16x16x32_bf16 v[4:7], v[220:223], v[52:55], v[4:7]
    v_mfma_f32_16x16x32_bf16 v[8:11], v[224:227], v[52:55], v[8:11]
    v_mfma_f32_16x16x32_bf16 v[12:15], v[228:231], v[52:55], v[12:15]
    v_mfma_f32_16x16x32_bf16 v[16:19], v[232:235], v[52:55], v[16:19]
K2_main:
    v_mov_b32 v252, 0
    s_waitcnt vmcnt(7)
    v_mfma_f32_16x16x32_bf16 v[216:219], v[56:59], v[20:23], v[0:3]
    v_max3_u32 v252, v252, v20, v21
    v_mfma_f32_16x16x32_bf16 v[220:223], v[60:63], v[20:23], v[4:7]
    v_max3_u32 v252, v252, v22, v23
    v_mfma_f32_16x16x32_bf16 v[224:227], v[64:67], v[20:23], v[8:11]
    v_mfma_f32_16x16x32_bf16 v[228:231], v[68:71], v[20:23], v[12:15]
    v_mfma_f32_16x16x32_bf16 v[232:235], v[72:75], v[20:23], v[16:19]
    s_waitcnt vmcnt(6)
    v_mfma_f32_16x16x32_bf16 v[216:219], v[76:79], v[24:27], v[216:219]
    v_max3_u32 v252, v252, v24, v25
    v_mfma_f32_16x16x32_bf16 v[220:223], v[80:83], v[24:27], v[220:223]
    v_max3_u32 v252, v252, v26, v27
    v_mfma_f32_16x16x32_bf16 v[224:227], v[84:87], v[24:27], v[224:227]
    v_mfma_f32_16x16x32_bf16 v[228:231], v[88:91], v[24:27], v[228:231]
    v_mfma_f32_16x16x32_bf16 v[232:235], v[92:95], v[24:27], v[232:235]
    s_waitcnt vmcnt(5)
    v_mfma_f32_16x16x32_bf16 v[216:219], v[96:99], v[28:31], v[216:219]
    v_max3_u32 v252, v252, v28, v29
    v_mfma_f32_16x16x32_bf16 v[220:223], v[100:103], v[28:31], v[220:223]
    v_max3_u32 v252, v252, v30, v31
    v_mfma_f32_16x16x32_bf16 v[224:227], v[104:107], v[28:31], v[224:227]
    v_mfma_f32_16x16x32_bf16 v[228:231], v[108:111], v[28:31], v[228:231]
    v_mfma_f32_16x16x32_bf16 v[232:235], v[112:115], v[28:31], v[232:235]
    s_waitcnt vmcnt(4)
    v_mfma_f32_16x16x32_bf16 v[216:219], v[116:119], v[32:35], v[216:219]
    v_max3_u32 v252, v252, v32, v33
    v_mfma_f32_16x16x32_bf16 v[220:223], v[120:123], v[32:35], v[220:223]
    v_max3_u32 v252, v252, v34, v35
    v_mfma_f32_16x16x32_bf16 v[224:227], v[124:127], v[32:35], v[224:227]
    v_mfma_f32_16x16x32_bf16 v[228:231], v[128:131], v[32:35], v[228:231]
    v_mfma_f32_16x16x32_bf16 v[232:235], v[132:135], v[32:35], v[232:235]
    s_waitcnt vmcnt(3)
    v_mfma_f32_16x16x32_bf16 v[216:219], v[136:139], v[36:39], v[216:219]
    v_max3_u32 v252, v252, v36, v37
    v_mfma_f32_16x16x32_bf16 v[220:223], v[140:143], v[36:39], v[220:223]
    v_max3_u32 v252, v252, v38, v39
    v_mfma_f32_16x16x32_bf16 v[224:227], v[144:147], v[36:39], v[224:227]
    v_mfma_f32_16x16x32_bf16 v[228:231], v[148:151], v[36:39], v[228:231]
    v_mfma_f32_16x16x32_bf16 v[232:235], v[152:155], v[36:39], v[232:235]
    s_waitcnt vmcnt(2)
    v_mfma_f32_16x16x32_bf16 v[216:219], v[156:159], v[40:43], v[216:219]
    v_max3_u32 v252, v252, v40, v41
    v_mfma_f32_16x16x32_bf16 v[220:223], v[160:163], v[40:43], v[220:223]
    v_max3_u32 v252, v252, v42, v43
    v_mfma_f32_16x16x32_bf16 v[224:227], v[164:167], v[40:43], v[224:227]
    v_mfma_f32_16x16x32_bf16 v[228:231], v[168:171], v[40:43], v[228:231]
    v_mfma_f32_16x16x32_bf16 v[232:235], v[172:175], v[40:43], v[232:235]
    s_waitcnt vmcnt(1)
    v_mfma_f32_16x16x32_bf16 v[216:219], v[176:179], v[44:47], v[216:219]
    v_max3_u32 v252, v252, v44, v45
    v_mfma_f32_16x16x32_bf16 v[220:223], v[180:183], v[44:47], v[220:223]
    v_max3_u32 v252, v252, v46, v47
    v_mfma_f32_16x16x32_bf16 v[224:227], v[184:187], v[44:47], v[224:227]
    v_mfma_f32_16x16x32_bf16 v[228:231], v[188:191], v[44:47], v[228:231]
    v_mfma_f32_16x16x32_bf16 v[232:235], v[192:195], v[44:47], v[232:235]
    s_waitcnt vmcnt(0)
    v_mfma_f32_16x16x32_bf16 v[216:219], v[196:199], v[48:51], v[216:219]
    v_max3_u32 v252, v252, v48, v49
    v_mfma_f32_16x16x32_bf16 v[220:223], v[200:203], v[48:51], v[220:223]
    v_max3_u32 v252, v252, v50, v51
    v_mfma_f32_16x16x32_bf16 v[224:227], v[204:207], v[48:51], v[224:227]
    v_cmp_eq_u32 vcc, -1, v252
    v_mfma_f32_16x16x32_bf16 v[228:231], v[208:211], v[48:51], v[228:231]
    v_mfma_f32_16x16x32_bf16 v[232:235], v[212:215], v[48:51], v[232:235]
    s_cbranch_vccnz K2_redo
K2_out:
    s_nop 0
    v_cvt_pk_bf16_f32 v72, v216, v217
    v_cvt_pk_bf16_f32 v73, v218, v219
    ds_write_b64 v241, v[72:73]
    v_cvt_pk_bf16_f32 v74, v220, v221
    v_cvt_pk_bf16_f32 v75, v222, v223
    ds_write_b64 v241, v[74:75] offset:32
    v_cvt_pk_bf16_f32 v76, v224, v225
    v_cvt_pk_bf16_f32 v77, v226, v227
    ds_write_b64 v241, v[76:77] offset:64
    v_cvt_pk_bf16_f32 v78, v228, v229
    v_cvt_pk_bf16_f32 v79, v230, v231
    ds_write_b64 v241, v[78:79] offset:96
    v_cvt_pk_bf16_f32 v80, v232, v233
    v_cvt_pk_bf16_f32 v81, v234, v235
    ds_write_b64 v242, v[80:81] offset:128
    ds_read_b128 v[56:59], v249
    ds_read_b128 v[60:63], v249 offset:1008
    ds_read_b128 v[64:67], v249 offset:2016
    s_waitcnt lgkmcnt(2)
    buffer_store_dwordx4 v[56:59], v240, s[76:79], s34 offen
    s_waitcnt lgkmcnt(1)
    buffer_store_dwordx4 v[60:63], v240, s[76:79], s62 offen
    s_mov_b64 exec, 0x3ffff
    s_waitcnt lgkmcnt(0)
    buffer_store_dwordx4 v[64:67], v240, s[76:79], s63 offen
    s_lshr_b32 s4, s70, 4
    s_cmp_lg_u32 s4, s32
    s_cbranch_scc1 K2_fini
    v_mov_b32 v252, 0
    buffer_store_dword v252, off, s[12:15], 0 sc1
K2_fini:
    s_endpgm
K2_redo:
    s_sub_u32 s5, s5, 1
    s_cbranch_scc1 K2_out
    buffer_load_dwordx4 v[20:23], v237, s[24:27], s98 offen sc1
    buffer_load_dwordx4 v[24:27], v237, s[24:27], s98 offen offset:1024 sc1
    buffer_load_dwordx4 v[28:31], v237, s[24:27], s98 offen offset:2048 sc1
    buffer_load_dwordx4 v[32:35], v237, s[24:27], s98 offen offset:3072 sc1
    buffer_load_dwordx4 v[36:39], v237, s[24:27], s101 offen sc1
    buffer_load_dwordx4 v[40:43], v237, s[24:27], s101 offen offset:1024 sc1
    buffer_load_dwordx4 v[44:47], v237, s[24:27], s101 offen offset:2048 sc1
    buffer_load_dwordx4 v[48:51], v237, s[24:27], s101 offen offset:3072 sc1
    s_branch K2_main
K2_slow:
    s_lshr_b32 s4, s36, 1
    s_mul_i32 s4, s4, 2304
    s_and_b32 s5, s36, 1
    s_mul_i32 s5, s5, 1280
    s_add_u32 s5, s5, s4
    s_add_u32 s4, s4, 1024
    v_and_b32 v4, 31, v239
    v_lshrrev_b32 v6, 5, v239
    v_lshrrev_b32 v5, 4, v4
    v_mul_u32_u24 v5, 110336, v5
    v_lshl_add_u32 v5, v4, 4, v5
    v_add_u32 v45, s4, v5
    v_add_u32 v42, s5, v5
    v_lshl_add_u32 v42, v6, 9, v42
    s_mul_i32 s4, s36, 288
    s_add_u32 s4, s4, 36864
    v_min_u32 v5, 17, v4
    v_lshl_add_u32 v43, v5, 4, s4
    v_mul_u32_u24 v5, 9216, v6
    v_add_u32 v43, v43, v5
    v_add_u32 v44, 18432, v43
    s_and_b32 s4, s40, 1
    s_lshl_b32 s4, s4, 3
    s_add_u32 s59, s57, s4
    buffer_load_dwordx2 v[144:145], v45, s[24:27], s59 offen sc1
    buffer_load_dwordx2 v[128:129], v42, s[24:27], s59 offen sc1
    buffer_load_dwordx2 v[130:131], v42, s[24:27], s59 offen offset:256 sc1
    v_and_b32 v4, 31, v239
    v_or_b32 v5, 4, v4
    v_cmp_eq_u32 vcc, 21, v5
    v_mov_b32 v6, 0x3f803f80
    s_bitcmp0_b32 s36, 0
    v_cndmask_b32 v194, 0, v6, vcc
    s_cselect_b32 s4, -1, 0
    s_cselect_b32 s5, 0, -1
    v_mov_b32 v195, v194
    v_mov_b32 v196, v194
    v_mov_b32 v197, v194
    v_mov_b32 v198, v194
    v_mov_b32 v199, v194
    v_mov_b32 v200, v194
    v_mov_b32 v201, v194
    v_mov_b32 v112, 0
    v_mov_b32 v113, 0
    v_mov_b32 v114, 0
    v_mov_b32 v115, 0
    v_mov_b32 v116, 0
    v_mov_b32 v117, 0
    v_mov_b32 v118, 0
    v_mov_b32 v119, 0
    v_mov_b32 v120, 0
    v_mov_b32 v121, 0
    v_mov_b32 v122, 0
    v_mov_b32 v123, 0
    v_mov_b32 v124, 0
    v_mov_b32 v125, 0
    v_mov_b32 v126, 0
    v_mov_b32 v127, 0
    v_mov_b32 v40, 0xff800000
    s_waitcnt vmcnt(0)
    v_and_b32 v144, s4, v144
    v_and_b32 v145, s5, v145
    s_mov_b32 s10, 0
K2_slow0:
    s_lshr_b32 s8, s10, 1
    s_mul_i32 s8, s8, 221184
    s_add_u32 s8, s8, 36864
    s_and_b32 s9, s10, 1
    s_lshl_b32 s11, s9, 3
    s_add_u32 s11, s11, s8
    s_mul_i32 s9, s9, 18432
    s_add_u32 s8, s8, s9
    s_add_u32 s9, s8, 110592
    buffer_load_dwordx2 v[164:165], v42, s[24:27], s11 offen sc1
    buffer_load_dwordx2 v[166:167], v42, s[24:27], s11 offen offset:256 sc1
    buffer_load_dwordx2 v[148:149], v45, s[24:27], s11 offen sc1
    s_waitcnt vmcnt(0)
    v_mfma_f32_32x32x4_2b_bf16 v[0:31], v[148:149], v[144:145], 0
    s_nop 15
    s_nop 3
    v_mfma_f32_32x32x16_bf16 v[0:15], v[164:167], v[128:131], v[0:15]
    s_nop 15
    v_max3_f32 v40, v40, v0, v1
    v_max3_f32 v40, v40, v2, v3
    v_max3_f32 v40, v40, v4, v5
    v_max3_f32 v40, v40, v6, v7
    v_max3_f32 v40, v40, v8, v9
    v_max3_f32 v40, v40, v10, v11
    v_max3_f32 v40, v40, v12, v13
    v_max3_f32 v40, v40, v14, v15
    s_add_u32 s10, s10, 1
    s_cmp_lt_u32 s10, 64
    s_cbranch_scc1 K2_slow0
    v_mov_b32 v41, v40
    s_nop 1
    v_permlane32_swap_b32 v40, v41
    s_nop 1
    v_max_f32 v40, v40, v41
    s_mov_b32 s10, 0
K2_slow1:
    s_lshr_b32 s8, s10, 1
    s_mul_i32 s8, s8, 221184
    s_add_u32 s8, s8, 36864
    s_and_b32 s9, s10, 1
    s_lshl_b32 s11, s9, 3
    s_add_u32 s11, s11, s8
    s_mul_i32 s9, s9, 18432
    s_add_u32 s8, s8, s9
    s_add_u32 s9, s8, 110592
    buffer_load_dwordx2 v[164:165], v42, s[24:27], s11 offen sc1
    buffer_load_dwordx2 v[166:167], v42, s[24:27], s11 offen offset:256 sc1
    buffer_load_dwordx2 v[148:149], v45, s[24:27], s11 offen sc1
    s_mov_b64 exec, s[62:63]
    buffer_load_dwordx4 v[194:197], v43, s[24:27], s8 offen sc1
    buffer_load_dwordx4 v[198:201], v43, s[24:27], s9 offen sc1
    s_mov_b64 exec, -1
    s_waitcnt vmcnt(0)
    v_mfma_f32_32x32x4_2b_bf16 v[0:31], v[148:149], v[144:145], 0
    s_nop 15
    s_nop 3
    v_mfma_f32_32x32x16_bf16 v[0:15], v[164:167], v[128:131], v[0:15]
    s_nop 15
    v_sub_f32 v0, v0, v40
    v_sub_f32 v1, v1, v40
    v_sub_f32 v2, v2, v40
    v_sub_f32 v3, v3, v40
    v_sub_f32 v4, v4, v40
    v_sub_f32 v5, v5, v40
    v_sub_f32 v6, v6, v40
    v_sub_f32 v7, v7, v40
    v_sub_f32 v8, v8, v40
    v_sub_f32 v9, v9, v40
    v_sub_f32 v10, v10, v40
    v_sub_f32 v11, v11, v40
    v_sub_f32 v12, v12, v40
    v_sub_f32 v13, v13, v40
    v_sub_f32 v14, v14, v40
    v_sub_f32 v15, v15, v40
    v_exp_f32 v0, v0
    v_exp_f32 v1, v1
    v_exp_f32 v2, v2
    v_exp_f32 v3, v3
    v_exp_f32 v4, v4
    v_exp_f32 v5, v5
    v_exp_f32 v6, v6
    v_exp_f32 v7, v7
    v_exp_f32 v8, v8
    v_exp_f32 v9, v9
    v_exp_f32 v10, v10
    v_exp_f32 v11, v11
    v_exp_f32 v12, v12
    v_exp_f32 v13, v13
    v_exp_f32 v14, v14
    v_exp_f32 v15, v15
    s_nop 1
    v_smfmac_f32_32x32x32_bf16 v[112:127], v[194:197], v[0:7], v236
    v_smfmac_f32_32x32x32_bf16 v[112:127], v[198:201], v[8:15], v236
    s_nop 15
    s_add_u32 s10, s10, 1
    s_cmp_lt_u32 s10, 64
    s_cbranch_scc1 K2_slow1
    v_rcp_f32 v0, v121
    s_nop 0
    v_mul_f32 v0, v0, v190
    v_mul_f32 v2, v120, v0
    v_mul_f32 v3, v120, v0
    v_pk_mul_f32 v[112:113], v[112:113], v[0:1] op_sel_hi:[1,0]
    v_pk_mul_f32 v[114:115], v[114:115], v[0:1] op_sel_hi:[1,0]
    v_pk_mul_f32 v[116:117], v[116:117], v[0:1] op_sel_hi:[1,0]
    v_pk_mul_f32 v[118:119], v[118:119], v[0:1] op_sel_hi:[1,0]
    v_permlane32_swap_b32 v2, v3
    v_cvt_pk_bf16_f32 v4, v112, v113
    v_cvt_pk_bf16_f32 v5, v114, v115
    v_cvt_pk_bf16_f32 v6, v116, v117
    v_cvt_pk_bf16_f32 v7, v118, v119
    v_cvt_pk_bf16_f32 v2, v2, v3
    v_min_u32 v2, -2, v2
    v_min_u32 v4, -2, v4
    v_min_u32 v5, -2, v5
    v_min_u32 v6, -2, v6
    v_min_u32 v7, -2, v7
    s_branch K2_fin
K2_gqspin0:
    s_mov_b32 s6, 131072
K2_gqspin01:
    buffer_load_dwordx2 v[250:251], v234, s[24:27], s52 offen sc1
    s_sub_u32 s6, s6, 1
    s_waitcnt vmcnt(0)
    s_cbranch_scc1 K2_gqok0
    v_cmp_ne_u32 vcc, s53, v251
    s_cbranch_vccnz K2_gqspin01
    s_branch K2_gqok0
K2_gqspin1:
    s_mov_b32 s6, 131072
K2_gqspin11:
    buffer_load_dwordx2 v[190:191], v155, s[24:27], s52 offen sc1
    s_sub_u32 s6, s6, 1
    s_waitcnt vmcnt(0)
    s_cbranch_scc1 K2_gqok1
    v_cmp_ne_u32 vcc, s53, v191
    s_cbranch_vccnz K2_gqspin11
    s_branch K2_gqok1
K2_finwait:
    s_sub_u32 s5, s5, 1
    s_cbranch_scc1 K2_fin2
    ds_read_b32 v0, v255
    s_waitcnt lgkmcnt(0)
    v_readfirstlane_b32 s4, v0
    s_cmp_lt_u32 s4, 3
    s_cbranch_scc0 K2_fin1
    s_branch K2_finwait
K2_candspin:
    s_mov_b32 s6, 131072
    s_mov_b32 s7, 7323648
K2_candspin1:
    buffer_load_dwordx4 v[250:253], v237, s[24:27], s7 offen sc1
    s_sub_u32 s6, s6, 1
    s_waitcnt vmcnt(0)
    s_cbranch_scc1 K2_candok
    v_cmp_ne_u32 vcc, s53, v251
    v_cmp_ne_u32 s[4:5], s53, v253
    s_or_b64 vcc, vcc, s[4:5]
    s_cbranch_scc1 K2_candspin1
    s_branch K2_candok
K2_codeend:
    s_endpgm
.section .rodata,"a"
.p2align 6
.amdhsa_kernel gated_mix__mha_block__moe_arch_mod__prompt_kernel
  .amdhsa_next_free_vgpr 256
  .amdhsa_next_free_sgpr 102
  .amdhsa_accum_offset 256
  .amdhsa_group_segment_fixed_size 0
  .amdhsa_kernarg_size 96
  .amdhsa_user_sgpr_count 2
  .amdhsa_user_sgpr_kernarg_segment_ptr 1
  .amdhsa_system_sgpr_workgroup_id_x 1
.end_amdhsa_kernel
```
